```python
import torch

def _softmax(x, axis=-1):
    return torch.softmax(x, dim=axis)
def _gelu(x):
    return torch.nn.functional.gelu(x, approximate="tanh")
def _silu(x):
    return torch.nn.functional.silu(x)
def _sigmoid(x):
    return torch.sigmoid(x)
def _layernorm(x, axis=-1, eps=1e-5):
    m = x.mean(dim=axis, keepdim=True)
    v = x.var(dim=axis, keepdim=True, unbiased=False)
    return (x - m) / torch.sqrt(v + eps)
def _scatter_add(tgt, idx, src, axis=0):
    return tgt.clone().index_add_(axis, idx, src)
def _segment_sum(src, seg, n):
    out = torch.zeros((n,) + src.shape[1:], dtype=src.dtype)
    return out.index_add_(0, seg, src)
def _pad(x, pw):
    flat = tuple(v for pair in reversed(pw) for v in pair)
    return torch.nn.functional.pad(x, flat)

kernel_name = 'sequential_preLN__mha_block__mixer_s_mlp__prompt'

def setup_inputs():

    _w = (lambda a: (lambda t: t.to(torch.bfloat16) if t.is_floating_point() else t)(torch.as_tensor(a)))
    def _A_setup():
        B, S, D, H = 1, 2048, 512, 32
        return {
            "x": _w((lambda *s: torch.randn(*s, dtype=torch.bfloat16) * 0.05)(B, S, D)),
            "wqkv": _w((lambda *s: torch.randn(*s, dtype=torch.bfloat16) * 0.05)(D, 3 * D)),
            "wo": _w((lambda *s: torch.randn(*s, dtype=torch.bfloat16) * 0.05)(D, D)),
        }
    _A_in = _A_setup()

    def _B_setup():
        B, S, D, F = 1, 2048, 512, 1792
        return {
            "x":  _w((lambda *s: torch.randn(*s, dtype=torch.bfloat16) * 0.05)(B, S, D)),
            "w1": _w((lambda *s: torch.randn(*s, dtype=torch.bfloat16) * 3.2)(D, D) * (D ** -0.5)),
            "w2": _w((lambda *s: torch.randn(*s, dtype=torch.bfloat16) * 3.2)(D, D) * (D ** -0.5)),
            "w3": _w((lambda *s: torch.randn(*s, dtype=torch.bfloat16) * 3.2)(D, F) * (D ** -0.5)),
            "w4": _w((lambda *s: torch.randn(*s, dtype=torch.bfloat16) * 3.2)(F, D) * (F ** -0.5)),
        }
    _B_in = _B_setup()

    return {
        "A_x": _A_in["x"],
        "A_wqkv": _A_in["wqkv"],
        "A_wo": _A_in["wo"],
        "B_x": _B_in["x"],
        "B_w1": _B_in["w1"],
        "B_w2": _B_in["w2"],
        "B_w3": _B_in["w3"],
        "B_w4": _B_in["w4"],
    }

def reference(A_x, A_wqkv, A_wo, B_x, B_w1, B_w2, B_w3, B_w4):
    def _A_ref(x, wqkv, wo):
        B, S, D = x.shape
        H = 32
        Dh = D // H
        qkv = (lambda x, *d: x.permute(*d))((x @ wqkv).reshape(B, S, 3, H, Dh), 2, 0, 3, 1, 4)
        q, k, v = qkv[0], qkv[1], qkv[2]
        scores = torch.einsum("bhqd,bhkd->bhqk", q, k) * (Dh ** -0.5)
        p = _softmax(scores, axis=-1)
        o = torch.einsum("bhqk,bhkd->bhqd", p, v)
        return (lambda x, *d: x.permute(*d))(o, 0, 2, 1, 3).reshape(B, S, D) @ wo

    def _B_ref(x, w1, w2, w3, w4):
        B, S, D = x.shape
        h = _gelu(_layernorm(x, axis=-1) @ w1)
        c = D // 4
        g0 = _pad(h[:, :, 0*c:1*c], ((0, 0), (1, 0), (0, 0)))[:, :S, :]
        g1 = _pad(h[:, :, 1*c:2*c], ((0, 0), (0, 1), (0, 0)))[:, 1:, :]
        g2 = _pad(h[:, :, 2*c:3*c], ((0, 0), (2, 0), (0, 0)))[:, :S, :]
        g3 = _pad(h[:, :, 3*c:   ], ((0, 0), (0, 2), (0, 0)))[:, 2:, :]
        hs = torch.concatenate([g0, g1, g2, g3], axis=-1) @ w2
        x1 = x + hs
        h2 = _gelu(_layernorm(x1, axis=-1) @ w3) @ w4
        return x1 + h2

    x = A_x
    h = x + _A_ref(_layernorm(x, axis=-1), A_wqkv, A_wo)
    h2 = h + _B_ref(_layernorm(h, axis=-1), B_w1, B_w2, B_w3, B_w4)
    return h2
```

```asm
; @launch grid=(256,1,1) block=(512,1,1) lds=163840
.amdgcn_target "amdgcn-amd-amdhsa--gfx950"
.text
.globl sequential_preLN__mha_block__mixer_s_mlp__prompt_kernel
.p2align 8
.type sequential_preLN__mha_block__mixer_s_mlp__prompt_kernel,@function
sequential_preLN__mha_block__mixer_s_mlp__prompt_kernel:
    s_cmp_ge_u32 s2, 256
    s_cbranch_scc1 sequential_preLN__mha_block__mixer_s_mlp__prompt_kernel_end
    s_load_dwordx16 s[36:51], s[0:1], 0
    s_load_dwordx4 s[52:55], s[0:1], 64
    s_load_dwordx2 s[56:57], s[0:1], 80
    v_lshrrev_b32 v1, 6, v0
    v_and_b32 v2, 63, v0
    v_readfirstlane_b32 s20, v1
    s_and_b32 s21, s2, 7
    s_lshr_b32 s22, s2, 3
    s_lshr_b32 s23, s22, 3
    s_and_b32 s24, s22, 7
    s_and_b32 s69, s20, 3
    s_cmp_lt_u32 s20, 4
    s_cbranch_scc1 L_cw11
    s_setprio 3
    s_memrealtime s[32:33]
    v_lshrrev_b32 v3, 3, v2
    s_lshl_b32 s27, s69, 3
    v_add_u32 v6, s27, v3
    v_lshrrev_b32 v4, 4, v2
    s_and_b32 s27, s69, 1
    s_lshl_b32 s27, s27, 2
    v_add_u32 v4, s27, v4
    v_and_b32 v5, 7, v2
    v_xor_b32 v4, v4, v5
    v_lshlrev_b32 v4, 4, v4
    v_lshl_add_u32 v12, v6, 10, v4
    v_bfe_u32 v4, v3, 1, 1
    v_lshlrev_b32 v4, 2, v4
    v_bfe_u32 v7, v3, 2, 1
    v_lshl_add_u32 v4, v7, 1, v4
    v_xor_b32 v4, v4, v5
    v_lshlrev_b32 v55, 4, v4
    s_movk_i32 s27, 0xc00
    v_mad_u32_u24 v13, v6, s27, v55
    s_lshl_b32 s28, s22, 16
    s_lshl_b32 s29, s69, 10
    s_xor_b32 s31, s21, 5
    s_lshl_b32 s31, s31, 7
    s_add_u32 s68, s24, s21
    s_mov_b32 s18, 0x200000
    s_mov_b32 s19, 0x20000
    s_mov_b32 s14, 0x180000
    s_mov_b32 s15, 0x20000
    s_waitcnt lgkmcnt(0)
    s_or_b32 s27, s2, s69
    s_cmp_lg_u32 s27, 0
    s_cbranch_scc1 L_nc2
    s_mov_b32 s8, s54
    s_mov_b32 s9, s55
    s_mov_b32 s10, 0x100
    s_mov_b32 s11, 0x20000
    s_lshl_b64 s[32:33], s[32:33], 5
    s_or_b32 s32, s32, 16
    v_mov_b32 v10, s32
    v_mov_b32 v11, s33
    s_mov_b64 exec, 1
    buffer_store_dwordx2 v[10:11], off, s[8:11], 0 sc1
    s_mov_b64 exec, -1
L_nc2:
    s_mov_b64 s[16:17], s[36:37]
    s_mov_b64 s[12:13], s[38:39]
    s_add_u32 s33, s68, 0
    s_and_b32 s33, s33, 7
    s_lshl_b32 s34, s33, 7
    s_add_u32 s34, s34, s28
    s_add_u32 m0, s29, 0
    s_nop 0
    buffer_load_dwordx4 v12, s[16:19], s34 offen lds
    s_add_u32 m0, s29, 4096
    s_add_u32 s34, s34, 32768
    buffer_load_dwordx4 v12, s[16:19], s34 offen lds
    s_add_u32 s33, s68, 0
    s_and_b32 s33, s33, 7
    s_mul_i32 s35, s33, 196608
    s_add_u32 s35, s35, s31
    s_add_u32 m0, s29, 65536
    s_add_u32 s34, s35, 0
    buffer_load_dwordx4 v13, s[12:15], s34 offen lds
    s_add_u32 m0, s29, 73728
    s_add_u32 s34, s35, 1024
    buffer_load_dwordx4 v13, s[12:15], s34 offen lds
    s_add_u32 m0, s29, 81920
    s_add_u32 s34, s35, 2048
    buffer_load_dwordx4 v13, s[12:15], s34 offen lds
    s_add_u32 m0, s29, 69632
    s_add_u32 s34, s35, 98304
    buffer_load_dwordx4 v13, s[12:15], s34 offen lds
    s_add_u32 m0, s29, 77824
    s_add_u32 s34, s35, 99328
    buffer_load_dwordx4 v13, s[12:15], s34 offen lds
    s_add_u32 m0, s29, 86016
    s_add_u32 s34, s35, 100352
    buffer_load_dwordx4 v13, s[12:15], s34 offen lds
    s_add_u32 s33, s68, 1
    s_and_b32 s33, s33, 7
    s_lshl_b32 s34, s33, 7
    s_add_u32 s34, s34, s28
    s_add_u32 m0, s29, 8192
    s_nop 0
    buffer_load_dwordx4 v12, s[16:19], s34 offen lds
    s_add_u32 m0, s29, 12288
    s_add_u32 s34, s34, 32768
    buffer_load_dwordx4 v12, s[16:19], s34 offen lds
    s_add_u32 s33, s68, 1
    s_and_b32 s33, s33, 7
    s_mul_i32 s35, s33, 196608
    s_add_u32 s35, s35, s31
    s_add_u32 m0, s29, 90112
    s_add_u32 s34, s35, 0
    buffer_load_dwordx4 v13, s[12:15], s34 offen lds
    s_add_u32 m0, s29, 98304
    s_add_u32 s34, s35, 1024
    buffer_load_dwordx4 v13, s[12:15], s34 offen lds
    s_add_u32 m0, s29, 106496
    s_add_u32 s34, s35, 2048
    buffer_load_dwordx4 v13, s[12:15], s34 offen lds
    s_add_u32 m0, s29, 94208
    s_add_u32 s34, s35, 98304
    buffer_load_dwordx4 v13, s[12:15], s34 offen lds
    s_add_u32 m0, s29, 102400
    s_add_u32 s34, s35, 99328
    buffer_load_dwordx4 v13, s[12:15], s34 offen lds
    s_add_u32 m0, s29, 110592
    s_add_u32 s34, s35, 100352
    buffer_load_dwordx4 v13, s[12:15], s34 offen lds
    v_lshlrev_b32 v3, 4, v2
    v_and_b32 v4, 31, v2
    v_lshrrev_b32 v5, 5, v2
    v_and_b32 v6, 15, v2
    v_lshrrev_b32 v7, 4, v2
    v_bfe_u32 v8, v2, 2, 2
    v_and_b32 v9, 3, v2
    v_lshlrev_b32 v1, 3, v2
    s_lshl_b32 s25, s23, 2
    s_add_u32 s70, s25, s69
    s_lshl_b32 s3, s21, 21
    s_add_u32 s3, s3, 8388608
    s_mul_i32 s66, s21, 917504
    s_mul_i32 s67, s23, 229376
    s_add_u32 s67, s67, s66
    s_cmp_gt_u32 s20, 3
    s_subb_u32 s4, s20, 0
    s_mul_i32 s5, s24, 229376
    s_mul_i32 s26, s20, 28672
    s_add_u32 s5, s5, s26
    s_add_u32 s5, s5, 28573696
    s_mov_b32 s62, 0xbdd2d3e8
    s_mov_b32 s63, 0xbdd2d3e8
    s_mov_b32 s64, 1.0
    s_mov_b32 s65, 1.0
    s_mov_b32 s8, s56
    s_mov_b32 s9, s57
    s_mov_b32 s10, 0x1e00000
    s_mov_b32 s11, 0x20000
    v_and_b32 v10, 1, v7
    v_lshrrev_b32 v11, 1, v8
    v_lshl_add_u32 v11, v11, 1, v10
    v_lshl_add_u32 v10, v7, 2, v8
    v_lshlrev_b32 v10, 7, v10
    v_lshl_add_u32 v10, v9, 3, v10
    s_mul_i32 s26, s69, 3
    s_add_u32 s26, s26, 0
    s_and_b32 s27, s26, 3
    s_lshr_b32 s26, s26, 2
    s_lshl_b32 s26, s26, 13
    s_add_u32 s26, s26, 65536
    v_xor_b32 v40, s27, v11
    v_lshl_add_u32 v40, v40, 5, v10
    v_add_u32 v14, s26, v40
    s_mul_i32 s26, s69, 3
    s_add_u32 s26, s26, 1
    s_and_b32 s27, s26, 3
    s_lshr_b32 s26, s26, 2
    s_lshl_b32 s26, s26, 13
    s_add_u32 s26, s26, 65536
    v_xor_b32 v40, s27, v11
    v_lshl_add_u32 v40, v40, 5, v10
    v_add_u32 v15, s26, v40
    s_mul_i32 s26, s69, 3
    s_add_u32 s26, s26, 2
    s_and_b32 s27, s26, 3
    s_lshr_b32 s26, s26, 2
    s_lshl_b32 s26, s26, 13
    s_add_u32 s26, s26, 65536
    v_xor_b32 v40, s27, v11
    v_lshl_add_u32 v40, v40, 5, v10
    v_add_u32 v16, s26, v40
    s_lshl_b32 s26, s69, 11
    v_lshlrev_b32 v10, 7, v6
    v_bfe_u32 v11, v6, 1, 3
    v_xor_b32 v11, v11, v7
    v_lshl_add_u32 v10, v11, 4, v10
    v_add_u32 v17, s26, v10
    v_xor_b32 v41, 64, v17
    v_mov_b32 v18, 0x3f803f80
    v_mov_b32 v19, 0x3f803f80
    v_mov_b32 v96, 0x3f803f80
    v_mov_b32 v97, 0x3f803f80
    v_mov_b32 v98, 0x3f803f80
    v_mov_b32 v99, 0x3f803f80
    s_mul_i32 s26, s69, 192
    s_add_u32 s26, s26, 139264
    v_lshl_add_u32 v100, v7, 4, s26
    s_lshl_b32 s26, s69, 6
    s_add_u32 s26, s26, 140288
    v_lshl_add_u32 v101, v6, 2, s26
    v_cmp_eq_u32 s[42:43], 1, v9
    v_cmp_eq_u32 s[6:7], 2, v9
    s_mul_i32 s26, s69, 192
    s_add_u32 s26, s26, 139264
    v_add_u32 v112, s26, v1
    s_lshl_b32 s75, s21, 16
    s_mul_i32 s26, s69, 384
    s_add_u32 s75, s75, s26
    s_add_u32 s75, s75, 30801920
    s_lshl_b32 s26, s22, 11
    s_add_u32 s74, s75, s26
    s_lshl_b32 s26, s23, 14
    s_add_u32 s75, s75, s26
    v_lshrrev_b32 v111, 3, v2
    v_lshlrev_b32 v111, 11, v111
    v_and_b32 v10, 7, v2
    v_lshl_add_u32 v111, v10, 4, v111
    v_lshlrev_b32 v108, 16, v7
    s_mov_b32 s26, 229376
    v_bfe_u32 v10, v2, 3, 1
    v_mad_u32_u24 v108, v10, s26, v108
    v_and_b32 v10, 7, v2
    v_lshl_add_u32 v108, v10, 7, v108
    s_lshl_b32 s26, s22, 1
    s_lshr_b32 s27, s69, 1
    s_add_u32 s26, s26, s27
    s_lshl_b32 s26, s26, 10
    s_and_b32 s27, s69, 1
    s_mul_i32 s27, s27, 458752
    s_add_u32 s26, s26, s27
    s_add_u32 s26, s26, s66
    v_add_u32 v108, s26, v108
    s_add_u32 s26, s3, 557056
    v_and_b32 v10, 1, v2
    v_lshl_add_u32 v10, v10, 7, s26
    v_cmp_lt_u32 vcc, 47, v2
    s_nop 1
    v_cndmask_b32 v108, v108, v10, vcc
    s_add_u32 s33, s68, 2
    s_and_b32 s33, s33, 7
    s_lshl_b32 s34, s33, 7
    s_add_u32 s34, s34, s28
    s_add_u32 m0, s29, 16384
    s_nop 0
    buffer_load_dwordx4 v12, s[16:19], s34 offen lds
    s_add_u32 m0, s29, 20480
    s_add_u32 s34, s34, 32768
    buffer_load_dwordx4 v12, s[16:19], s34 offen lds
    s_mov_b32 s44, s54
    s_mov_b32 s45, s55
    s_mov_b32 s46, 0x100
    s_mov_b32 s47, 0x20000
    v_lshrrev_b32 v54, 3, v2
    buffer_load_dwordx2 v[104:105], off, s[44:47], 0 sc1
    s_load_dwordx4 s[44:47], s[0:1], 32
    s_waitcnt vmcnt(11)
    s_barrier
    ds_read_b64_tr_b16 v[64:65], v14 offset:0
    ds_read_b64_tr_b16 v[66:67], v14 offset:2048
    ds_read_b64_tr_b16 v[68:69], v14 offset:4096
    ds_read_b64_tr_b16 v[70:71], v14 offset:6144
    ds_read_b64_tr_b16 v[72:73], v15 offset:0
    ds_read_b64_tr_b16 v[74:75], v15 offset:2048
    ds_read_b64_tr_b16 v[76:77], v15 offset:4096
    ds_read_b64_tr_b16 v[78:79], v15 offset:6144
    ds_read_b64_tr_b16 v[80:81], v16 offset:0
    ds_read_b64_tr_b16 v[82:83], v16 offset:2048
    ds_read_b64_tr_b16 v[84:85], v16 offset:4096
    ds_read_b64_tr_b16 v[86:87], v16 offset:6144
    ds_read_b128 v[88:91], v17 offset:0
    ds_read_b128 v[92:95], v41 offset:0
    s_add_u32 s33, s68, 2
    s_and_b32 s33, s33, 7
    s_mul_i32 s35, s33, 196608
    s_add_u32 s35, s35, s31
    s_add_u32 m0, s29, 114688
    s_add_u32 s34, s35, 0
    buffer_load_dwordx4 v13, s[12:15], s34 offen lds
    s_add_u32 m0, s29, 122880
    s_add_u32 s34, s35, 1024
    buffer_load_dwordx4 v13, s[12:15], s34 offen lds
    s_add_u32 m0, s29, 131072
    s_add_u32 s34, s35, 2048
    buffer_load_dwordx4 v13, s[12:15], s34 offen lds
    s_add_u32 m0, s29, 118784
    s_add_u32 s34, s35, 98304
    buffer_load_dwordx4 v13, s[12:15], s34 offen lds
    s_add_u32 m0, s29, 126976
    s_add_u32 s34, s35, 99328
    buffer_load_dwordx4 v13, s[12:15], s34 offen lds
    s_add_u32 m0, s29, 135168
    s_add_u32 s34, s35, 100352
    buffer_load_dwordx4 v13, s[12:15], s34 offen lds
    s_add_u32 s33, s68, 3
    s_and_b32 s33, s33, 7
    s_lshl_b32 s34, s33, 7
    s_add_u32 s34, s34, s28
    s_add_u32 m0, s29, 24576
    s_nop 0
    buffer_load_dwordx4 v12, s[16:19], s34 offen lds
    s_add_u32 m0, s29, 28672
    s_add_u32 s34, s34, 32768
    buffer_load_dwordx4 v12, s[16:19], s34 offen lds
    s_waitcnt lgkmcnt(0)
    v_mfma_f32_16x16x32_bf16 v[20:23], v[64:67], v[96:99], 0
    v_mfma_f32_16x16x32_bf16 v[24:27], v[72:75], v[96:99], 0
    v_mfma_f32_16x16x32_bf16 v[28:31], v[80:83], v[96:99], 0
    v_mfma_f32_16x16x32_bf16 v[20:23], v[68:71], v[96:99], v[20:23]
    v_mfma_f32_16x16x32_bf16 v[24:27], v[76:79], v[96:99], v[24:27]
    v_mfma_f32_16x16x32_bf16 v[28:31], v[84:87], v[96:99], v[28:31]
    v_mfma_f32_16x16x32_bf16 v[32:35], v[96:99], v[88:91], 0
    v_mfma_f32_16x16x32_bf16 v[36:39], v[88:91], v[88:91], 0
    v_mfma_f32_16x16x32_bf16 v[32:35], v[96:99], v[92:95], v[32:35]
    v_mfma_f32_16x16x32_bf16 v[36:39], v[92:95], v[92:95], v[36:39]
    s_nop 1
    ds_write_b128 v100, v[20:23] offset:0
    ds_write_b128 v100, v[24:27] offset:64
    ds_write_b128 v100, v[28:31] offset:128
    ds_read_b64 v[76:77], v112
    s_waitcnt vmcnt(11)
    s_barrier
    ds_read_b128 v[88:91], v17 offset:8192
    ds_read_b128 v[92:95], v41 offset:8192
    s_add_u32 s33, s68, 3
    s_and_b32 s33, s33, 7
    s_mul_i32 s35, s33, 196608
    s_add_u32 s35, s35, s31
    s_add_u32 m0, s29, 65536
    s_add_u32 s34, s35, 0
    buffer_load_dwordx4 v13, s[12:15], s34 offen lds
    s_add_u32 m0, s29, 73728
    s_add_u32 s34, s35, 1024
    buffer_load_dwordx4 v13, s[12:15], s34 offen lds
    s_add_u32 m0, s29, 81920
    s_add_u32 s34, s35, 2048
    buffer_load_dwordx4 v13, s[12:15], s34 offen lds
    s_add_u32 m0, s29, 69632
    s_add_u32 s34, s35, 98304
    buffer_load_dwordx4 v13, s[12:15], s34 offen lds
    s_add_u32 m0, s29, 77824
    s_add_u32 s34, s35, 99328
    buffer_load_dwordx4 v13, s[12:15], s34 offen lds
    s_add_u32 m0, s29, 86016
    s_add_u32 s34, s35, 100352
    buffer_load_dwordx4 v13, s[12:15], s34 offen lds
    s_add_u32 s33, s68, 4
    s_and_b32 s33, s33, 7
    s_lshl_b32 s34, s33, 7
    s_add_u32 s34, s34, s28
    s_add_u32 m0, s29, 32768
    s_nop 0
    buffer_load_dwordx4 v12, s[16:19], s34 offen lds
    s_add_u32 m0, s29, 36864
    s_add_u32 s34, s34, 32768
    buffer_load_dwordx4 v12, s[16:19], s34 offen lds
    s_waitcnt lgkmcnt(0)
    v_mfma_f32_16x16x32_bf16 v[32:35], v[96:99], v[88:91], v[32:35]
    v_mfma_f32_16x16x32_bf16 v[36:39], v[88:91], v[88:91], v[36:39]
    v_mfma_f32_16x16x32_bf16 v[32:35], v[96:99], v[92:95], v[32:35]
    v_mfma_f32_16x16x32_bf16 v[36:39], v[92:95], v[92:95], v[36:39]
    s_waitcnt vmcnt(10)
    s_barrier
    ds_read_b128 v[88:91], v17 offset:16384
    ds_read_b128 v[92:95], v41 offset:16384
    v_readfirstlane_b32 s58, v104
    v_readfirstlane_b32 s59, v105
    s_cmp_lg_u32 s58, 0
    s_cbranch_scc1 L_gn3
    s_mov_b32 s16, s54
    s_mov_b32 s17, s55
    s_mov_b32 s18, 0x100
    s_mov_b32 s19, 0x20000
    s_mov_b32 s60, 0
L_non4:
    buffer_load_dwordx2 v[10:11], off, s[16:19], 0 sc1
    s_add_u32 s60, s60, 1
    s_waitcnt vmcnt(0)
    v_readfirstlane_b32 s58, v10
    v_readfirstlane_b32 s59, v11
    s_cmp_gt_u32 s60, 0x20000
    s_cbranch_scc1 L_nond5
    s_cmp_eq_u32 s58, 0
    s_cbranch_scc1 L_non4
L_nond5:
    s_mov_b32 s16, s36
    s_mov_b32 s17, s37
    s_mov_b32 s18, 0x200000
    s_mov_b32 s19, 0x20000
L_gn3:
    v_mov_b32 v78, s58
    v_mov_b32 v79, s59
    s_mov_b64 exec, 0xffffff
    buffer_store_dwordx4 v[76:79], v3, s[8:11], s74 offen sc1
    s_mov_b64 exec, -1
    s_cmp_lg_u32 s69, 0
    s_cbranch_scc1 L_xp6
    s_getreg_b32 s27, hwreg(HW_REG_XCC_ID)
    s_and_b32 s27, s27, 15
    s_or_b32 s27, s27, s58
    v_mov_b32 v104, s27
    v_mov_b32 v105, s59
    s_lshl_b32 s26, s21, 12
    s_lshl_b32 s27, s22, 7
    s_add_u32 s26, s26, s27
    s_add_u32 s26, s26, 30474240
    s_mov_b64 exec, 1
    buffer_store_dwordx2 v[104:105], off, s[8:11], s26 sc1
    s_mov_b64 exec, -1
L_xp6:
    s_add_u32 s33, s68, 4
    s_and_b32 s33, s33, 7
    s_mul_i32 s35, s33, 196608
    s_add_u32 s35, s35, s31
    s_add_u32 m0, s29, 90112
    s_add_u32 s34, s35, 0
    buffer_load_dwordx4 v13, s[12:15], s34 offen lds
    s_add_u32 m0, s29, 98304
    s_add_u32 s34, s35, 1024
    buffer_load_dwordx4 v13, s[12:15], s34 offen lds
    s_add_u32 m0, s29, 106496
    s_add_u32 s34, s35, 2048
    buffer_load_dwordx4 v13, s[12:15], s34 offen lds
    s_add_u32 m0, s29, 94208
    s_add_u32 s34, s35, 98304
    buffer_load_dwordx4 v13, s[12:15], s34 offen lds
    s_add_u32 m0, s29, 102400
    s_add_u32 s34, s35, 99328
    buffer_load_dwordx4 v13, s[12:15], s34 offen lds
    s_add_u32 m0, s29, 110592
    s_add_u32 s34, s35, 100352
    buffer_load_dwordx4 v13, s[12:15], s34 offen lds
    s_add_u32 s33, s68, 5
    s_and_b32 s33, s33, 7
    s_lshl_b32 s34, s33, 7
    s_add_u32 s34, s34, s28
    s_add_u32 m0, s29, 40960
    s_nop 0
    buffer_load_dwordx4 v12, s[16:19], s34 offen lds
    s_add_u32 m0, s29, 45056
    s_add_u32 s34, s34, 32768
    buffer_load_dwordx4 v12, s[16:19], s34 offen lds
    s_waitcnt lgkmcnt(0)
    v_mfma_f32_16x16x32_bf16 v[32:35], v[96:99], v[88:91], v[32:35]
    v_mfma_f32_16x16x32_bf16 v[36:39], v[88:91], v[88:91], v[36:39]
    v_mfma_f32_16x16x32_bf16 v[32:35], v[96:99], v[92:95], v[32:35]
    v_mfma_f32_16x16x32_bf16 v[36:39], v[92:95], v[92:95], v[36:39]
    s_waitcnt vmcnt(11)
    s_barrier
    ds_read_b128 v[88:91], v17 offset:24576
    ds_read_b128 v[92:95], v41 offset:24576
    s_add_u32 s33, s68, 5
    s_and_b32 s33, s33, 7
    s_mul_i32 s35, s33, 196608
    s_add_u32 s35, s35, s31
    s_add_u32 m0, s29, 114688
    s_add_u32 s34, s35, 0
    buffer_load_dwordx4 v13, s[12:15], s34 offen lds
    s_add_u32 m0, s29, 122880
    s_add_u32 s34, s35, 1024
    buffer_load_dwordx4 v13, s[12:15], s34 offen lds
    s_add_u32 m0, s29, 131072
    s_add_u32 s34, s35, 2048
    buffer_load_dwordx4 v13, s[12:15], s34 offen lds
    s_add_u32 m0, s29, 118784
    s_add_u32 s34, s35, 98304
    buffer_load_dwordx4 v13, s[12:15], s34 offen lds
    s_add_u32 m0, s29, 126976
    s_add_u32 s34, s35, 99328
    buffer_load_dwordx4 v13, s[12:15], s34 offen lds
    s_add_u32 m0, s29, 135168
    s_add_u32 s34, s35, 100352
    buffer_load_dwordx4 v13, s[12:15], s34 offen lds
    s_add_u32 s33, s68, 6
    s_and_b32 s33, s33, 7
    s_lshl_b32 s34, s33, 7
    s_add_u32 s34, s34, s28
    s_add_u32 m0, s29, 49152
    s_nop 0
    buffer_load_dwordx4 v12, s[16:19], s34 offen lds
    s_add_u32 m0, s29, 53248
    s_add_u32 s34, s34, 32768
    buffer_load_dwordx4 v12, s[16:19], s34 offen lds
    s_waitcnt lgkmcnt(0)
    v_mfma_f32_16x16x32_bf16 v[32:35], v[96:99], v[88:91], v[32:35]
    v_mfma_f32_16x16x32_bf16 v[36:39], v[88:91], v[88:91], v[36:39]
    v_mfma_f32_16x16x32_bf16 v[32:35], v[96:99], v[92:95], v[32:35]
    v_mfma_f32_16x16x32_bf16 v[36:39], v[92:95], v[92:95], v[36:39]
    s_waitcnt vmcnt(10)
    s_barrier
    ds_read_b128 v[88:91], v17 offset:32768
    ds_read_b128 v[92:95], v41 offset:32768
    s_add_u32 s33, s68, 6
    s_and_b32 s33, s33, 7
    s_mul_i32 s35, s33, 196608
    s_add_u32 s35, s35, s31
    s_add_u32 m0, s29, 65536
    s_add_u32 s34, s35, 0
    buffer_load_dwordx4 v13, s[12:15], s34 offen lds
    s_add_u32 m0, s29, 73728
    s_add_u32 s34, s35, 1024
    buffer_load_dwordx4 v13, s[12:15], s34 offen lds
    s_add_u32 m0, s29, 81920
    s_add_u32 s34, s35, 2048
    buffer_load_dwordx4 v13, s[12:15], s34 offen lds
    s_add_u32 m0, s29, 69632
    s_add_u32 s34, s35, 98304
    buffer_load_dwordx4 v13, s[12:15], s34 offen lds
    s_add_u32 m0, s29, 77824
    s_add_u32 s34, s35, 99328
    buffer_load_dwordx4 v13, s[12:15], s34 offen lds
    s_add_u32 m0, s29, 86016
    s_add_u32 s34, s35, 100352
    buffer_load_dwordx4 v13, s[12:15], s34 offen lds
    s_add_u32 s33, s68, 7
    s_and_b32 s33, s33, 7
    s_lshl_b32 s34, s33, 7
    s_add_u32 s34, s34, s28
    s_add_u32 m0, s29, 57344
    s_nop 0
    buffer_load_dwordx4 v12, s[16:19], s34 offen lds
    s_add_u32 m0, s29, 61440
    s_add_u32 s34, s34, 32768
    buffer_load_dwordx4 v12, s[16:19], s34 offen lds
    s_waitcnt lgkmcnt(0)
    v_mfma_f32_16x16x32_bf16 v[32:35], v[96:99], v[88:91], v[32:35]
    v_mfma_f32_16x16x32_bf16 v[36:39], v[88:91], v[88:91], v[36:39]
    v_mfma_f32_16x16x32_bf16 v[32:35], v[96:99], v[92:95], v[32:35]
    v_mfma_f32_16x16x32_bf16 v[36:39], v[92:95], v[92:95], v[36:39]
    s_waitcnt vmcnt(10)
    s_barrier
    ds_read_b128 v[88:91], v17 offset:40960
    ds_read_b128 v[92:95], v41 offset:40960
    s_mov_b32 exec_hi, 0
    s_lshl_b32 s26, s21, 12
    s_add_u32 s26, s26, 30474240
    v_lshlrev_b32 v109, 7, v4
    buffer_load_dwordx2 v[106:107], v109, s[8:11], s26 offen sc1
    s_mov_b32 exec_hi, -1
    s_add_u32 s33, s68, 7
    s_and_b32 s33, s33, 7
    s_mul_i32 s35, s33, 196608
    s_add_u32 s35, s35, s31
    s_add_u32 m0, s29, 90112
    s_add_u32 s34, s35, 0
    buffer_load_dwordx4 v13, s[12:15], s34 offen lds
    s_add_u32 m0, s29, 98304
    s_add_u32 s34, s35, 1024
    buffer_load_dwordx4 v13, s[12:15], s34 offen lds
    s_add_u32 m0, s29, 106496
    s_add_u32 s34, s35, 2048
    buffer_load_dwordx4 v13, s[12:15], s34 offen lds
    s_add_u32 m0, s29, 94208
    s_add_u32 s34, s35, 98304
    buffer_load_dwordx4 v13, s[12:15], s34 offen lds
    s_add_u32 m0, s29, 102400
    s_add_u32 s34, s35, 99328
    buffer_load_dwordx4 v13, s[12:15], s34 offen lds
    s_add_u32 m0, s29, 110592
    s_add_u32 s34, s35, 100352
    buffer_load_dwordx4 v13, s[12:15], s34 offen lds
    buffer_load_dwordx4 v[64:67], v111, s[8:11], s75 offen offset:0 sc1
    buffer_load_dwordx4 v[68:71], v111, s[8:11], s75 offen offset:128 sc1
    buffer_load_dwordx4 v[72:75], v111, s[8:11], s75 offen offset:256 sc1
    s_waitcnt lgkmcnt(0)
    v_mfma_f32_16x16x32_bf16 v[32:35], v[96:99], v[88:91], v[32:35]
    v_mfma_f32_16x16x32_bf16 v[36:39], v[88:91], v[88:91], v[36:39]
    v_mfma_f32_16x16x32_bf16 v[32:35], v[96:99], v[92:95], v[32:35]
    v_mfma_f32_16x16x32_bf16 v[36:39], v[92:95], v[92:95], v[36:39]
    s_waitcnt vmcnt(12)
    s_barrier
    ds_read_b128 v[88:91], v17 offset:49152
    ds_read_b128 v[92:95], v41 offset:49152
    s_waitcnt lgkmcnt(0)
    v_mfma_f32_16x16x32_bf16 v[32:35], v[96:99], v[88:91], v[32:35]
    v_mfma_f32_16x16x32_bf16 v[36:39], v[88:91], v[88:91], v[36:39]
    v_mfma_f32_16x16x32_bf16 v[32:35], v[96:99], v[92:95], v[32:35]
    v_mfma_f32_16x16x32_bf16 v[36:39], v[92:95], v[92:95], v[36:39]
    buffer_load_dword v110, v108, s[8:11], 0 offen sc1
    s_waitcnt vmcnt(4)
    s_barrier
    ds_read_b128 v[88:91], v17 offset:57344
    ds_read_b128 v[92:95], v41 offset:57344
    s_waitcnt lgkmcnt(0)
    v_mfma_f32_16x16x32_bf16 v[32:35], v[96:99], v[88:91], v[32:35]
    v_mfma_f32_16x16x32_bf16 v[36:39], v[88:91], v[88:91], v[36:39]
    v_mfma_f32_16x16x32_bf16 v[32:35], v[96:99], v[92:95], v[32:35]
    v_mfma_f32_16x16x32_bf16 v[36:39], v[92:95], v[92:95], v[36:39]
    v_cmp_eq_u32 vcc, 3, v9
    s_nop 5
    v_mul_f32 v32, 0xbb000000, v32
    v_cndmask_b32 v36, v36, v37, s[42:43]
    v_cndmask_b32 v36, v36, v38, s[6:7]
    v_cndmask_b32 v36, v36, v39, vcc
    v_mul_f32 v36, 0x3b000000, v36
    v_fma_f32 v36, -v32, v32, v36
    v_max_f32 v36, 0, v36
    v_add_f32 v36, 0x3727c5ac, v36
    v_rsq_f32 v36, v36
    s_mov_b32 exec_lo, 0x00f0000f
    s_mov_b32 exec_hi, 0xf0000f00
    v_mul_f32 v32, v32, v36
    ds_write_b32 v101, v36 offset:256
    ds_write_b32 v101, v32
    s_mov_b64 exec, -1
    s_waitcnt vmcnt(1)
    s_mov_b32 s60, 0
L_gr7:
    v_cmp_ne_u64 vcc, s[58:59], v[66:67]
    v_cmp_ne_u64 s[32:33], s[58:59], v[70:71]
    v_cmp_ne_u64 s[34:35], s[58:59], v[74:75]
    s_or_b64 vcc, vcc, s[32:33]
    s_or_b64 vcc, vcc, s[34:35]
    s_cbranch_vccz L_go8
    s_add_u32 s60, s60, 1
    s_cmp_gt_u32 s60, 0x20000
    s_cbranch_scc1 L_go8
    buffer_load_dwordx4 v[64:67], v111, s[8:11], s75 offen offset:0 sc1
    buffer_load_dwordx4 v[68:71], v111, s[8:11], s75 offen offset:128 sc1
    buffer_load_dwordx4 v[72:75], v111, s[8:11], s75 offen offset:256 sc1
    s_waitcnt vmcnt(0)
    s_branch L_gr7
L_go8:
    v_add_f32_dpp v64, v64, v64 row_ror:8 row_mask:0xf bank_mask:0xf
    v_add_f32_dpp v65, v65, v65 row_ror:8 row_mask:0xf bank_mask:0xf
    v_add_f32_dpp v68, v68, v68 row_ror:8 row_mask:0xf bank_mask:0xf
    v_add_f32_dpp v69, v69, v69 row_ror:8 row_mask:0xf bank_mask:0xf
    v_add_f32_dpp v72, v72, v72 row_ror:8 row_mask:0xf bank_mask:0xf
    v_add_f32_dpp v73, v73, v73 row_ror:8 row_mask:0xf bank_mask:0xf
    v_mov_b32 v66, v64
    v_mov_b32 v67, v65
    v_mov_b32 v70, v68
    v_mov_b32 v71, v69
    v_mov_b32 v74, v72
    v_mov_b32 v75, v73
    v_permlane16_swap_b32 v64, v66
    v_permlane16_swap_b32 v65, v67
    v_permlane16_swap_b32 v68, v70
    v_permlane16_swap_b32 v69, v71
    v_permlane16_swap_b32 v72, v74
    v_permlane16_swap_b32 v73, v75
    v_add_f32 v64, v64, v66
    v_add_f32 v65, v65, v67
    v_add_f32 v68, v68, v70
    v_add_f32 v69, v69, v71
    v_add_f32 v72, v72, v74
    v_add_f32 v73, v73, v75
    v_mov_b32 v66, v64
    v_mov_b32 v67, v65
    v_mov_b32 v70, v68
    v_mov_b32 v71, v69
    v_mov_b32 v74, v72
    v_mov_b32 v75, v73
    v_permlane32_swap_b32 v64, v66
    v_permlane32_swap_b32 v65, v67
    v_permlane32_swap_b32 v68, v70
    v_permlane32_swap_b32 v69, v71
    v_permlane32_swap_b32 v72, v74
    v_permlane32_swap_b32 v73, v75
    v_add_f32 v64, v64, v66
    v_add_f32 v65, v65, v67
    v_add_f32 v68, v68, v70
    v_add_f32 v69, v69, v71
    v_add_f32 v72, v72, v74
    v_add_f32 v73, v73, v75
    s_mov_b64 exec, 0xff
    ds_write_b64 v112, v[64:65] offset:0
    ds_write_b64 v112, v[68:69] offset:64
    ds_write_b64 v112, v[72:73] offset:128
    s_mov_b64 exec, -1
    s_cmp_lg_u32 s69, 0
    s_cbranch_scc1 L_nw9
    s_mov_b32 s60, 0
    s_mov_b32 exec_hi, 0
L_xr10:
    v_and_b32 v10, -16, v106
    v_mov_b32 v11, v107
    v_cmp_ne_u64 vcc, s[58:59], v[10:11]
    s_cbranch_vccz L_xo11
    s_add_u32 s60, s60, 1
    s_cmp_gt_u32 s60, 64
    s_cbranch_scc1 L_xo11
    s_lshl_b32 s26, s21, 12
    s_add_u32 s26, s26, 30474240
    v_lshlrev_b32 v109, 7, v4
    buffer_load_dwordx2 v[106:107], v109, s[8:11], s26 offen sc1
    s_waitcnt vmcnt(0)
    s_branch L_xr10
L_xo11:
    s_getreg_b32 s34, hwreg(HW_REG_XCC_ID)
    s_and_b32 s34, s34, 15
    s_or_b32 s34, s34, s58
    s_mov_b32 s35, s59
    v_cmp_ne_u64 vcc, s[34:35], v[106:107]
    s_nop 0
    s_cmp_eq_u64 vcc, 0
    s_cselect_b32 s61, 1, 0
    s_cmp_eq_u32 s58, 0
    s_cselect_b32 s61, 0, s61
    s_mov_b32 exec_hi, -1
    v_mov_b32 v104, s58
    v_mov_b32 v105, s59
    v_mov_b32 v106, s61
    v_mov_b32 v10, 140800
    ds_write_b128 v10, v[104:107]
L_nw9:
    s_waitcnt lgkmcnt(0)
    s_barrier
    v_and_b32 v10, 1, v7
    v_lshrrev_b32 v11, 1, v8
    v_lshl_add_u32 v11, v11, 1, v10
    v_lshl_add_u32 v56, v10, 2, v8
    v_lshrrev_b32 v57, 1, v7
    v_lshl_add_u32 v58, v57, 4, v56
    v_lshl_add_u32 v59, v57, 3, v56
    v_xor_b32 v60, 0, v11
    v_lshlrev_b32 v60, 5, v60
    v_lshl_add_u32 v60, v9, 3, v60
    v_lshl_add_u32 v44, v58, 7, v60
    v_xor_b32 v60, 1, v11
    v_lshlrev_b32 v60, 5, v60
    v_lshl_add_u32 v60, v9, 3, v60
    v_lshl_add_u32 v45, v58, 7, v60
    v_xor_b32 v60, 2, v11
    v_lshlrev_b32 v60, 5, v60
    v_lshl_add_u32 v60, v9, 3, v60
    v_lshl_add_u32 v46, v58, 7, v60
    v_xor_b32 v60, 3, v11
    v_lshlrev_b32 v60, 5, v60
    v_lshl_add_u32 v60, v9, 3, v60
    v_lshl_add_u32 v47, v58, 7, v60
    v_xor_b32 v60, 0, v11
    v_lshlrev_b32 v60, 5, v60
    v_lshl_add_u32 v60, v9, 3, v60
    v_lshl_add_u32 v48, v59, 7, v60
    v_xor_b32 v60, 1, v11
    v_lshlrev_b32 v60, 5, v60
    v_lshl_add_u32 v60, v9, 3, v60
    v_lshl_add_u32 v49, v59, 7, v60
    v_xor_b32 v60, 2, v11
    v_lshlrev_b32 v60, 5, v60
    v_lshl_add_u32 v60, v9, 3, v60
    v_lshl_add_u32 v50, v59, 7, v60
    v_xor_b32 v60, 3, v11
    v_lshlrev_b32 v60, 5, v60
    v_lshl_add_u32 v60, v9, 3, v60
    v_lshl_add_u32 v51, v59, 7, v60
    v_lshrrev_b32 v11, 1, v8
    v_lshl_add_u32 v11, v11, 1, v5
    v_lshl_add_u32 v56, v5, 2, v8
    v_lshlrev_b32 v56, 7, v56
    v_lshl_add_u32 v56, v9, 3, v56
    v_add_u32 v60, 0, v10
    v_xor_b32 v60, v60, v11
    v_lshl_add_u32 v52, v60, 5, v56
    v_add_u32 v60, 2, v10
    v_xor_b32 v60, v60, v11
    v_lshl_add_u32 v53, v60, 5, v56
    v_lshrrev_b32 v54, 3, v2
    v_mov_b32 v10, 140800
    ds_read_b32 v25, v10 offset:8
    v_lshlrev_b32 v12, 7, v2
    s_lshr_b32 s26, s69, 1
    s_mul_i32 s26, s26, 114688
    s_mul_i32 s27, s24, 14336
    s_add_u32 s26, s26, s27
    s_and_b32 s27, s69, 1
    s_mul_i32 s27, s27, 7168
    s_add_u32 s26, s26, s27
    s_add_u32 s26, s26, s67
    v_min_u32 v14, 7040, v12
    v_add_u32 v14, s26, v14
    s_lshl_b32 s28, s70, 14
    s_lshl_b32 s27, s24, 11
    s_add_u32 s28, s28, s27
    s_add_u32 s28, s28, s3
    s_add_u32 s28, s28, 262144
    v_add_u32 v17, s28, v12
    s_lshl_b32 s27, s22, 2
    s_add_u32 s27, s27, s69
    s_mul_i32 s27, s27, 384
    s_add_u32 s27, s27, s3
    s_add_u32 s27, s27, 522240
    v_add_u32 v24, s27, v12
    v_cmp_lt_u32 vcc, 15, v2
    s_nop 1
    v_cndmask_b32 v17, v17, v24, vcc
    s_mul_i32 s26, s70, 3
    s_add_u32 s26, s26, 0
    s_min_u32 s26, s26, 41
    s_mul_hi_u32 s27, s26, 0x2aaaaaab
    s_lshl_b32 s27, s27, 1
    s_add_u32 s26, s26, s27
    s_add_u32 s26, s26, 2
    s_lshl_b32 s26, s26, 12
    s_mul_i32 s27, s24, 229376
    s_add_u32 s26, s26, s27
    s_add_u32 s26, s26, 26738688
    v_lshl_add_u32 v15, v4, 7, s26
    s_mul_i32 s26, s70, 3
    s_add_u32 s26, s26, 1
    s_min_u32 s26, s26, 41
    s_mul_hi_u32 s27, s26, 0x2aaaaaab
    s_lshl_b32 s27, s27, 1
    s_add_u32 s26, s26, s27
    s_add_u32 s26, s26, 2
    s_lshl_b32 s26, s26, 12
    s_mul_i32 s27, s24, 229376
    s_add_u32 s26, s26, s27
    s_add_u32 s26, s26, 26738688
    v_lshl_add_u32 v24, v4, 7, s26
    s_mul_i32 s26, s70, 3
    s_add_u32 s26, s26, 2
    s_min_u32 s26, s26, 41
    s_mul_hi_u32 s27, s26, 0x2aaaaaab
    s_lshl_b32 s27, s27, 1
    s_add_u32 s26, s26, s27
    s_add_u32 s26, s26, 2
    s_lshl_b32 s26, s26, 12
    s_mul_i32 s27, s24, 229376
    s_add_u32 s26, s26, s27
    s_add_u32 s26, s26, 26738688
    v_lshl_add_u32 v16, v4, 7, s26
    v_cmp_lt_u32 vcc, 31, v2
    s_nop 1
    v_cndmask_b32 v15, v15, v24, vcc
    s_mul_i32 s26, s24, 229376
    s_mul_i32 s27, s69, 28672
    s_add_u32 s26, s26, s27
    s_lshl_b32 s27, s23, 12
    s_add_u32 s26, s26, s27
    s_add_u32 s26, s26, 28577792
    v_lshl_add_u32 v24, v4, 7, s26
    v_cndmask_b32 v16, v16, v24, vcc
    s_waitcnt lgkmcnt(0)
    v_readfirstlane_b32 s61, v25
    v_and_b32 v10, 23, v2
    v_cmp_eq_u32 vcc, 0, v10
    v_mov_b32 v10, 0x3f803f80
    s_nop 0
    v_cndmask_b32 v20, 0, v10, vcc
    v_mov_b32 v21, v20
    v_mov_b32 v22, v20
    v_mov_b32 v23, v20
    v_add_u32 v24, s29, v3
    s_add_u32 s6, s67, s29
    s_add_u32 s6, s6, 0x10000
    s_add_u32 s27, s3, 557056
    s_mov_b32 s30, -1
    s_mov_b32 s31, 0
    s_barrier
    ds_write_b128 v24, v[20:23] offset:28672
    s_mov_b64 exec, s[30:31]
    s_mov_b32 s60, 0
L_poll12:
    buffer_load_dwordx2 v[10:11], v1, s[8:11], s27 offen sc1
    s_add_u32 s60, s60, 1
    s_cmp_gt_u32 s60, 0x20000
    s_waitcnt vmcnt(0)
    s_cbranch_scc1 L_polld13
    v_cmp_ne_u64 vcc, s[58:59], v[10:11]
    s_cbranch_vccnz L_poll12
L_polld13:
    s_mov_b64 exec, -1
    s_add_u32 m0, s29, 32768
    s_add_u32 s30, s6, 0
    buffer_load_dwordx4 v3, s[8:11], s30 offen sc1 lds
    s_add_u32 m0, s29, 36864
    s_add_u32 s30, s6, 65536
    buffer_load_dwordx4 v3, s[8:11], s30 offen sc1 lds
    s_add_u32 m0, s29, 40960
    s_add_u32 s30, s6, 4096
    buffer_load_dwordx4 v3, s[8:11], s30 offen sc1 lds
    s_add_u32 m0, s29, 45056
    s_add_u32 s30, s6, 69632
    buffer_load_dwordx4 v3, s[8:11], s30 offen sc1 lds
    s_waitcnt vmcnt(0) lgkmcnt(0)
    s_barrier
    s_add_u32 m0, s29, 49152
    s_add_u32 s30, s6, 8192
    buffer_load_dwordx4 v3, s[8:11], s30 offen sc1 lds
    s_add_u32 m0, s29, 53248
    s_add_u32 s30, s6, 73728
    buffer_load_dwordx4 v3, s[8:11], s30 offen sc1 lds
    s_add_u32 m0, s29, 57344
    s_add_u32 s30, s6, 12288
    buffer_load_dwordx4 v3, s[8:11], s30 offen sc1 lds
    s_add_u32 m0, s29, 61440
    s_add_u32 s30, s6, 77824
    buffer_load_dwordx4 v3, s[8:11], s30 offen sc1 lds
    s_waitcnt vmcnt(0)
    v_mov_b32 v10, 28772
    v_mov_b32 v11, 1
    s_mov_b64 exec, 1
    ds_add_u32 v10, v11 offset:0
    s_mov_b64 exec, -1
    s_mul_i32 s72, s2, 5
    s_add_u32 s72, s72, s69
    s_mov_b32 s15, 0x20000
    s_cmp_ge_u32 s72, 832
    s_cbranch_scc1 L_u415
    s_cmp_ge_u32 s72, 384
    s_cbranch_scc1 L_u314
    s_lshr_b32 s32, s72, 7
    s_bfe_u32 s33, s72, 0x40003
    s_and_b32 s34, s72, 7
    s_lshl_b32 s27, s33, 15
    s_lshl_b32 s35, s34, 7
    s_add_u32 s27, s27, s35
    s_lshl_b32 s28, s32, 19
    s_lshl_b32 s35, s34, 16
    s_add_u32 s28, s28, s35
    s_lshl_b32 s35, s33, 12
    s_add_u32 s28, s28, s35
    s_add_u32 s28, s28, 25165824
    s_min_u32 s26, s32, 1
    s_cmp_eq_u32 s32, 1
    s_cselect_b64 s[12:13], s[44:45], s[46:47]
    s_cmp_eq_u32 s32, 0
    s_cselect_b64 s[12:13], s[40:41], s[12:13]
    s_mov_b32 s14, 0x80000
    s_branch L_ud16
L_u314:
    s_sub_u32 s32, s72, 384
    s_mul_hi_u32 s33, s32, 0x0924924a
    s_mul_i32 s34, s33, 28
    s_sub_u32 s34, s32, s34
    s_mul_i32 s27, s33, 114688
    s_lshl_b32 s35, s34, 7
    s_add_u32 s27, s27, s35
    s_lshl_b32 s28, s34, 16
    s_lshl_b32 s35, s33, 11
    s_add_u32 s28, s28, s35
    s_add_u32 s28, s28, 26738688
    s_mov_b32 s26, 2
    s_mov_b64 s[12:13], s[48:49]
    s_mov_b32 s14, 0x1c0000
    s_branch L_ud16
L_u415:
    s_sub_u32 s32, s72, 832
    s_lshr_b32 s33, s32, 3
    s_and_b32 s34, s32, 7
    s_lshl_b32 s27, s33, 15
    s_lshl_b32 s35, s34, 7
    s_add_u32 s27, s27, s35
    s_mul_i32 s28, s34, 229376
    s_lshl_b32 s35, s33, 12
    s_add_u32 s28, s28, s35
    s_add_u32 s28, s28, 28573696
    s_mov_b32 s26, 3
    s_mov_b64 s[12:13], s[50:51]
    s_mov_b32 s14, 0x1c0000
L_ud16:
    s_cmp_eq_u32 s26, 2
    s_movk_i32 s32, 0x400
    s_cselect_b32 s32, 0xe00, s32
    v_mad_u32_u24 v60, v54, s32, v55
    s_lshl_b32 s32, s32, 3
    s_lshl_b32 s35, s69, 12
    s_add_u32 m0, s35, 0
    s_nop 0
    buffer_load_dwordx4 v60, s[12:15], s27 offen lds
    s_add_u32 m0, s35, 1024
    s_add_u32 s27, s27, s32
    buffer_load_dwordx4 v60, s[12:15], s27 offen lds
    s_add_u32 m0, s35, 2048
    s_add_u32 s27, s27, s32
    buffer_load_dwordx4 v60, s[12:15], s27 offen lds
    s_add_u32 m0, s35, 3072
    s_add_u32 s27, s27, s32
    buffer_load_dwordx4 v60, s[12:15], s27 offen lds
    s_cmp_lg_u32 s69, 3
    s_cbranch_scc1 L_u417
    s_mul_i32 s72, s2, 5
    s_add_u32 s72, s72, 4
    s_mov_b32 s15, 0x20000
    s_cmp_ge_u32 s72, 832
    s_cbranch_scc1 L_u419
    s_cmp_ge_u32 s72, 384
    s_cbranch_scc1 L_u318
    s_lshr_b32 s32, s72, 7
    s_bfe_u32 s33, s72, 0x40003
    s_and_b32 s34, s72, 7
    s_lshl_b32 s27, s33, 15
    s_lshl_b32 s35, s34, 7
    s_add_u32 s27, s27, s35
    s_lshl_b32 s28, s32, 19
    s_lshl_b32 s35, s34, 16
    s_add_u32 s28, s28, s35
    s_lshl_b32 s35, s33, 12
    s_add_u32 s28, s28, s35
    s_add_u32 s28, s28, 25165824
    s_min_u32 s26, s32, 1
    s_cmp_eq_u32 s32, 1
    s_cselect_b64 s[12:13], s[44:45], s[46:47]
    s_cmp_eq_u32 s32, 0
    s_cselect_b64 s[12:13], s[40:41], s[12:13]
    s_mov_b32 s14, 0x80000
    s_branch L_ud20
L_u318:
    s_sub_u32 s32, s72, 384
    s_mul_hi_u32 s33, s32, 0x0924924a
    s_mul_i32 s34, s33, 28
    s_sub_u32 s34, s32, s34
    s_mul_i32 s27, s33, 114688
    s_lshl_b32 s35, s34, 7
    s_add_u32 s27, s27, s35
    s_lshl_b32 s28, s34, 16
    s_lshl_b32 s35, s33, 11
    s_add_u32 s28, s28, s35
    s_add_u32 s28, s28, 26738688
    s_mov_b32 s26, 2
    s_mov_b64 s[12:13], s[48:49]
    s_mov_b32 s14, 0x1c0000
    s_branch L_ud20
L_u419:
    s_sub_u32 s32, s72, 832
    s_lshr_b32 s33, s32, 3
    s_and_b32 s34, s32, 7
    s_lshl_b32 s27, s33, 15
    s_lshl_b32 s35, s34, 7
    s_add_u32 s27, s27, s35
    s_mul_i32 s28, s34, 229376
    s_lshl_b32 s35, s33, 12
    s_add_u32 s28, s28, s35
    s_add_u32 s28, s28, 28573696
    s_mov_b32 s26, 3
    s_mov_b64 s[12:13], s[50:51]
    s_mov_b32 s14, 0x1c0000
L_ud20:
    s_cmp_eq_u32 s26, 2
    s_movk_i32 s32, 0x400
    s_cselect_b32 s32, 0xe00, s32
    v_mad_u32_u24 v60, v54, s32, v55
    s_lshl_b32 s32, s32, 3
    s_mov_b32 s35, 16384
    s_add_u32 m0, s35, 0
    s_nop 0
    buffer_load_dwordx4 v60, s[12:15], s27 offen lds
    s_add_u32 m0, s35, 1024
    s_add_u32 s27, s27, s32
    buffer_load_dwordx4 v60, s[12:15], s27 offen lds
    s_add_u32 m0, s35, 2048
    s_add_u32 s27, s27, s32
    buffer_load_dwordx4 v60, s[12:15], s27 offen lds
    s_add_u32 m0, s35, 3072
    s_add_u32 s27, s27, s32
    buffer_load_dwordx4 v60, s[12:15], s27 offen lds
L_u417:
    s_add_u32 m0, s29, 65536
    s_add_u32 s30, s6, 16384
    buffer_load_dwordx4 v3, s[8:11], s30 offen sc1 lds
    s_add_u32 m0, s29, 69632
    s_add_u32 s30, s6, 81920
    buffer_load_dwordx4 v3, s[8:11], s30 offen sc1 lds
    s_add_u32 m0, s29, 73728
    s_add_u32 s30, s6, 20480
    buffer_load_dwordx4 v3, s[8:11], s30 offen sc1 lds
    s_add_u32 m0, s29, 77824
    s_add_u32 s30, s6, 86016
    buffer_load_dwordx4 v3, s[8:11], s30 offen sc1 lds
    s_add_u32 m0, s29, 81920
    s_add_u32 s30, s6, 24576
    buffer_load_dwordx4 v3, s[8:11], s30 offen sc1 lds
    s_add_u32 m0, s29, 86016
    s_add_u32 s30, s6, 90112
    buffer_load_dwordx4 v3, s[8:11], s30 offen sc1 lds
    s_add_u32 m0, s29, 90112
    s_add_u32 s30, s6, 28672
    buffer_load_dwordx4 v3, s[8:11], s30 offen sc1 lds
    s_add_u32 m0, s29, 94208
    s_add_u32 s30, s6, 94208
    buffer_load_dwordx4 v3, s[8:11], s30 offen sc1 lds
    s_add_u32 m0, s29, 98304
    s_add_u32 s30, s6, 32768
    buffer_load_dwordx4 v3, s[8:11], s30 offen sc1 lds
    s_add_u32 m0, s29, 102400
    s_add_u32 s30, s6, 98304
    buffer_load_dwordx4 v3, s[8:11], s30 offen sc1 lds
    s_add_u32 m0, s29, 106496
    s_add_u32 s30, s6, 36864
    buffer_load_dwordx4 v3, s[8:11], s30 offen sc1 lds
    s_add_u32 m0, s29, 110592
    s_add_u32 s30, s6, 102400
    buffer_load_dwordx4 v3, s[8:11], s30 offen sc1 lds
    s_add_u32 m0, s29, 114688
    s_add_u32 s30, s6, 40960
    buffer_load_dwordx4 v3, s[8:11], s30 offen sc1 lds
    s_add_u32 m0, s29, 118784
    s_add_u32 s30, s6, 106496
    buffer_load_dwordx4 v3, s[8:11], s30 offen sc1 lds
    s_add_u32 m0, s29, 122880
    s_add_u32 s30, s6, 45056
    buffer_load_dwordx4 v3, s[8:11], s30 offen sc1 lds
    s_add_u32 m0, s29, 126976
    s_add_u32 s30, s6, 110592
    buffer_load_dwordx4 v3, s[8:11], s30 offen sc1 lds
    s_add_u32 m0, s29, 131072
    s_add_u32 s30, s6, 49152
    buffer_load_dwordx4 v3, s[8:11], s30 offen sc1 lds
    s_add_u32 m0, s29, 135168
    s_add_u32 s30, s6, 114688
    buffer_load_dwordx4 v3, s[8:11], s30 offen sc1 lds
    s_add_u32 m0, s29, 139264
    s_add_u32 s30, s6, 53248
    buffer_load_dwordx4 v3, s[8:11], s30 offen sc1 lds
    s_add_u32 m0, s29, 143360
    s_add_u32 s30, s6, 118784
    buffer_load_dwordx4 v3, s[8:11], s30 offen sc1 lds
    s_add_u32 m0, s29, 147456
    s_add_u32 s30, s6, 57344
    buffer_load_dwordx4 v3, s[8:11], s30 offen sc1 lds
    s_add_u32 m0, s29, 151552
    s_add_u32 s30, s6, 122880
    buffer_load_dwordx4 v3, s[8:11], s30 offen sc1 lds
    s_add_u32 m0, s29, 155648
    s_add_u32 s30, s6, 61440
    buffer_load_dwordx4 v3, s[8:11], s30 offen sc1 lds
    s_add_u32 m0, s29, 159744
    s_add_u32 s30, s6, 126976
    buffer_load_dwordx4 v3, s[8:11], s30 offen sc1 lds
    s_waitcnt vmcnt(0)
    v_mov_b32 v10, 28772
    v_mov_b32 v11, 1
    s_mov_b64 exec, 1
    ds_add_u32 v10, v11 offset:4
    s_mov_b64 exec, -1
    s_setprio 2
    s_waitcnt vmcnt(0)
    s_mul_i32 s72, s2, 5
    s_add_u32 s72, s72, s69
    s_mov_b32 s15, 0x20000
    s_cmp_ge_u32 s72, 832
    s_cbranch_scc1 L_u422
    s_cmp_ge_u32 s72, 384
    s_cbranch_scc1 L_u321
    s_lshr_b32 s32, s72, 7
    s_bfe_u32 s33, s72, 0x40003
    s_and_b32 s34, s72, 7
    s_lshl_b32 s27, s33, 15
    s_lshl_b32 s35, s34, 7
    s_add_u32 s27, s27, s35
    s_lshl_b32 s28, s32, 19
    s_lshl_b32 s35, s34, 16
    s_add_u32 s28, s28, s35
    s_lshl_b32 s35, s33, 12
    s_add_u32 s28, s28, s35
    s_add_u32 s28, s28, 25165824
    s_min_u32 s26, s32, 1
    s_cmp_eq_u32 s32, 1
    s_cselect_b64 s[12:13], s[44:45], s[46:47]
    s_cmp_eq_u32 s32, 0
    s_cselect_b64 s[12:13], s[40:41], s[12:13]
    s_mov_b32 s14, 0x80000
    s_branch L_ud23
L_u321:
    s_sub_u32 s32, s72, 384
    s_mul_hi_u32 s33, s32, 0x0924924a
    s_mul_i32 s34, s33, 28
    s_sub_u32 s34, s32, s34
    s_mul_i32 s27, s33, 114688
    s_lshl_b32 s35, s34, 7
    s_add_u32 s27, s27, s35
    s_lshl_b32 s28, s34, 16
    s_lshl_b32 s35, s33, 11
    s_add_u32 s28, s28, s35
    s_add_u32 s28, s28, 26738688
    s_mov_b32 s26, 2
    s_mov_b64 s[12:13], s[48:49]
    s_mov_b32 s14, 0x1c0000
    s_branch L_ud23
L_u422:
    s_sub_u32 s32, s72, 832
    s_lshr_b32 s33, s32, 3
    s_and_b32 s34, s32, 7
    s_lshl_b32 s27, s33, 15
    s_lshl_b32 s35, s34, 7
    s_add_u32 s27, s27, s35
    s_mul_i32 s28, s34, 229376
    s_lshl_b32 s35, s33, 12
    s_add_u32 s28, s28, s35
    s_add_u32 s28, s28, 28573696
    s_mov_b32 s26, 3
    s_mov_b64 s[12:13], s[50:51]
    s_mov_b32 s14, 0x1c0000
L_ud23:
    s_lshl_b32 s32, s69, 12
    s_add_u32 s32, s32, 0
    s_cmp_eq_u32 s26, 1
    s_cbranch_scc1 L_k124
    s_cmp_eq_u32 s26, 2
    s_cbranch_scc1 L_k225
    s_cmp_eq_u32 s26, 3
    s_cbranch_scc1 L_k326
    v_add_u32 v60, s32, v44
    v_add_u32 v61, s32, v45
    v_add_u32 v62, s32, v46
    v_add_u32 v63, s32, v47
    ds_read_b64_tr_b16 v[64:65], v60 offset:0
    ds_read_b64_tr_b16 v[66:67], v60 offset:1024
    ds_read_b64_tr_b16 v[68:69], v61 offset:0
    ds_read_b64_tr_b16 v[70:71], v61 offset:1024
    ds_read_b64_tr_b16 v[72:73], v62 offset:0
    ds_read_b64_tr_b16 v[74:75], v62 offset:1024
    ds_read_b64_tr_b16 v[76:77], v63 offset:0
    ds_read_b64_tr_b16 v[78:79], v63 offset:1024
    s_add_u32 s35, s28, 2048
    s_branch L_kd27
L_k124:
    v_add_u32 v60, s32, v48
    v_add_u32 v61, s32, v49
    v_add_u32 v62, s32, v50
    v_add_u32 v63, s32, v51
    ds_read_b64_tr_b16 v[64:65], v60 offset:0
    ds_read_b64_tr_b16 v[66:67], v60 offset:2048
    ds_read_b64_tr_b16 v[68:69], v61 offset:0
    ds_read_b64_tr_b16 v[70:71], v61 offset:2048
    ds_read_b64_tr_b16 v[72:73], v62 offset:0
    ds_read_b64_tr_b16 v[74:75], v62 offset:2048
    ds_read_b64_tr_b16 v[76:77], v63 offset:0
    ds_read_b64_tr_b16 v[78:79], v63 offset:2048
    s_add_u32 s35, s28, 2048
    s_branch L_kd27
L_k225:
    v_add_u32 v60, s32, v52
    v_add_u32 v61, s32, v53
    ds_read_b64_tr_b16 v[64:65], v60 offset:0
    ds_read_b64_tr_b16 v[66:67], v60 offset:2048
    ds_read_b64_tr_b16 v[68:69], v60 offset:1024
    ds_read_b64_tr_b16 v[70:71], v60 offset:3072
    ds_read_b64_tr_b16 v[72:73], v61 offset:0
    ds_read_b64_tr_b16 v[74:75], v61 offset:2048
    ds_read_b64_tr_b16 v[76:77], v61 offset:1024
    ds_read_b64_tr_b16 v[78:79], v61 offset:3072
    s_add_u32 s35, s28, 32768
    s_mul_i32 s33, s33, 7168
    s_lshl_b32 s34, s34, 8
    s_add_u32 s33, s33, s34
    s_add_u32 s33, s33, 30539776
    v_lshlrev_b32 v62, 2, v2
    s_waitcnt lgkmcnt(0)
    v_mfma_f32_4x4x4_16b_bf16 v[80:83], v[18:19], v[64:65], 0
    v_mfma_f32_4x4x4_16b_bf16 v[84:87], v[18:19], v[72:73], 0
    s_nop 0
    v_mfma_f32_4x4x4_16b_bf16 v[80:83], v[18:19], v[66:67], v[80:83]
    v_mfma_f32_4x4x4_16b_bf16 v[84:87], v[18:19], v[74:75], v[84:87]
    s_nop 0
    v_mfma_f32_4x4x4_16b_bf16 v[80:83], v[18:19], v[68:69], v[80:83]
    v_mfma_f32_4x4x4_16b_bf16 v[84:87], v[18:19], v[76:77], v[84:87]
    s_nop 0
    v_mfma_f32_4x4x4_16b_bf16 v[80:83], v[18:19], v[70:71], v[80:83]
    v_mfma_f32_4x4x4_16b_bf16 v[84:87], v[18:19], v[78:79], v[84:87]
    s_nop 4
    v_permlane32_swap_b32 v80, v84
    v_add_f32 v80, v80, v84
    buffer_store_dword v80, v62, s[8:11], s33 offen sc1
    s_branch L_kd27
L_k326:
    v_add_u32 v60, s32, v52
    v_add_u32 v61, s32, v53
    ds_read_b64_tr_b16 v[64:65], v60 offset:0
    ds_read_b64_tr_b16 v[66:67], v60 offset:1024
    ds_read_b64_tr_b16 v[68:69], v61 offset:0
    ds_read_b64_tr_b16 v[70:71], v61 offset:1024
    ds_read_b64_tr_b16 v[72:73], v60 offset:2048
    ds_read_b64_tr_b16 v[74:75], v60 offset:3072
    ds_read_b64_tr_b16 v[76:77], v61 offset:2048
    ds_read_b64_tr_b16 v[78:79], v61 offset:3072
    s_add_u32 s35, s28, 2048
L_kd27:
    s_waitcnt lgkmcnt(0)
    buffer_store_dwordx4 v[64:67], v3, s[8:11], s28 offen sc1
    buffer_store_dwordx4 v[68:71], v3, s[8:11], s28 offen offset:1024 sc1
    buffer_store_dwordx4 v[72:75], v3, s[8:11], s35 offen sc1
    buffer_store_dwordx4 v[76:79], v3, s[8:11], s35 offen offset:1024 sc1
    s_mov_b32 s68, s28
    s_mov_b32 s71, s35
    s_cmp_lg_u32 s69, 3
    s_cbranch_scc1 L_u428
    s_mul_i32 s72, s2, 5
    s_add_u32 s72, s72, 4
    s_mov_b32 s15, 0x20000
    s_cmp_ge_u32 s72, 832
    s_cbranch_scc1 L_u430
    s_cmp_ge_u32 s72, 384
    s_cbranch_scc1 L_u329
    s_lshr_b32 s32, s72, 7
    s_bfe_u32 s33, s72, 0x40003
    s_and_b32 s34, s72, 7
    s_lshl_b32 s27, s33, 15
    s_lshl_b32 s35, s34, 7
    s_add_u32 s27, s27, s35
    s_lshl_b32 s28, s32, 19
    s_lshl_b32 s35, s34, 16
    s_add_u32 s28, s28, s35
    s_lshl_b32 s35, s33, 12
    s_add_u32 s28, s28, s35
    s_add_u32 s28, s28, 25165824
    s_min_u32 s26, s32, 1
    s_cmp_eq_u32 s32, 1
    s_cselect_b64 s[12:13], s[44:45], s[46:47]
    s_cmp_eq_u32 s32, 0
    s_cselect_b64 s[12:13], s[40:41], s[12:13]
    s_mov_b32 s14, 0x80000
    s_branch L_ud31
L_u329:
    s_sub_u32 s32, s72, 384
    s_mul_hi_u32 s33, s32, 0x0924924a
    s_mul_i32 s34, s33, 28
    s_sub_u32 s34, s32, s34
    s_mul_i32 s27, s33, 114688
    s_lshl_b32 s35, s34, 7
    s_add_u32 s27, s27, s35
    s_lshl_b32 s28, s34, 16
    s_lshl_b32 s35, s33, 11
    s_add_u32 s28, s28, s35
    s_add_u32 s28, s28, 26738688
    s_mov_b32 s26, 2
    s_mov_b64 s[12:13], s[48:49]
    s_mov_b32 s14, 0x1c0000
    s_branch L_ud31
L_u430:
    s_sub_u32 s32, s72, 832
    s_lshr_b32 s33, s32, 3
    s_and_b32 s34, s32, 7
    s_lshl_b32 s27, s33, 15
    s_lshl_b32 s35, s34, 7
    s_add_u32 s27, s27, s35
    s_mul_i32 s28, s34, 229376
    s_lshl_b32 s35, s33, 12
    s_add_u32 s28, s28, s35
    s_add_u32 s28, s28, 28573696
    s_mov_b32 s26, 3
    s_mov_b64 s[12:13], s[50:51]
    s_mov_b32 s14, 0x1c0000
L_ud31:
    s_mov_b32 s32, 16384
    s_cmp_eq_u32 s26, 1
    s_cbranch_scc1 L_k132
    s_cmp_eq_u32 s26, 2
    s_cbranch_scc1 L_k233
    s_cmp_eq_u32 s26, 3
    s_cbranch_scc1 L_k334
    v_add_u32 v60, s32, v44
    v_add_u32 v61, s32, v45
    v_add_u32 v62, s32, v46
    v_add_u32 v63, s32, v47
    ds_read_b64_tr_b16 v[64:65], v60 offset:0
    ds_read_b64_tr_b16 v[66:67], v60 offset:1024
    ds_read_b64_tr_b16 v[68:69], v61 offset:0
    ds_read_b64_tr_b16 v[70:71], v61 offset:1024
    ds_read_b64_tr_b16 v[72:73], v62 offset:0
    ds_read_b64_tr_b16 v[74:75], v62 offset:1024
    ds_read_b64_tr_b16 v[76:77], v63 offset:0
    ds_read_b64_tr_b16 v[78:79], v63 offset:1024
    s_add_u32 s35, s28, 2048
    s_branch L_kd35
L_k132:
    v_add_u32 v60, s32, v48
    v_add_u32 v61, s32, v49
    v_add_u32 v62, s32, v50
    v_add_u32 v63, s32, v51
    ds_read_b64_tr_b16 v[64:65], v60 offset:0
    ds_read_b64_tr_b16 v[66:67], v60 offset:2048
    ds_read_b64_tr_b16 v[68:69], v61 offset:0
    ds_read_b64_tr_b16 v[70:71], v61 offset:2048
    ds_read_b64_tr_b16 v[72:73], v62 offset:0
    ds_read_b64_tr_b16 v[74:75], v62 offset:2048
    ds_read_b64_tr_b16 v[76:77], v63 offset:0
    ds_read_b64_tr_b16 v[78:79], v63 offset:2048
    s_add_u32 s35, s28, 2048
    s_branch L_kd35
L_k233:
    v_add_u32 v60, s32, v52
    v_add_u32 v61, s32, v53
    ds_read_b64_tr_b16 v[64:65], v60 offset:0
    ds_read_b64_tr_b16 v[66:67], v60 offset:2048
    ds_read_b64_tr_b16 v[68:69], v60 offset:1024
    ds_read_b64_tr_b16 v[70:71], v60 offset:3072
    ds_read_b64_tr_b16 v[72:73], v61 offset:0
    ds_read_b64_tr_b16 v[74:75], v61 offset:2048
    ds_read_b64_tr_b16 v[76:77], v61 offset:1024
    ds_read_b64_tr_b16 v[78:79], v61 offset:3072
    s_add_u32 s35, s28, 32768
    s_mul_i32 s33, s33, 7168
    s_lshl_b32 s34, s34, 8
    s_add_u32 s33, s33, s34
    s_add_u32 s33, s33, 30539776
    v_lshlrev_b32 v62, 2, v2
    s_waitcnt lgkmcnt(0)
    v_mfma_f32_4x4x4_16b_bf16 v[80:83], v[18:19], v[64:65], 0
    v_mfma_f32_4x4x4_16b_bf16 v[84:87], v[18:19], v[72:73], 0
    s_nop 0
    v_mfma_f32_4x4x4_16b_bf16 v[80:83], v[18:19], v[66:67], v[80:83]
    v_mfma_f32_4x4x4_16b_bf16 v[84:87], v[18:19], v[74:75], v[84:87]
    s_nop 0
    v_mfma_f32_4x4x4_16b_bf16 v[80:83], v[18:19], v[68:69], v[80:83]
    v_mfma_f32_4x4x4_16b_bf16 v[84:87], v[18:19], v[76:77], v[84:87]
    s_nop 0
    v_mfma_f32_4x4x4_16b_bf16 v[80:83], v[18:19], v[70:71], v[80:83]
    v_mfma_f32_4x4x4_16b_bf16 v[84:87], v[18:19], v[78:79], v[84:87]
    s_nop 4
    v_permlane32_swap_b32 v80, v84
    v_add_f32 v80, v80, v84
    buffer_store_dword v80, v62, s[8:11], s33 offen sc1
    s_branch L_kd35
L_k334:
    v_add_u32 v60, s32, v52
    v_add_u32 v61, s32, v53
    ds_read_b64_tr_b16 v[64:65], v60 offset:0
    ds_read_b64_tr_b16 v[66:67], v60 offset:1024
    ds_read_b64_tr_b16 v[68:69], v61 offset:0
    ds_read_b64_tr_b16 v[70:71], v61 offset:1024
    ds_read_b64_tr_b16 v[72:73], v60 offset:2048
    ds_read_b64_tr_b16 v[74:75], v60 offset:3072
    ds_read_b64_tr_b16 v[76:77], v61 offset:2048
    ds_read_b64_tr_b16 v[78:79], v61 offset:3072
    s_add_u32 s35, s28, 2048
L_kd35:
    s_waitcnt lgkmcnt(0)
    buffer_store_dwordx4 v[64:67], v3, s[8:11], s28 offen sc1
    buffer_store_dwordx4 v[68:71], v3, s[8:11], s28 offen offset:1024 sc1
    buffer_store_dwordx4 v[72:75], v3, s[8:11], s35 offen sc1
    buffer_store_dwordx4 v[76:79], v3, s[8:11], s35 offen offset:1024 sc1
L_u428:
    s_waitcnt vmcnt(0)
    v_mov_b32 v10, 28768
    v_mov_b32 v11, 1
    s_mov_b64 exec, 1
    ds_add_rtn_u32 v18, v10, v11
    s_mov_b64 exec, -1
    s_waitcnt lgkmcnt(0)
    v_readfirstlane_b32 s26, v18
    s_nop 0
    s_cmp_lg_u32 s26, 3
    s_cbranch_scc1 L_pf36
    s_lshl_b32 s26, s2, 7
    s_add_u32 s26, s26, 30441472
    v_mov_b32 v10, s58
    v_mov_b32 v11, s59
    s_mov_b64 exec, 1
    buffer_store_dwordx2 v[10:11], off, s[8:11], s26 sc1
    s_mov_b64 exec, -1
    s_mov_b32 s16, s52
    s_mov_b32 s17, s53
    s_mov_b32 s18, 0x200000
    s_mov_b32 s19, 0x20000
    v_lshlrev_b32 v10, 21, v2
    s_mov_b32 s26, 8962048
    s_mov_b64 exec, 0xff
    buffer_load_dword v13, v10, s[8:11], s26 offen
    buffer_load_dword v13, off, s[16:19], 0
    s_mov_b64 exec, -1
L_pf36:
    s_lshl_b32 s31, s24, 16
    s_add_u32 s31, s31, s29
    s_mul_i32 s33, s24, 229376
    s_lshl_b32 s7, s4, 15
    s_add_u32 s7, s7, s33
    s_add_u32 s7, s7, 26738688
    s_add_u32 s33, s33, s29
    s_mul_i32 s32, s24, 896
    s_mul_i32 s30, s69, 28672
    s_add_u32 s32, s32, s30
    s_add_u32 s27, s3, 557568
    s_cmp_eq_u32 s22, 0
    s_cbranch_scc1 L_ld37
    s_mov_b64 exec, 1
    s_mov_b32 s60, 0
L_poll39:
    s_sleep 2
    buffer_load_dwordx2 v[10:11], v1, s[8:11], s27 offen sc1
    s_add_u32 s60, s60, 1
    s_cmp_gt_u32 s60, 0x20000
    s_waitcnt vmcnt(0)
    s_cbranch_scc1 L_polld40
    v_cmp_ne_u64 vcc, s[58:59], v[10:11]
    s_cbranch_vccnz L_poll39
L_polld40:
    s_mov_b64 exec, -1
    s_branch L_lj38
L_ld37:
    s_lshl_b32 s28, s69, 13
    s_add_u32 s28, s28, 30441472
    s_mov_b32 s60, 0
L_poll41:
    s_sleep 1
    buffer_load_dwordx2 v[10:11], v12, s[8:11], s28 offen sc1
    s_add_u32 s60, s60, 1
    s_cmp_gt_u32 s60, 0x20000
    s_waitcnt vmcnt(0)
    s_cbranch_scc1 L_polld42
    v_cmp_ne_u64 vcc, s[58:59], v[10:11]
    s_cbranch_vccnz L_poll41
L_polld42:
L_lj38:
    v_mov_b32 v10, 28768
    v_mov_b32 v11, 1
    s_mov_b64 exec, 1
    ds_add_u32 v10, v11
    s_mov_b64 exec, -1
L_hp43:
    s_sleep 2
    ds_read_b32 v11, v10
    s_waitcnt lgkmcnt(0)
    v_cmp_gt_u32 vcc, 8, v11
    s_cbranch_vccnz L_hp43
    s_or_b32 s26, s22, s69
    s_cmp_lg_u32 s26, 0
    s_cbranch_scc1 L_rd44
    v_mov_b32 v10, s58
    v_mov_b32 v11, s59
    s_cmp_eq_u32 s61, 0
    s_cbranch_scc1 L_sf45
    s_mov_b64 exec, 1
    buffer_store_dwordx2 v[10:11], off, s[8:11], s27
    s_mov_b64 exec, -1
L_sd46:
L_rd44:
    s_add_u32 s30, s7, 8192
    buffer_load_dwordx4 v[160:163], v3, s[8:11], s30 offen offset:0 sc1
    s_add_u32 s30, s7, 8192
    buffer_load_dwordx4 v[164:167], v3, s[8:11], s30 offen offset:1024 sc1
    s_add_u32 s30, s7, 8192
    buffer_load_dwordx4 v[168:171], v3, s[8:11], s30 offen offset:2048 sc1
    s_add_u32 s30, s7, 8192
    buffer_load_dwordx4 v[172:175], v3, s[8:11], s30 offen offset:3072 sc1
    s_add_u32 s30, s7, 12288
    buffer_load_dwordx4 v[176:179], v3, s[8:11], s30 offen offset:0 sc1
    s_add_u32 s30, s7, 12288
    buffer_load_dwordx4 v[180:183], v3, s[8:11], s30 offen offset:1024 sc1
    s_add_u32 s30, s7, 12288
    buffer_load_dwordx4 v[184:187], v3, s[8:11], s30 offen offset:2048 sc1
    s_add_u32 s30, s7, 12288
    buffer_load_dwordx4 v[188:191], v3, s[8:11], s30 offen offset:3072 sc1
    s_add_u32 s30, s7, 16384
    buffer_load_dwordx4 v[192:195], v3, s[8:11], s30 offen offset:0 sc1
    s_add_u32 s30, s7, 16384
    buffer_load_dwordx4 v[196:199], v3, s[8:11], s30 offen offset:1024 sc1
    s_add_u32 s30, s7, 16384
    buffer_load_dwordx4 v[200:203], v3, s[8:11], s30 offen offset:2048 sc1
    s_add_u32 s30, s7, 16384
    buffer_load_dwordx4 v[204:207], v3, s[8:11], s30 offen offset:3072 sc1
    s_add_u32 s30, s5, 16384
    buffer_load_dwordx4 v[208:211], v3, s[8:11], s30 offen offset:0 sc1
    s_add_u32 s30, s5, 16384
    buffer_load_dwordx4 v[212:215], v3, s[8:11], s30 offen offset:1024 sc1
    s_add_u32 s30, s5, 16384
    buffer_load_dwordx4 v[216:219], v3, s[8:11], s30 offen offset:2048 sc1
    s_add_u32 s30, s5, 16384
    buffer_load_dwordx4 v[220:223], v3, s[8:11], s30 offen offset:3072 sc1
    s_add_u32 m0, s29, 0
    s_add_u32 s30, s31, 25722880
    buffer_load_dwordx4 v3, s[8:11], s30 offen sc1 lds
    s_waitcnt vmcnt(16)
    s_add_u32 m0, s29, 4096
    s_add_u32 s30, s31, 25726976
    buffer_load_dwordx4 v3, s[8:11], s30 offen sc1 lds
    s_add_u32 m0, s29, 8192
    s_add_u32 s30, s31, 25731072
    buffer_load_dwordx4 v3, s[8:11], s30 offen sc1 lds
    s_waitcnt vmcnt(16)
    s_add_u32 m0, s29, 12288
    s_add_u32 s30, s31, 25735168
    buffer_load_dwordx4 v3, s[8:11], s30 offen sc1 lds
    s_add_u32 m0, s29, 16384
    s_add_u32 s30, s31, 25739264
    buffer_load_dwordx4 v3, s[8:11], s30 offen sc1 lds
    s_waitcnt vmcnt(16)
    s_add_u32 m0, s29, 20480
    s_add_u32 s30, s31, 25743360
    buffer_load_dwordx4 v3, s[8:11], s30 offen sc1 lds
    s_add_u32 m0, s29, 24576
    s_add_u32 s30, s31, 25747456
    buffer_load_dwordx4 v3, s[8:11], s30 offen sc1 lds
    s_waitcnt vmcnt(16)
    s_add_u32 s30, s31, 25751552
    buffer_load_dwordx4 v[88:91], v3, s[8:11], s30 offen offset:0 sc1
    s_add_u32 s30, s5, 20480
    buffer_load_dwordx4 v[224:227], v3, s[8:11], s30 offen offset:0 sc1
    s_waitcnt vmcnt(16)
    s_add_u32 s30, s5, 20480
    buffer_load_dwordx4 v[228:231], v3, s[8:11], s30 offen offset:1024 sc1
    s_add_u32 s30, s5, 20480
    buffer_load_dwordx4 v[232:235], v3, s[8:11], s30 offen offset:2048 sc1
    s_waitcnt vmcnt(16)
    s_add_u32 s30, s5, 20480
    buffer_load_dwordx4 v[236:239], v3, s[8:11], s30 offen offset:3072 sc1
    s_add_u32 s30, s5, 24576
    buffer_load_dwordx4 v[240:243], v3, s[8:11], s30 offen offset:0 sc1
    s_waitcnt vmcnt(16)
    s_add_u32 s30, s5, 24576
    buffer_load_dwordx4 v[244:247], v3, s[8:11], s30 offen offset:1024 sc1
    s_add_u32 s30, s5, 24576
    buffer_load_dwordx4 v[248:251], v3, s[8:11], s30 offen offset:2048 sc1
    s_waitcnt vmcnt(16)
    s_add_u32 s30, s5, 24576
    buffer_load_dwordx4 v[252:255], v3, s[8:11], s30 offen offset:3072 sc1
    s_add_u32 s30, s31, 26214400
    buffer_load_dwordx4 v[24:27], v3, s[8:11], s30 offen offset:0 sc1
    s_waitcnt vmcnt(16)
    s_add_u32 s30, s31, 26218496
    buffer_load_dwordx4 v[28:31], v3, s[8:11], s30 offen offset:0 sc1
    s_add_u32 s30, s31, 26222592
    buffer_load_dwordx4 v[32:35], v3, s[8:11], s30 offen offset:0 sc1
    s_waitcnt vmcnt(16)
    s_add_u32 s30, s31, 26226688
    buffer_load_dwordx4 v[36:39], v3, s[8:11], s30 offen offset:0 sc1
    s_add_u32 s30, s31, 26230784
    buffer_load_dwordx4 v[40:43], v3, s[8:11], s30 offen offset:0 sc1
    s_waitcnt vmcnt(16)
    s_add_u32 s30, s31, 26234880
    buffer_load_dwordx4 v[44:47], v3, s[8:11], s30 offen offset:0 sc1
    s_add_u32 s30, s31, 26238976
    buffer_load_dwordx4 v[48:51], v3, s[8:11], s30 offen offset:0 sc1
    s_waitcnt vmcnt(16)
    s_add_u32 s30, s31, 26243072
    buffer_load_dwordx4 v[52:55], v3, s[8:11], s30 offen offset:0 sc1
    s_add_u32 s30, s31, 26247168
    buffer_load_dwordx4 v[56:59], v3, s[8:11], s30 offen offset:0 sc1
    s_waitcnt vmcnt(16)
    s_add_u32 s30, s31, 26251264
    buffer_load_dwordx4 v[60:63], v3, s[8:11], s30 offen offset:0 sc1
    s_add_u32 s30, s31, 26255360
    buffer_load_dwordx4 v[64:67], v3, s[8:11], s30 offen offset:0 sc1
    s_waitcnt vmcnt(16)
    s_add_u32 s30, s31, 26259456
    buffer_load_dwordx4 v[68:71], v3, s[8:11], s30 offen offset:0 sc1
    s_add_u32 s30, s31, 26263552
    buffer_load_dwordx4 v[72:75], v3, s[8:11], s30 offen offset:0 sc1
    s_waitcnt vmcnt(16)
    s_add_u32 s30, s31, 26267648
    buffer_load_dwordx4 v[76:79], v3, s[8:11], s30 offen offset:0 sc1
    s_add_u32 s30, s31, 26271744
    buffer_load_dwordx4 v[80:83], v3, s[8:11], s30 offen offset:0 sc1
    s_waitcnt vmcnt(16)
    s_add_u32 s30, s31, 26275840
    buffer_load_dwordx4 v[84:87], v3, s[8:11], s30 offen offset:0 sc1
    s_add_u32 s30, s7, 0
    buffer_load_dwordx4 v[128:131], v3, s[8:11], s30 offen offset:0 sc1
    s_waitcnt vmcnt(16)
    s_add_u32 s30, s7, 0
    buffer_load_dwordx4 v[132:135], v3, s[8:11], s30 offen offset:1024 sc1
    s_add_u32 s30, s7, 0
    buffer_load_dwordx4 v[136:139], v3, s[8:11], s30 offen offset:2048 sc1
    s_waitcnt vmcnt(16)
    s_add_u32 s30, s7, 0
    buffer_load_dwordx4 v[140:143], v3, s[8:11], s30 offen offset:3072 sc1
    s_add_u32 s30, s7, 4096
    buffer_load_dwordx4 v[144:147], v3, s[8:11], s30 offen offset:0 sc1
    s_waitcnt vmcnt(16)
    s_add_u32 s30, s7, 4096
    buffer_load_dwordx4 v[148:151], v3, s[8:11], s30 offen offset:1024 sc1
    s_add_u32 s30, s7, 4096
    buffer_load_dwordx4 v[152:155], v3, s[8:11], s30 offen offset:2048 sc1
    s_waitcnt vmcnt(16)
    s_add_u32 s30, s7, 4096
    buffer_load_dwordx4 v[156:159], v3, s[8:11], s30 offen offset:3072 sc1
    s_add_u32 s30, s33, 26738688
    buffer_load_dwordx4 v[92:95], v3, s[8:11], s30 offen offset:0 sc1
    s_waitcnt vmcnt(16)
    s_add_u32 s30, s33, 26742784
    buffer_load_dwordx4 v[96:99], v3, s[8:11], s30 offen offset:0 sc1
    s_add_u32 s30, s33, 26771456
    buffer_load_dwordx4 v[100:103], v3, s[8:11], s30 offen offset:0 sc1
    s_waitcnt vmcnt(16)
    s_add_u32 s30, s33, 26775552
    buffer_load_dwordx4 v[104:107], v3, s[8:11], s30 offen offset:0 sc1
    s_add_u32 s30, s33, 26804224
    buffer_load_dwordx4 v[108:111], v3, s[8:11], s30 offen offset:0 sc1
    s_waitcnt vmcnt(16)
    s_add_u32 s30, s33, 26808320
    buffer_load_dwordx4 v[112:115], v3, s[8:11], s30 offen offset:0 sc1
    s_add_u32 s30, s32, 30539776
    buffer_load_dwordx4 v[116:119], v3, s[8:11], s30 offen offset:0 sc1
    s_waitcnt vmcnt(16)
    s_add_u32 s30, s32, 30546944
    buffer_load_dwordx4 v[120:123], v3, s[8:11], s30 offen offset:0 sc1
    s_add_u32 s30, s32, 30554112
    buffer_load_dwordx4 v[124:127], v3, s[8:11], s30 offen offset:0 sc1
    s_waitcnt vmcnt(16)
    s_add_u32 s30, s32, 30561280
    buffer_load_dwordx4 v[20:23], v3, s[8:11], s30 offen offset:0 sc1
    s_mov_b32 exec_lo, 0x7ffff
    s_mov_b32 exec_hi, 0x0
    buffer_load_dword v13, v17, s[8:11], 0 offen sc1
    s_mov_b64 exec, -1
    v_mov_b32 v10, 28736
    v_lshl_add_u32 v10, v9, 2, v10
L_wp47:
    ds_read_b32 v11, v10
    s_waitcnt lgkmcnt(0)
    v_cmp_gt_u32 vcc, 8, v11
    s_cbranch_vccz L_wd48
    s_sleep 12
    s_branch L_wp47
L_wd48:
    s_add_u32 m0, s29, 32768
    s_add_u32 s30, s31, 25165824
    buffer_load_dwordx4 v3, s[8:11], s30 offen sc1 lds
    s_add_u32 m0, s29, 36864
    s_add_u32 s30, s31, 25169920
    buffer_load_dwordx4 v3, s[8:11], s30 offen sc1 lds
    s_add_u32 m0, s29, 40960
    s_add_u32 s30, s31, 25174016
    buffer_load_dwordx4 v3, s[8:11], s30 offen sc1 lds
    s_add_u32 m0, s29, 45056
    s_add_u32 s30, s31, 25178112
    buffer_load_dwordx4 v3, s[8:11], s30 offen sc1 lds
    s_add_u32 m0, s29, 49152
    s_add_u32 s30, s31, 25182208
    buffer_load_dwordx4 v3, s[8:11], s30 offen sc1 lds
    s_add_u32 m0, s29, 53248
    s_add_u32 s30, s31, 25186304
    buffer_load_dwordx4 v3, s[8:11], s30 offen sc1 lds
    s_add_u32 m0, s29, 57344
    s_add_u32 s30, s31, 25190400
    buffer_load_dwordx4 v3, s[8:11], s30 offen sc1 lds
    s_add_u32 m0, s29, 61440
    s_add_u32 s30, s31, 25194496
    buffer_load_dwordx4 v3, s[8:11], s30 offen sc1 lds
    s_add_u32 m0, s29, 65536
    s_add_u32 s30, s31, 25198592
    buffer_load_dwordx4 v3, s[8:11], s30 offen sc1 lds
    s_add_u32 m0, s29, 69632
    s_add_u32 s30, s31, 25202688
    buffer_load_dwordx4 v3, s[8:11], s30 offen sc1 lds
    s_add_u32 m0, s29, 73728
    s_add_u32 s30, s31, 25206784
    buffer_load_dwordx4 v3, s[8:11], s30 offen sc1 lds
    s_add_u32 m0, s29, 77824
    s_add_u32 s30, s31, 25210880
    buffer_load_dwordx4 v3, s[8:11], s30 offen sc1 lds
    s_add_u32 m0, s29, 81920
    s_add_u32 s30, s31, 25214976
    buffer_load_dwordx4 v3, s[8:11], s30 offen sc1 lds
    s_add_u32 m0, s29, 86016
    s_add_u32 s30, s31, 25219072
    buffer_load_dwordx4 v3, s[8:11], s30 offen sc1 lds
    s_add_u32 m0, s29, 90112
    s_add_u32 s30, s31, 25223168
    buffer_load_dwordx4 v3, s[8:11], s30 offen sc1 lds
    s_add_u32 m0, s29, 94208
    s_add_u32 s30, s31, 25227264
    buffer_load_dwordx4 v3, s[8:11], s30 offen sc1 lds
    s_waitcnt vmcnt(8)
    v_mov_b32 v10, 28736
    v_lshl_add_u32 v10, v9, 2, v10
L_wp49:
    ds_read_b32 v11, v10
    s_waitcnt lgkmcnt(0)
    v_cmp_gt_u32 vcc, 10, v11
    s_cbranch_vccz L_wd50
    s_sleep 12
    s_branch L_wp49
L_wd50:
    s_add_u32 m0, s29, 98304
    s_add_u32 s30, s31, 25690112
    buffer_load_dwordx4 v3, s[8:11], s30 offen sc1 lds
    s_add_u32 m0, s29, 102400
    s_add_u32 s30, s31, 25694208
    buffer_load_dwordx4 v3, s[8:11], s30 offen sc1 lds
    s_add_u32 m0, s29, 106496
    s_add_u32 s30, s31, 25698304
    buffer_load_dwordx4 v3, s[8:11], s30 offen sc1 lds
    s_add_u32 m0, s29, 110592
    s_add_u32 s30, s31, 25702400
    buffer_load_dwordx4 v3, s[8:11], s30 offen sc1 lds
    s_waitcnt vmcnt(8)
    v_mov_b32 v10, 28736
    v_lshl_add_u32 v10, v9, 2, v10
L_wp51:
    ds_read_b32 v11, v10
    s_waitcnt lgkmcnt(0)
    v_cmp_gt_u32 vcc, 12, v11
    s_cbranch_vccz L_wd52
    s_sleep 12
    s_branch L_wp51
L_wd52:
    s_add_u32 m0, s29, 114688
    s_add_u32 s30, s31, 25706496
    buffer_load_dwordx4 v3, s[8:11], s30 offen sc1 lds
    s_add_u32 m0, s29, 118784
    s_add_u32 s30, s31, 25710592
    buffer_load_dwordx4 v3, s[8:11], s30 offen sc1 lds
    s_add_u32 m0, s29, 122880
    s_add_u32 s30, s31, 25714688
    buffer_load_dwordx4 v3, s[8:11], s30 offen sc1 lds
    s_add_u32 m0, s29, 126976
    s_add_u32 s30, s31, 25718784
    buffer_load_dwordx4 v3, s[8:11], s30 offen sc1 lds
    s_waitcnt vmcnt(8)
    ds_read_b32 v11, v10
    s_waitcnt lgkmcnt(0)
    v_cmp_gt_u32 vcc, 13, v11
    s_cbranch_vccz L_h2s53
    s_mov_b32 exec_lo, 0xffff
    s_mov_b32 exec_hi, 0x0
    buffer_load_dword v13, v14, s[8:11], 0 offen sc1
    s_mov_b64 exec, -1
    s_waitcnt vmcnt(1)
    ds_read_b32 v11, v10
    s_waitcnt lgkmcnt(0)
    v_cmp_gt_u32 vcc, 13, v11
    s_cbranch_vccz L_h2s53
    s_mov_b32 exec_lo, 0xffff0000
    s_mov_b32 exec_hi, 0x0
    buffer_load_dword v13, v14, s[8:11], 0 offen sc1
    s_mov_b64 exec, -1
    s_waitcnt vmcnt(1)
    ds_read_b32 v11, v10
    s_waitcnt lgkmcnt(0)
    v_cmp_gt_u32 vcc, 13, v11
    s_cbranch_vccz L_h2s53
    s_mov_b32 exec_lo, 0x0
    s_mov_b32 exec_hi, 0xffff
    buffer_load_dword v13, v14, s[8:11], 0 offen sc1
    s_mov_b64 exec, -1
    s_waitcnt vmcnt(1)
    ds_read_b32 v11, v10
    s_waitcnt lgkmcnt(0)
    v_cmp_gt_u32 vcc, 13, v11
    s_cbranch_vccz L_h2s53
    s_mov_b32 exec_lo, 0x0
    s_mov_b32 exec_hi, 0xffff0000
    buffer_load_dword v13, v14, s[8:11], 0 offen sc1
    s_mov_b64 exec, -1
    s_waitcnt vmcnt(1)
L_h2s53:
    s_cmp_lg_u32 s69, 2
    s_cbranch_scc1 L_cw54
    s_getpc_b64 s[26:27]
L_pc55:
    s_sub_u32 s26, s26, L_pc55-sequential_preLN__mha_block__mixer_s_mlp__prompt_kernel
    s_subb_u32 s27, s27, 0
    s_lshl_b32 s30, s22, 11
    v_lshl_add_u32 v10, v2, 7, s30
    v_min_u32 v10, sequential_preLN__mha_block__mixer_s_mlp__prompt_kernel_end-sequential_preLN__mha_block__mixer_s_mlp__prompt_kernel, v10
    s_mov_b64 exec, 0xffff
    global_load_dword v13, v10, s[26:27] sc1
    s_mov_b64 exec, -1
L_cw54:
    s_setprio 0
    s_waitcnt vmcnt(0)
    v_add_u32 v12, s29, v3
    v_add_u32 v13, 98304, v12
    v_add_u32 v14, 32768, v12
    s_mul_i32 s26, s69, 896
    v_add_u32 v15, s26, v3
    s_barrier
    ds_write_b128 v13, v[88:91] offset:32768
    ds_write_b128 v13, v[24:27] offset:36864
    ds_write_b128 v13, v[28:31] offset:40960
    ds_write_b128 v13, v[32:35] offset:45056
    ds_write_b128 v13, v[36:39] offset:49152
    ds_write_b128 v13, v[40:43] offset:53248
    ds_write_b128 v13, v[44:47] offset:57344
    ds_write_b128 v13, v[48:51] offset:61440
    v_pk_add_f32 v[116:117], v[116:117], v[120:121]
    v_pk_add_f32 v[118:119], v[118:119], v[122:123]
    v_pk_add_f32 v[116:117], v[116:117], v[124:125]
    v_pk_add_f32 v[118:119], v[118:119], v[126:127]
    v_pk_add_f32 v[116:117], v[116:117], v[20:21]
    v_pk_add_f32 v[118:119], v[118:119], v[22:23]
    s_mov_b32 exec_hi, 0xffffff
    ds_write_b128 v15, v[116:119] offset:28928
    s_mov_b32 exec_hi, -1
    v_mov_b32 v20, 0x3f803f80
    v_mov_b32 v21, 0x3f803f80
    v_mov_b32 v22, 0x3f803f80
    v_mov_b32 v23, 0x3f803f80
    s_nop 1
    v_mfma_f32_16x16x32_bf16 v[16:19], v[88:91], v[20:23], 0
    s_waitcnt lgkmcnt(0)
    ds_read_b128 v[24:27], v13 offset:0
    ds_read_b128 v[28:31], v13 offset:4096
    ds_read_b128 v[32:35], v13 offset:8192
    ds_read_b128 v[36:39], v13 offset:12288
    ds_read_b128 v[40:43], v13 offset:16384
    s_waitcnt lgkmcnt(4)
    v_mfma_f32_16x16x32_bf16 v[16:19], v[24:27], v[20:23], v[16:19]
    s_waitcnt lgkmcnt(3)
    v_mfma_f32_16x16x32_bf16 v[16:19], v[28:31], v[20:23], v[16:19]
    s_waitcnt lgkmcnt(2)
    v_mfma_f32_16x16x32_bf16 v[16:19], v[32:35], v[20:23], v[16:19]
    s_waitcnt lgkmcnt(1)
    v_mfma_f32_16x16x32_bf16 v[16:19], v[36:39], v[20:23], v[16:19]
    s_waitcnt lgkmcnt(0)
    v_mfma_f32_16x16x32_bf16 v[16:19], v[40:43], v[20:23], v[16:19]
    ds_read_b128 v[24:27], v13 offset:20480
    ds_read_b128 v[28:31], v13 offset:24576
    ds_read_b128 v[32:35], v13 offset:28672
    ds_read_b128 v[36:39], v12 offset:0
    ds_read_b128 v[40:43], v12 offset:4096
    s_waitcnt lgkmcnt(4)
    v_mfma_f32_16x16x32_bf16 v[16:19], v[24:27], v[20:23], v[16:19]
    s_waitcnt lgkmcnt(3)
    v_mfma_f32_16x16x32_bf16 v[16:19], v[28:31], v[20:23], v[16:19]
    s_waitcnt lgkmcnt(2)
    v_mfma_f32_16x16x32_bf16 v[16:19], v[32:35], v[20:23], v[16:19]
    s_waitcnt lgkmcnt(1)
    v_mfma_f32_16x16x32_bf16 v[16:19], v[36:39], v[20:23], v[16:19]
    s_waitcnt lgkmcnt(0)
    v_mfma_f32_16x16x32_bf16 v[16:19], v[40:43], v[20:23], v[16:19]
    ds_read_b128 v[24:27], v12 offset:8192
    ds_read_b128 v[28:31], v12 offset:12288
    ds_read_b128 v[32:35], v12 offset:16384
    ds_read_b128 v[36:39], v12 offset:20480
    ds_read_b128 v[40:43], v12 offset:24576
    s_waitcnt lgkmcnt(4)
    v_mfma_f32_16x16x32_bf16 v[16:19], v[24:27], v[20:23], v[16:19]
    s_waitcnt lgkmcnt(3)
    v_mfma_f32_16x16x32_bf16 v[16:19], v[28:31], v[20:23], v[16:19]
    s_waitcnt lgkmcnt(2)
    v_mfma_f32_16x16x32_bf16 v[16:19], v[32:35], v[20:23], v[16:19]
    s_waitcnt lgkmcnt(1)
    v_mfma_f32_16x16x32_bf16 v[16:19], v[36:39], v[20:23], v[16:19]
    s_waitcnt lgkmcnt(0)
    v_mfma_f32_16x16x32_bf16 v[16:19], v[40:43], v[20:23], v[16:19]
    s_lshl_b32 s26, s69, 6
    s_add_u32 s26, s26, 28672
    v_lshl_add_u32 v10, v7, 4, s26
    s_nop 4
    ds_write_b128 v10, v[16:19]
    s_cmp_lg_u32 s69, 0
    s_cbranch_scc1 L_of56
    s_lshl_b32 s28, s21, 14
    s_lshl_b32 s27, s23, 12
    s_add_u32 s28, s28, s27
    s_add_u32 s28, s28, 30670848
    s_mov_b32 s30, -1
    s_mov_b32 s31, 0
    v_lshlrev_b32 v20, 7, v2
    s_mov_b64 exec, s[30:31]
    s_mov_b32 s60, 0
L_poll57:
    s_sleep 1
    buffer_load_dwordx2 v[10:11], v20, s[8:11], s28 offen sc1
    s_add_u32 s60, s60, 1
    s_cmp_gt_u32 s60, 0x20000
    s_waitcnt vmcnt(0)
    s_cbranch_scc1 L_polld58
    v_cmp_ne_u64 vcc, s[58:59], v[10:11]
    s_cbranch_vccnz L_poll57
L_polld58:
    s_mov_b64 exec, -1
L_of56:
    s_waitcnt lgkmcnt(0)
    s_barrier
    s_cmp_lg_u32 s69, 3
    s_cbranch_scc1 L_c3w59
    ds_read_b128 v[24:27], v3 offset:28928
    ds_read_b128 v[28:31], v3 offset:29824
    ds_read_b128 v[32:35], v3 offset:30720
    ds_read_b128 v[36:39], v3 offset:31616
    s_waitcnt lgkmcnt(0)
    v_pk_add_f32 v[24:25], v[24:25], v[28:29]
    v_pk_add_f32 v[26:27], v[26:27], v[30:31]
    v_pk_add_f32 v[24:25], v[24:25], v[32:33]
    v_pk_add_f32 v[26:27], v[26:27], v[34:35]
    v_pk_add_f32 v[24:25], v[24:25], v[36:37]
    v_pk_add_f32 v[26:27], v[26:27], v[38:39]
    ds_write_b128 v3, v[24:27] offset:28928
L_c3w59:
    s_barrier
    ds_write_b128 v14, v[52:55] offset:28672
    ds_write_b128 v14, v[56:59] offset:32768
    ds_write_b128 v14, v[60:63] offset:36864
    ds_write_b128 v14, v[64:67] offset:40960
    ds_write_b128 v14, v[68:71] offset:45056
    ds_write_b128 v14, v[72:75] offset:49152
    ds_write_b128 v14, v[76:79] offset:53248
    ds_write_b128 v14, v[80:83] offset:57344
    ds_write_b128 v14, v[84:87] offset:61440
    s_waitcnt lgkmcnt(0)
    s_barrier
    ds_write_b128 v13, v[92:95] offset:0
    ds_write_b128 v13, v[96:99] offset:4096
    ds_write_b128 v13, v[100:103] offset:8192
    ds_write_b128 v13, v[104:107] offset:12288
    ds_write_b128 v13, v[108:111] offset:16384
    ds_write_b128 v13, v[112:115] offset:20480
    v_lshrrev_b32 v15, 4, v4
    v_lshlrev_b32 v14, 14, v15
    v_lshl_add_u32 v14, v5, 8, v14
    v_lshl_add_u32 v14, v6, 4, v14
    v_add_u32 v14, 32768, v14
    v_mul_u32_u24 v15, 0xe000, v15
    v_lshl_add_u32 v15, v5, 8, v15
    v_lshl_add_u32 v15, v6, 4, v15
    v_lshlrev_b32 v16, 4, v4
    s_lshl_b32 s26, s4, 7
    s_add_u32 s26, s26, 28928
    v_lshl_add_u32 v17, v5, 4, s26
    ds_read_b128 v[56:59], v17 offset:0
    ds_read_b128 v[60:63], v17 offset:32
    ds_read_b128 v[64:67], v17 offset:64
    ds_read_b128 v[68:71], v17 offset:96
    s_lshl_b32 s26, s4, 12
    v_add_u32 v18, s26, v3
    v_add_u32 v19, 0, v18
    s_lshl_b32 s28, s25, 10
    s_add_u32 s28, s28, s3
    s_add_u32 s28, s28, 540672
    s_mov_b32 s33, s67
    s_lshl_b32 s34, s23, 9
    s_add_u32 s34, s34, s3
    s_add_u32 s34, s34, 562176
    s_lshl_b32 s35, s24, 6
    s_add_u32 s35, s35, s34
    s_lshl_b32 s29, s4, 3
    s_add_u32 s35, s35, s29
    s_add_u32 s29, s35, 2048
    s_lshl_b32 s32, s20, 6
    s_add_u32 s32, s32, s34
    s_mul_i32 s31, s20, 14336
    s_add_u32 s31, s31, s33
    s_lshl_b32 s27, s69, 2
    v_add_u32 v10, s27, v7
    v_xor_b32 v12, v10, v6
    v_lshlrev_b32 v12, 4, v12
    v_lshl_add_u32 v12, v10, 8, v12
    s_cmp_gt_u32 s20, 3
    s_cselect_b32 s26, 8192, 0
    s_mov_b32 s27, 114688
    s_cselect_b32 s27, 122880, s27
    s_add_u32 s26, s26, 98304
    v_add_u32 v20, s26, v12
    v_add_u32 v21, s27, v12
    s_lshl_b32 s27, s20, 13
    v_lshlrev_b32 v13, 4, v5
    v_xor_b32 v13, v13, v3
    v_add_u32 v13, s27, v13
    s_lshl_b32 s27, s20, 2
    v_add_u32 v10, s27, v7
    v_xor_b32 v10, v10, v6
    v_lshlrev_b32 v10, 4, v10
    v_and_b32 v11, 1, v2
    v_lshl_add_u32 v10, v11, 9, v10
    v_lshrrev_b32 v11, 1, v6
    v_lshl_add_u32 v22, v11, 10, v10
    v_add_u32 v23, 0x10000, v22
    v_lshlrev_b32 v12, 10, v7
    v_lshl_add_u32 v12, v6, 3, v12
    s_mov_b32 s16, s52
    s_mov_b32 s17, s53
    s_mov_b32 s18, 0x200000
    s_mov_b32 s19, 0x20000
    s_lshl_b32 s72, s21, 4
    s_add_u32 s72, s72, s25
    s_lshl_b32 s72, s72, 14
    s_lshl_b32 s27, s20, 12
    s_add_u32 s72, s72, s27
    s_lshl_b32 s27, s24, 7
    s_add_u32 s72, s72, s27
    s_add_u32 s73, s72, 32768
    s_mul_i32 s26, s24, 14336
    s_add_u32 s26, s26, s33
    s_lshl_b32 s27, s4, 11
    s_add_u32 s26, s26, s27
    s_add_u32 s27, s26, 114688
    s_lshl_b32 s74, s70, 6
    s_add_u32 s74, s74, s3
    s_add_u32 s74, s74, 561152
    s_lshl_b32 s6, s70, 14
    s_lshl_b32 s75, s69, 14
    s_add_u32 s6, s6, s3
    s_add_u32 s6, s6, 262144
    s_waitcnt lgkmcnt(0)
    s_barrier
    s_mov_b64 exec, 0xff
    s_mov_b32 s60, 0
L_poll60:
    buffer_load_dwordx2 v[10:11], v1, s[8:11], s74 offen sc1
    s_add_u32 s60, s60, 1
    s_cmp_gt_u32 s60, 0x20000
    s_waitcnt vmcnt(0)
    s_cbranch_scc1 L_polld61
    v_cmp_ne_u64 vcc, s[58:59], v[10:11]
    s_cbranch_vccnz L_poll60
L_polld61:
    s_mov_b64 exec, -1
    s_add_u32 m0, s75, 32768
    s_add_u32 s30, s6, 0
    buffer_load_dwordx4 v3, s[8:11], s30 offen offset:0 sc1 lds
    buffer_load_dwordx4 v3, s[8:11], s30 offen offset:1024 sc1 lds
    buffer_load_dwordx4 v3, s[8:11], s30 offen offset:2048 sc1 lds
    buffer_load_dwordx4 v3, s[8:11], s30 offen offset:3072 sc1 lds
    s_add_u32 m0, s75, 36864
    s_add_u32 s30, s6, 4096
    buffer_load_dwordx4 v3, s[8:11], s30 offen offset:0 sc1 lds
    buffer_load_dwordx4 v3, s[8:11], s30 offen offset:1024 sc1 lds
    buffer_load_dwordx4 v3, s[8:11], s30 offen offset:2048 sc1 lds
    buffer_load_dwordx4 v3, s[8:11], s30 offen offset:3072 sc1 lds
    s_branch L_hjoin62
L_cw11:
    s_cmp_lg_u32 s20, 1
    s_cbranch_scc1 L_cp63
    s_getpc_b64 s[26:27]
sequential_preLN__mha_block__mixer_s_mlp__prompt_kernel_pc:
    s_sub_u32 s26, s26, sequential_preLN__mha_block__mixer_s_mlp__prompt_kernel_pc-sequential_preLN__mha_block__mixer_s_mlp__prompt_kernel
    s_subb_u32 s27, s27, 0
    s_lshl_b32 s28, s22, 11
    v_lshl_add_u32 v10, v2, 7, s28
    v_min_u32 v10, sequential_preLN__mha_block__mixer_s_mlp__prompt_kernel_end-sequential_preLN__mha_block__mixer_s_mlp__prompt_kernel, v10
    s_mov_b64 exec, 0xffff
    global_load_dword v255, v10, s[26:27]
    s_mov_b64 exec, -1
L_cp63:
    v_lshlrev_b32 v3, 4, v2
    v_and_b32 v4, 31, v2
    v_lshrrev_b32 v5, 5, v2
    v_and_b32 v6, 15, v2
    v_lshrrev_b32 v7, 4, v2
    v_bfe_u32 v8, v2, 2, 2
    v_and_b32 v9, 3, v2
    v_lshlrev_b32 v1, 3, v2
    s_lshl_b32 s25, s23, 2
    s_add_u32 s70, s25, s69
    s_lshl_b32 s3, s21, 21
    s_add_u32 s3, s3, 8388608
    s_mul_i32 s66, s21, 917504
    s_mul_i32 s67, s23, 229376
    s_add_u32 s67, s67, s66
    s_cmp_gt_u32 s20, 3
    s_subb_u32 s4, s20, 0
    s_mul_i32 s5, s24, 229376
    s_mul_i32 s26, s20, 28672
    s_add_u32 s5, s5, s26
    s_add_u32 s5, s5, 28573696
    s_mov_b32 s62, 0xbdd2d3e8
    s_mov_b32 s63, 0xbdd2d3e8
    s_mov_b32 s64, 1.0
    s_mov_b32 s65, 1.0
    s_lshr_b32 s30, s69, 1
    s_and_b32 s31, s69, 1
    s_lshl_b32 s27, s30, 5
    v_add_u32 v10, s27, v4
    v_lshlrev_b32 v10, 7, v10
    v_bfe_u32 v11, v4, 1, 3
    v_add_u32 v12, 0, v5
    v_xor_b32 v12, v12, v11
    v_lshl_add_u32 v112, v12, 4, v10
    v_add_u32 v12, 2, v5
    v_xor_b32 v12, v12, v11
    v_lshl_add_u32 v113, v12, 4, v10
    v_add_u32 v12, 4, v5
    v_xor_b32 v12, v12, v11
    v_lshl_add_u32 v114, v12, 4, v10
    v_add_u32 v12, 6, v5
    v_xor_b32 v12, v12, v11
    v_lshl_add_u32 v115, v12, 4, v10
    v_lshl_add_u32 v10, v5, 3, v8
    v_lshlrev_b32 v10, 7, v10
    v_lshl_add_u32 v10, v9, 3, v10
    v_and_b32 v11, 1, v7
    s_lshl_b32 s27, s31, 1
    v_add_u32 v11, s27, v11
    v_and_b32 v12, 2, v8
    v_xor_b32 v11, v11, v12
    v_lshl_add_u32 v116, v11, 5, v10
    v_add_u32 v116, 65536, v116
    v_xor_b32 v117, 32, v116
    v_add_u32 v117, 512, v117
    v_add_u32 v118, 49152, v116
    v_add_u32 v119, 49152, v117
    s_waitcnt lgkmcnt(0)
    s_mov_b32 s16, s54
    s_mov_b32 s17, s55
    s_mov_b32 s18, 0x100
    s_mov_b32 s19, 0x20000
    s_mov_b32 s8, s56
    s_mov_b32 s9, s57
    s_mov_b32 s10, 0x1e00000
    s_mov_b32 s11, 0x20000
    s_lshl_b32 s27, s31, 7
    s_add_u32 s27, s27, 139264
    v_lshl_add_u32 v120, v5, 4, s27
    v_lshl_add_u32 v121, v4, 2, s27
    s_lshl_b32 s27, s30, 7
    s_add_u32 s27, s27, 140288
    v_lshl_add_u32 v122, v4, 2, s27
    v_lshl_add_u32 v123, v5, 4, s27
    v_lshrrev_b32 v10, 4, v4
    v_mul_u32_u24 v10, 229376, v10
    v_lshl_add_u32 v10, v5, 8, v10
    v_lshl_add_u32 v124, v6, 4, v10
    s_lshl_b32 s26, s22, 1
    s_add_u32 s26, s26, s30
    s_lshl_b32 s26, s26, 10
    s_mul_i32 s27, s31, 458752
    s_add_u32 s26, s26, s27
    s_add_u32 s6, s26, s66
    v_mov_b32 v125, 140800
    s_barrier
    ds_read_b128 v[64:67], v112 offset:0
    ds_read_b64_tr_b16 v[68:69], v116 offset:0
    ds_read_b64_tr_b16 v[70:71], v117 offset:0
    ds_read_b64_tr_b16 v[72:73], v116 offset:8192
    ds_read_b64_tr_b16 v[74:75], v117 offset:8192
    ds_read_b64_tr_b16 v[76:77], v116 offset:16384
    ds_read_b64_tr_b16 v[78:79], v117 offset:16384
    ds_read_b128 v[80:83], v113 offset:0
    ds_read_b64_tr_b16 v[84:85], v116 offset:2048
    ds_read_b64_tr_b16 v[86:87], v117 offset:2048
    ds_read_b64_tr_b16 v[88:89], v116 offset:10240
    ds_read_b64_tr_b16 v[90:91], v117 offset:10240
    ds_read_b64_tr_b16 v[92:93], v116 offset:18432
    ds_read_b64_tr_b16 v[94:95], v117 offset:18432
    s_waitcnt lgkmcnt(7)
    v_mfma_f32_32x32x16_bf16 v[16:31], v[68:71], v[64:67], 0
    ds_read_b128 v[96:99], v114 offset:0
    ds_read_b64_tr_b16 v[100:101], v116 offset:4096
    ds_read_b64_tr_b16 v[102:103], v117 offset:4096
    ds_read_b64_tr_b16 v[104:105], v116 offset:12288
    ds_read_b64_tr_b16 v[106:107], v117 offset:12288
    v_mfma_f32_32x32x16_bf16 v[32:47], v[72:75], v[64:67], 0
    ds_read_b64_tr_b16 v[108:109], v116 offset:20480
    ds_read_b64_tr_b16 v[110:111], v117 offset:20480
    ds_read_b128 v[228:231], v115 offset:0
    ds_read_b64_tr_b16 v[232:233], v116 offset:6144
    ds_read_b64_tr_b16 v[234:235], v117 offset:6144
    v_mfma_f32_32x32x16_bf16 v[48:63], v[64:67], v[76:79], 0
    ds_read_b64_tr_b16 v[236:237], v116 offset:14336
    ds_read_b64_tr_b16 v[238:239], v117 offset:14336
    ds_read_b64_tr_b16 v[240:241], v116 offset:22528
    ds_read_b64_tr_b16 v[242:243], v117 offset:22528
    s_waitcnt lgkmcnt(14)
    v_mfma_f32_32x32x16_bf16 v[16:31], v[84:87], v[80:83], v[16:31]
    v_mfma_f32_32x32x16_bf16 v[32:47], v[88:91], v[80:83], v[32:47]
    v_mfma_f32_32x32x16_bf16 v[48:63], v[80:83], v[92:95], v[48:63]
    s_waitcnt lgkmcnt(0)
    s_barrier
    v_mfma_f32_32x32x16_bf16 v[16:31], v[100:103], v[96:99], v[16:31]
    ds_read_b128 v[64:67], v112 offset:8192
    ds_read_b64_tr_b16 v[68:69], v116 offset:24576
    ds_read_b64_tr_b16 v[70:71], v117 offset:24576
    v_mfma_f32_32x32x16_bf16 v[32:47], v[104:107], v[96:99], v[32:47]
    ds_read_b64_tr_b16 v[72:73], v116 offset:32768
    ds_read_b64_tr_b16 v[74:75], v117 offset:32768
    ds_read_b64_tr_b16 v[76:77], v116 offset:40960
    v_mfma_f32_32x32x16_bf16 v[48:63], v[96:99], v[108:111], v[48:63]
    ds_read_b64_tr_b16 v[78:79], v117 offset:40960
    v_mfma_f32_32x32x16_bf16 v[16:31], v[232:235], v[228:231], v[16:31]
    ds_read_b128 v[80:83], v113 offset:8192
    ds_read_b64_tr_b16 v[84:85], v116 offset:26624
    ds_read_b64_tr_b16 v[86:87], v117 offset:26624
    v_mfma_f32_32x32x16_bf16 v[32:47], v[236:239], v[228:231], v[32:47]
    ds_read_b64_tr_b16 v[88:89], v116 offset:34816
    ds_read_b64_tr_b16 v[90:91], v117 offset:34816
    ds_read_b64_tr_b16 v[92:93], v116 offset:43008
    v_mfma_f32_32x32x16_bf16 v[48:63], v[228:231], v[240:243], v[48:63]
    ds_read_b64_tr_b16 v[94:95], v117 offset:43008
    s_waitcnt lgkmcnt(7)
    v_mfma_f32_32x32x16_bf16 v[16:31], v[68:71], v[64:67], v[16:31]
    ds_read_b128 v[96:99], v114 offset:8192
    ds_read_b64_tr_b16 v[100:101], v116 offset:28672
    ds_read_b64_tr_b16 v[102:103], v117 offset:28672
    ds_read_b64_tr_b16 v[104:105], v116 offset:36864
    ds_read_b64_tr_b16 v[106:107], v117 offset:36864
    v_mfma_f32_32x32x16_bf16 v[32:47], v[72:75], v[64:67], v[32:47]
    ds_read_b64_tr_b16 v[108:109], v116 offset:45056
    ds_read_b64_tr_b16 v[110:111], v117 offset:45056
    ds_read_b128 v[228:231], v115 offset:8192
    ds_read_b64_tr_b16 v[232:233], v116 offset:30720
    ds_read_b64_tr_b16 v[234:235], v117 offset:30720
    v_mfma_f32_32x32x16_bf16 v[48:63], v[64:67], v[76:79], v[48:63]
    ds_read_b64_tr_b16 v[236:237], v116 offset:38912
    ds_read_b64_tr_b16 v[238:239], v117 offset:38912
    ds_read_b64_tr_b16 v[240:241], v116 offset:47104
    ds_read_b64_tr_b16 v[242:243], v117 offset:47104
    s_waitcnt lgkmcnt(14)
    v_mfma_f32_32x32x16_bf16 v[16:31], v[84:87], v[80:83], v[16:31]
    v_mfma_f32_32x32x16_bf16 v[32:47], v[88:91], v[80:83], v[32:47]
    v_mfma_f32_32x32x16_bf16 v[48:63], v[80:83], v[92:95], v[48:63]
    s_waitcnt lgkmcnt(0)
    s_barrier
    v_mfma_f32_32x32x16_bf16 v[16:31], v[100:103], v[96:99], v[16:31]
    ds_read_b128 v[64:67], v112 offset:16384
    ds_read_b64_tr_b16 v[68:69], v118 offset:0
    ds_read_b64_tr_b16 v[70:71], v119 offset:0
    v_mfma_f32_32x32x16_bf16 v[32:47], v[104:107], v[96:99], v[32:47]
    ds_read_b64_tr_b16 v[72:73], v118 offset:8192
    ds_read_b64_tr_b16 v[74:75], v119 offset:8192
    ds_read_b64_tr_b16 v[76:77], v118 offset:16384
    v_mfma_f32_32x32x16_bf16 v[48:63], v[96:99], v[108:111], v[48:63]
    ds_read_b64_tr_b16 v[78:79], v119 offset:16384
    v_mfma_f32_32x32x16_bf16 v[16:31], v[232:235], v[228:231], v[16:31]
    ds_read_b128 v[80:83], v113 offset:16384
    ds_read_b64_tr_b16 v[84:85], v118 offset:2048
    ds_read_b64_tr_b16 v[86:87], v119 offset:2048
    v_mfma_f32_32x32x16_bf16 v[32:47], v[236:239], v[228:231], v[32:47]
    ds_read_b64_tr_b16 v[88:89], v118 offset:10240
    ds_read_b64_tr_b16 v[90:91], v119 offset:10240
    ds_read_b64_tr_b16 v[92:93], v118 offset:18432
    v_mfma_f32_32x32x16_bf16 v[48:63], v[228:231], v[240:243], v[48:63]
    ds_read_b64_tr_b16 v[94:95], v119 offset:18432
    s_waitcnt lgkmcnt(7)
    v_mfma_f32_32x32x16_bf16 v[16:31], v[68:71], v[64:67], v[16:31]
    ds_read_b128 v[96:99], v114 offset:16384
    ds_read_b64_tr_b16 v[100:101], v118 offset:4096
    ds_read_b64_tr_b16 v[102:103], v119 offset:4096
    ds_read_b64_tr_b16 v[104:105], v118 offset:12288
    ds_read_b64_tr_b16 v[106:107], v119 offset:12288
    v_mfma_f32_32x32x16_bf16 v[32:47], v[72:75], v[64:67], v[32:47]
    ds_read_b64_tr_b16 v[108:109], v118 offset:20480
    ds_read_b64_tr_b16 v[110:111], v119 offset:20480
    ds_read_b128 v[228:231], v115 offset:16384
    ds_read_b64_tr_b16 v[232:233], v118 offset:6144
    ds_read_b64_tr_b16 v[234:235], v119 offset:6144
    v_mfma_f32_32x32x16_bf16 v[48:63], v[64:67], v[76:79], v[48:63]
    ds_read_b64_tr_b16 v[236:237], v118 offset:14336
    ds_read_b64_tr_b16 v[238:239], v119 offset:14336
    ds_read_b64_tr_b16 v[240:241], v118 offset:22528
    ds_read_b64_tr_b16 v[242:243], v119 offset:22528
    s_waitcnt lgkmcnt(14)
    v_mfma_f32_32x32x16_bf16 v[16:31], v[84:87], v[80:83], v[16:31]
    v_mfma_f32_32x32x16_bf16 v[32:47], v[88:91], v[80:83], v[32:47]
    v_mfma_f32_32x32x16_bf16 v[48:63], v[80:83], v[92:95], v[48:63]
    s_waitcnt lgkmcnt(0)
    s_barrier
    v_mfma_f32_32x32x16_bf16 v[16:31], v[100:103], v[96:99], v[16:31]
    ds_read_b128 v[64:67], v112 offset:24576
    ds_read_b64_tr_b16 v[68:69], v116 offset:0
    ds_read_b64_tr_b16 v[70:71], v117 offset:0
    v_mfma_f32_32x32x16_bf16 v[32:47], v[104:107], v[96:99], v[32:47]
    ds_read_b64_tr_b16 v[72:73], v116 offset:8192
    ds_read_b64_tr_b16 v[74:75], v117 offset:8192
    ds_read_b64_tr_b16 v[76:77], v116 offset:16384
    v_mfma_f32_32x32x16_bf16 v[48:63], v[96:99], v[108:111], v[48:63]
    ds_read_b64_tr_b16 v[78:79], v117 offset:16384
    v_mfma_f32_32x32x16_bf16 v[16:31], v[232:235], v[228:231], v[16:31]
    ds_read_b128 v[80:83], v113 offset:24576
    ds_read_b64_tr_b16 v[84:85], v116 offset:2048
    ds_read_b64_tr_b16 v[86:87], v117 offset:2048
    v_mfma_f32_32x32x16_bf16 v[32:47], v[236:239], v[228:231], v[32:47]
    ds_read_b64_tr_b16 v[88:89], v116 offset:10240
    ds_read_b64_tr_b16 v[90:91], v117 offset:10240
    ds_read_b64_tr_b16 v[92:93], v116 offset:18432
    v_mfma_f32_32x32x16_bf16 v[48:63], v[228:231], v[240:243], v[48:63]
    ds_read_b64_tr_b16 v[94:95], v117 offset:18432
    s_waitcnt lgkmcnt(7)
    v_mfma_f32_32x32x16_bf16 v[16:31], v[68:71], v[64:67], v[16:31]
    ds_read_b128 v[96:99], v114 offset:24576
    ds_read_b64_tr_b16 v[100:101], v116 offset:4096
    ds_read_b64_tr_b16 v[102:103], v117 offset:4096
    ds_read_b64_tr_b16 v[104:105], v116 offset:12288
    ds_read_b64_tr_b16 v[106:107], v117 offset:12288
    v_mfma_f32_32x32x16_bf16 v[32:47], v[72:75], v[64:67], v[32:47]
    ds_read_b64_tr_b16 v[108:109], v116 offset:20480
    ds_read_b64_tr_b16 v[110:111], v117 offset:20480
    ds_read_b128 v[228:231], v115 offset:24576
    ds_read_b64_tr_b16 v[232:233], v116 offset:6144
    ds_read_b64_tr_b16 v[234:235], v117 offset:6144
    v_mfma_f32_32x32x16_bf16 v[48:63], v[64:67], v[76:79], v[48:63]
    ds_read_b64_tr_b16 v[236:237], v116 offset:14336
    ds_read_b64_tr_b16 v[238:239], v117 offset:14336
    ds_read_b64_tr_b16 v[240:241], v116 offset:22528
    ds_read_b64_tr_b16 v[242:243], v117 offset:22528
    s_waitcnt lgkmcnt(14)
    v_mfma_f32_32x32x16_bf16 v[16:31], v[84:87], v[80:83], v[16:31]
    v_mfma_f32_32x32x16_bf16 v[32:47], v[88:91], v[80:83], v[32:47]
    v_mfma_f32_32x32x16_bf16 v[48:63], v[80:83], v[92:95], v[48:63]
    s_waitcnt lgkmcnt(0)
    s_barrier
    v_mfma_f32_32x32x16_bf16 v[16:31], v[100:103], v[96:99], v[16:31]
    ds_read_b128 v[64:67], v112 offset:32768
    ds_read_b64_tr_b16 v[68:69], v116 offset:24576
    ds_read_b64_tr_b16 v[70:71], v117 offset:24576
    v_mfma_f32_32x32x16_bf16 v[32:47], v[104:107], v[96:99], v[32:47]
    ds_read_b64_tr_b16 v[72:73], v116 offset:32768
    ds_read_b64_tr_b16 v[74:75], v117 offset:32768
    ds_read_b64_tr_b16 v[76:77], v116 offset:40960
    v_mfma_f32_32x32x16_bf16 v[48:63], v[96:99], v[108:111], v[48:63]
    ds_read_b64_tr_b16 v[78:79], v117 offset:40960
    v_mfma_f32_32x32x16_bf16 v[16:31], v[232:235], v[228:231], v[16:31]
    ds_read_b128 v[80:83], v113 offset:32768
    ds_read_b64_tr_b16 v[84:85], v116 offset:26624
    ds_read_b64_tr_b16 v[86:87], v117 offset:26624
    v_mfma_f32_32x32x16_bf16 v[32:47], v[236:239], v[228:231], v[32:47]
    ds_read_b64_tr_b16 v[88:89], v116 offset:34816
    ds_read_b64_tr_b16 v[90:91], v117 offset:34816
    ds_read_b64_tr_b16 v[92:93], v116 offset:43008
    v_mfma_f32_32x32x16_bf16 v[48:63], v[228:231], v[240:243], v[48:63]
    ds_read_b64_tr_b16 v[94:95], v117 offset:43008
    s_waitcnt lgkmcnt(7)
    v_mfma_f32_32x32x16_bf16 v[16:31], v[68:71], v[64:67], v[16:31]
    ds_read_b128 v[96:99], v114 offset:32768
    ds_read_b64_tr_b16 v[100:101], v116 offset:28672
    ds_read_b64_tr_b16 v[102:103], v117 offset:28672
    ds_read_b64_tr_b16 v[104:105], v116 offset:36864
    ds_read_b64_tr_b16 v[106:107], v117 offset:36864
    v_mfma_f32_32x32x16_bf16 v[32:47], v[72:75], v[64:67], v[32:47]
    ds_read_b64_tr_b16 v[108:109], v116 offset:45056
    ds_read_b64_tr_b16 v[110:111], v117 offset:45056
    ds_read_b128 v[228:231], v115 offset:32768
    ds_read_b64_tr_b16 v[232:233], v116 offset:30720
    ds_read_b64_tr_b16 v[234:235], v117 offset:30720
    v_mfma_f32_32x32x16_bf16 v[48:63], v[64:67], v[76:79], v[48:63]
    ds_read_b64_tr_b16 v[236:237], v116 offset:38912
    ds_read_b64_tr_b16 v[238:239], v117 offset:38912
    ds_read_b64_tr_b16 v[240:241], v116 offset:47104
    ds_read_b64_tr_b16 v[242:243], v117 offset:47104
    s_waitcnt lgkmcnt(14)
    v_mfma_f32_32x32x16_bf16 v[16:31], v[84:87], v[80:83], v[16:31]
    v_mfma_f32_32x32x16_bf16 v[32:47], v[88:91], v[80:83], v[32:47]
    v_mfma_f32_32x32x16_bf16 v[48:63], v[80:83], v[92:95], v[48:63]
    s_waitcnt lgkmcnt(0)
    s_barrier
    v_mfma_f32_32x32x16_bf16 v[16:31], v[100:103], v[96:99], v[16:31]
    ds_read_b128 v[64:67], v112 offset:40960
    ds_read_b64_tr_b16 v[68:69], v118 offset:0
    ds_read_b64_tr_b16 v[70:71], v119 offset:0
    v_mfma_f32_32x32x16_bf16 v[32:47], v[104:107], v[96:99], v[32:47]
    ds_read_b64_tr_b16 v[72:73], v118 offset:8192
    ds_read_b64_tr_b16 v[74:75], v119 offset:8192
    ds_read_b64_tr_b16 v[76:77], v118 offset:16384
    v_mfma_f32_32x32x16_bf16 v[48:63], v[96:99], v[108:111], v[48:63]
    ds_read_b64_tr_b16 v[78:79], v119 offset:16384
    v_mfma_f32_32x32x16_bf16 v[16:31], v[232:235], v[228:231], v[16:31]
    ds_read_b128 v[80:83], v113 offset:40960
    ds_read_b64_tr_b16 v[84:85], v118 offset:2048
    ds_read_b64_tr_b16 v[86:87], v119 offset:2048
    v_mfma_f32_32x32x16_bf16 v[32:47], v[236:239], v[228:231], v[32:47]
    ds_read_b64_tr_b16 v[88:89], v118 offset:10240
    ds_read_b64_tr_b16 v[90:91], v119 offset:10240
    ds_read_b64_tr_b16 v[92:93], v118 offset:18432
    v_mfma_f32_32x32x16_bf16 v[48:63], v[228:231], v[240:243], v[48:63]
    ds_read_b64_tr_b16 v[94:95], v119 offset:18432
    s_waitcnt lgkmcnt(7)
    v_mfma_f32_32x32x16_bf16 v[16:31], v[68:71], v[64:67], v[16:31]
    ds_read_b128 v[96:99], v114 offset:40960
    ds_read_b64_tr_b16 v[100:101], v118 offset:4096
    ds_read_b64_tr_b16 v[102:103], v119 offset:4096
    ds_read_b64_tr_b16 v[104:105], v118 offset:12288
    ds_read_b64_tr_b16 v[106:107], v119 offset:12288
    v_mfma_f32_32x32x16_bf16 v[32:47], v[72:75], v[64:67], v[32:47]
    ds_read_b64_tr_b16 v[108:109], v118 offset:20480
    ds_read_b64_tr_b16 v[110:111], v119 offset:20480
    ds_read_b128 v[228:231], v115 offset:40960
    ds_read_b64_tr_b16 v[232:233], v118 offset:6144
    ds_read_b64_tr_b16 v[234:235], v119 offset:6144
    v_mfma_f32_32x32x16_bf16 v[48:63], v[64:67], v[76:79], v[48:63]
    ds_read_b64_tr_b16 v[236:237], v118 offset:14336
    ds_read_b64_tr_b16 v[238:239], v119 offset:14336
    ds_read_b64_tr_b16 v[240:241], v118 offset:22528
    ds_read_b64_tr_b16 v[242:243], v119 offset:22528
    s_waitcnt lgkmcnt(14)
    v_mfma_f32_32x32x16_bf16 v[16:31], v[84:87], v[80:83], v[16:31]
    v_mfma_f32_32x32x16_bf16 v[32:47], v[88:91], v[80:83], v[32:47]
    v_mfma_f32_32x32x16_bf16 v[48:63], v[80:83], v[92:95], v[48:63]
    s_waitcnt lgkmcnt(0)
    s_barrier
    v_mfma_f32_32x32x16_bf16 v[16:31], v[100:103], v[96:99], v[16:31]
    ds_read_b128 v[64:67], v112 offset:49152
    ds_read_b64_tr_b16 v[68:69], v116 offset:0
    ds_read_b64_tr_b16 v[70:71], v117 offset:0
    v_mfma_f32_32x32x16_bf16 v[32:47], v[104:107], v[96:99], v[32:47]
    ds_read_b64_tr_b16 v[72:73], v116 offset:8192
    ds_read_b64_tr_b16 v[74:75], v117 offset:8192
    ds_read_b64_tr_b16 v[76:77], v116 offset:16384
    v_mfma_f32_32x32x16_bf16 v[48:63], v[96:99], v[108:111], v[48:63]
    ds_read_b64_tr_b16 v[78:79], v117 offset:16384
    v_mfma_f32_32x32x16_bf16 v[16:31], v[232:235], v[228:231], v[16:31]
    ds_read_b128 v[80:83], v113 offset:49152
    ds_read_b64_tr_b16 v[84:85], v116 offset:2048
    ds_read_b64_tr_b16 v[86:87], v117 offset:2048
    v_mfma_f32_32x32x16_bf16 v[32:47], v[236:239], v[228:231], v[32:47]
    ds_read_b64_tr_b16 v[88:89], v116 offset:10240
    ds_read_b64_tr_b16 v[90:91], v117 offset:10240
    ds_read_b64_tr_b16 v[92:93], v116 offset:18432
    v_mfma_f32_32x32x16_bf16 v[48:63], v[228:231], v[240:243], v[48:63]
    ds_read_b64_tr_b16 v[94:95], v117 offset:18432
    s_waitcnt lgkmcnt(7)
    v_mfma_f32_32x32x16_bf16 v[16:31], v[68:71], v[64:67], v[16:31]
    ds_read_b128 v[96:99], v114 offset:49152
    ds_read_b64_tr_b16 v[100:101], v116 offset:4096
    ds_read_b64_tr_b16 v[102:103], v117 offset:4096
    ds_read_b64_tr_b16 v[104:105], v116 offset:12288
    ds_read_b64_tr_b16 v[106:107], v117 offset:12288
    v_mfma_f32_32x32x16_bf16 v[32:47], v[72:75], v[64:67], v[32:47]
    ds_read_b64_tr_b16 v[108:109], v116 offset:20480
    ds_read_b64_tr_b16 v[110:111], v117 offset:20480
    ds_read_b128 v[228:231], v115 offset:49152
    ds_read_b64_tr_b16 v[232:233], v116 offset:6144
    ds_read_b64_tr_b16 v[234:235], v117 offset:6144
    v_mfma_f32_32x32x16_bf16 v[48:63], v[64:67], v[76:79], v[48:63]
    ds_read_b64_tr_b16 v[236:237], v116 offset:14336
    ds_read_b64_tr_b16 v[238:239], v117 offset:14336
    ds_read_b64_tr_b16 v[240:241], v116 offset:22528
    ds_read_b64_tr_b16 v[242:243], v117 offset:22528
    s_waitcnt lgkmcnt(14)
    v_mfma_f32_32x32x16_bf16 v[16:31], v[84:87], v[80:83], v[16:31]
    v_mfma_f32_32x32x16_bf16 v[32:47], v[88:91], v[80:83], v[32:47]
    v_mfma_f32_32x32x16_bf16 v[48:63], v[80:83], v[92:95], v[48:63]
    s_waitcnt lgkmcnt(0)
    s_barrier
    v_mfma_f32_32x32x16_bf16 v[16:31], v[100:103], v[96:99], v[16:31]
    ds_read_b128 v[64:67], v112 offset:57344
    ds_read_b64_tr_b16 v[68:69], v116 offset:24576
    ds_read_b64_tr_b16 v[70:71], v117 offset:24576
    v_mfma_f32_32x32x16_bf16 v[32:47], v[104:107], v[96:99], v[32:47]
    ds_read_b64_tr_b16 v[72:73], v116 offset:32768
    ds_read_b64_tr_b16 v[74:75], v117 offset:32768
    ds_read_b64_tr_b16 v[76:77], v116 offset:40960
    v_mfma_f32_32x32x16_bf16 v[48:63], v[96:99], v[108:111], v[48:63]
    ds_read_b64_tr_b16 v[78:79], v117 offset:40960
    v_mfma_f32_32x32x16_bf16 v[16:31], v[232:235], v[228:231], v[16:31]
    ds_read_b128 v[80:83], v113 offset:57344
    ds_read_b64_tr_b16 v[84:85], v116 offset:26624
    ds_read_b64_tr_b16 v[86:87], v117 offset:26624
    v_mfma_f32_32x32x16_bf16 v[32:47], v[236:239], v[228:231], v[32:47]
    ds_read_b64_tr_b16 v[88:89], v116 offset:34816
    ds_read_b64_tr_b16 v[90:91], v117 offset:34816
    ds_read_b64_tr_b16 v[92:93], v116 offset:43008
    v_mfma_f32_32x32x16_bf16 v[48:63], v[228:231], v[240:243], v[48:63]
    ds_read_b64_tr_b16 v[94:95], v117 offset:43008
    s_waitcnt lgkmcnt(7)
    v_mfma_f32_32x32x16_bf16 v[16:31], v[68:71], v[64:67], v[16:31]
    ds_read_b128 v[96:99], v114 offset:57344
    ds_read_b64_tr_b16 v[100:101], v116 offset:28672
    ds_read_b64_tr_b16 v[102:103], v117 offset:28672
    ds_read_b64_tr_b16 v[104:105], v116 offset:36864
    ds_read_b64_tr_b16 v[106:107], v117 offset:36864
    v_mfma_f32_32x32x16_bf16 v[32:47], v[72:75], v[64:67], v[32:47]
    ds_read_b64_tr_b16 v[108:109], v116 offset:45056
    ds_read_b64_tr_b16 v[110:111], v117 offset:45056
    ds_read_b128 v[228:231], v115 offset:57344
    ds_read_b64_tr_b16 v[232:233], v116 offset:30720
    ds_read_b64_tr_b16 v[234:235], v117 offset:30720
    v_mfma_f32_32x32x16_bf16 v[48:63], v[64:67], v[76:79], v[48:63]
    ds_read_b64_tr_b16 v[236:237], v116 offset:38912
    ds_read_b64_tr_b16 v[238:239], v117 offset:38912
    ds_read_b64_tr_b16 v[240:241], v116 offset:47104
    ds_read_b64_tr_b16 v[242:243], v117 offset:47104
    s_waitcnt lgkmcnt(14)
    v_mfma_f32_32x32x16_bf16 v[16:31], v[84:87], v[80:83], v[16:31]
    v_mfma_f32_32x32x16_bf16 v[32:47], v[88:91], v[80:83], v[32:47]
    v_mfma_f32_32x32x16_bf16 v[48:63], v[80:83], v[92:95], v[48:63]
    s_waitcnt lgkmcnt(0)
    v_mfma_f32_32x32x16_bf16 v[16:31], v[100:103], v[96:99], v[16:31]
    v_mfma_f32_32x32x16_bf16 v[32:47], v[104:107], v[96:99], v[32:47]
    v_mfma_f32_32x32x16_bf16 v[48:63], v[96:99], v[108:111], v[48:63]
    s_waitcnt lgkmcnt(0)
    s_barrier
    v_mfma_f32_32x32x16_bf16 v[16:31], v[232:235], v[228:231], v[16:31]
    ds_read_b128 v[12:15], v125
    ds_read_b32 v192, v122
    ds_read_b32 v224, v122 offset:256
    ds_read_b32 v194, v121 offset:512
    ds_read_b128 v[128:131], v120 offset:0
    ds_read_b128 v[132:135], v120 offset:32
    ds_read_b128 v[136:139], v120 offset:64
    v_mfma_f32_32x32x16_bf16 v[32:47], v[236:239], v[228:231], v[32:47]
    ds_read_b128 v[140:143], v120 offset:96
    ds_read_b128 v[144:147], v120 offset:256
    ds_read_b128 v[148:151], v120 offset:288
    ds_read_b128 v[152:155], v120 offset:320
    ds_read_b128 v[156:159], v120 offset:352
    ds_read_b128 v[160:163], v123 offset:0
    ds_read_b128 v[164:167], v123 offset:32
    v_mfma_f32_32x32x16_bf16 v[48:63], v[228:231], v[240:243], v[48:63]
    ds_read_b128 v[168:171], v123 offset:64
    ds_read_b128 v[172:175], v123 offset:96
    ds_read_b128 v[176:179], v123 offset:256
    ds_read_b128 v[180:183], v123 offset:288
    ds_read_b128 v[184:187], v123 offset:320
    ds_read_b128 v[188:191], v123 offset:352
    s_waitcnt lgkmcnt(8)
    v_readfirstlane_b32 s61, v14
    v_readfirstlane_b32 s58, v12
    v_readfirstlane_b32 s59, v13
    v_mul_f32 v196, 0x3eb8aa3b, v192
    v_mul_f32 v226, 0x3eb8aa3b, v224
    s_cmp_eq_u32 s61, 0
    s_cbranch_scc1 L_sf64
    v_pk_mul_f32 v[128:129], v[128:129], v[196:197] op_sel_hi:[1,0]
    v_pk_mul_f32 v[130:131], v[130:131], v[196:197] op_sel_hi:[1,0]
    v_pk_mul_f32 v[132:133], v[132:133], v[196:197] op_sel_hi:[1,0]
    v_pk_mul_f32 v[134:135], v[134:135], v[196:197] op_sel_hi:[1,0]
    v_pk_mul_f32 v[136:137], v[136:137], v[196:197] op_sel_hi:[1,0]
    v_pk_mul_f32 v[138:139], v[138:139], v[196:197] op_sel_hi:[1,0]
    v_pk_mul_f32 v[140:141], v[140:141], v[196:197] op_sel_hi:[1,0]
    v_pk_mul_f32 v[142:143], v[142:143], v[196:197] op_sel_hi:[1,0]
    v_pk_fma_f32 v[16:17], v[16:17], v[226:227], v[128:129] op_sel_hi:[1,0,1]
    v_pk_fma_f32 v[18:19], v[18:19], v[226:227], v[130:131] op_sel_hi:[1,0,1]
    v_pk_fma_f32 v[20:21], v[20:21], v[226:227], v[132:133] op_sel_hi:[1,0,1]
    v_pk_fma_f32 v[22:23], v[22:23], v[226:227], v[134:135] op_sel_hi:[1,0,1]
    v_cvt_pk_bf16_f32 v200, v16, v17
    v_cvt_pk_bf16_f32 v201, v18, v19
    v_cvt_pk_bf16_f32 v202, v20, v21
    v_cvt_pk_bf16_f32 v203, v22, v23
    s_add_u32 s26, s6, 0
    buffer_store_dwordx4 v[200:203], v3, s[8:11], s26 offen
    v_pk_fma_f32 v[24:25], v[24:25], v[226:227], v[136:137] op_sel_hi:[1,0,1]
    v_pk_fma_f32 v[26:27], v[26:27], v[226:227], v[138:139] op_sel_hi:[1,0,1]
    v_pk_fma_f32 v[28:29], v[28:29], v[226:227], v[140:141] op_sel_hi:[1,0,1]
    v_pk_fma_f32 v[30:31], v[30:31], v[226:227], v[142:143] op_sel_hi:[1,0,1]
    v_cvt_pk_bf16_f32 v204, v24, v25
    v_cvt_pk_bf16_f32 v205, v26, v27
    v_cvt_pk_bf16_f32 v206, v28, v29
    v_cvt_pk_bf16_f32 v207, v30, v31
    s_add_u32 s26, s6, 229376
    buffer_store_dwordx4 v[204:207], v3, s[8:11], s26 offen
    v_pk_mul_f32 v[144:145], v[144:145], v[192:193] op_sel_hi:[1,0]
    v_pk_mul_f32 v[146:147], v[146:147], v[192:193] op_sel_hi:[1,0]
    v_pk_mul_f32 v[148:149], v[148:149], v[192:193] op_sel_hi:[1,0]
    v_pk_mul_f32 v[150:151], v[150:151], v[192:193] op_sel_hi:[1,0]
    v_pk_mul_f32 v[152:153], v[152:153], v[192:193] op_sel_hi:[1,0]
    v_pk_mul_f32 v[154:155], v[154:155], v[192:193] op_sel_hi:[1,0]
    v_pk_mul_f32 v[156:157], v[156:157], v[192:193] op_sel_hi:[1,0]
    v_pk_mul_f32 v[158:159], v[158:159], v[192:193] op_sel_hi:[1,0]
    v_pk_fma_f32 v[32:33], v[32:33], v[224:225], v[144:145] op_sel_hi:[1,0,1]
    v_pk_fma_f32 v[34:35], v[34:35], v[224:225], v[146:147] op_sel_hi:[1,0,1]
    v_pk_fma_f32 v[36:37], v[36:37], v[224:225], v[148:149] op_sel_hi:[1,0,1]
    v_pk_fma_f32 v[38:39], v[38:39], v[224:225], v[150:151] op_sel_hi:[1,0,1]
    v_cvt_pk_bf16_f32 v208, v32, v33
    v_cvt_pk_bf16_f32 v209, v34, v35
    v_cvt_pk_bf16_f32 v210, v36, v37
    v_cvt_pk_bf16_f32 v211, v38, v39
    s_add_u32 s26, s6, 65536
    buffer_store_dwordx4 v[208:211], v3, s[8:11], s26 offen
    v_pk_fma_f32 v[40:41], v[40:41], v[224:225], v[152:153] op_sel_hi:[1,0,1]
    v_pk_fma_f32 v[42:43], v[42:43], v[224:225], v[154:155] op_sel_hi:[1,0,1]
    v_pk_fma_f32 v[44:45], v[44:45], v[224:225], v[156:157] op_sel_hi:[1,0,1]
    v_pk_fma_f32 v[46:47], v[46:47], v[224:225], v[158:159] op_sel_hi:[1,0,1]
    v_cvt_pk_bf16_f32 v212, v40, v41
    v_cvt_pk_bf16_f32 v213, v42, v43
    v_cvt_pk_bf16_f32 v214, v44, v45
    v_cvt_pk_bf16_f32 v215, v46, v47
    s_add_u32 s26, s6, 294912
    buffer_store_dwordx4 v[212:215], v3, s[8:11], s26 offen
    s_waitcnt lgkmcnt(0)
    s_add_u32 s26, s6, 0x20000
    v_pk_mul_f32 v[160:161], v[160:161], v[194:195] op_sel_hi:[1,0]
    v_pk_mul_f32 v[162:163], v[162:163], v[194:195] op_sel_hi:[1,0]
    v_pk_mul_f32 v[164:165], v[164:165], v[194:195] op_sel_hi:[1,0]
    v_pk_mul_f32 v[166:167], v[166:167], v[194:195] op_sel_hi:[1,0]
    v_pk_mul_f32 v[168:169], v[168:169], v[194:195] op_sel_hi:[1,0]
    v_pk_mul_f32 v[170:171], v[170:171], v[194:195] op_sel_hi:[1,0]
    v_pk_mul_f32 v[172:173], v[172:173], v[194:195] op_sel_hi:[1,0]
    v_pk_mul_f32 v[174:175], v[174:175], v[194:195] op_sel_hi:[1,0]
    v_pk_fma_f32 v[48:49], v[48:49], v[176:177], v[160:161]
    v_pk_fma_f32 v[50:51], v[50:51], v[178:179], v[162:163]
    v_pk_fma_f32 v[52:53], v[52:53], v[180:181], v[164:165]
    v_pk_fma_f32 v[54:55], v[54:55], v[182:183], v[166:167]
    v_cvt_pk_bf16_f32 v216, v48, v49
    v_cvt_pk_bf16_f32 v217, v50, v51
    v_cvt_pk_bf16_f32 v218, v52, v53
    v_cvt_pk_bf16_f32 v219, v54, v55
    buffer_store_dwordx4 v[216:219], v124, s[8:11], s26 offen offset:0
    v_pk_fma_f32 v[56:57], v[56:57], v[184:185], v[168:169]
    v_pk_fma_f32 v[58:59], v[58:59], v[186:187], v[170:171]
    v_pk_fma_f32 v[60:61], v[60:61], v[188:189], v[172:173]
    v_pk_fma_f32 v[62:63], v[62:63], v[190:191], v[174:175]
    v_cvt_pk_bf16_f32 v220, v56, v57
    v_cvt_pk_bf16_f32 v221, v58, v59
    v_cvt_pk_bf16_f32 v222, v60, v61
    v_cvt_pk_bf16_f32 v223, v62, v63
    buffer_store_dwordx4 v[220:223], v124, s[8:11], s26 offen offset:512
L_sd65:
    v_lshlrev_b32 v10, 8, v5
    v_lshl_add_u32 v10, v6, 4, v10
    v_and_b32 v11, 11, v6
    v_cmp_eq_u32 vcc, 0, v11
    v_mov_b32 v11, 28688
    v_mov_b32 v20, 28672
    v_cndmask_b32 v11, v11, v20, vcc
    v_add_u32 v20, 4, v6
    v_and_b32 v20, 8, v20
    v_lshl_add_u32 v11, v20, 4, v11
    v_cmp_gt_u32 vcc, 16, v4
    v_add_u32 v20, 36864, v10
    s_nop 0
    v_cndmask_b32 v116, v11, v20, vcc
    v_mov_b32 v20, 0x2000
    v_cndmask_b32 v118, 0, v20, vcc
    v_add_u32 v117, 32768, v3
    v_mov_b32 v119, 0
    s_lshl_b32 s27, s69, 2
    s_add_u32 s27, s27, 28736
    v_mov_b32 v129, s27
    s_lshl_b32 s28, s24, 13
    s_lshl_b32 s27, s69, 11
    s_add_u32 s28, s28, s27
    s_add_u32 s72, s28, s67
    s_mul_i32 s7, s24, 7
    s_add_u32 s7, s7, s69
    s_lshl_b32 s7, s7, 15
    s_add_u32 s7, s7, 26738688
    v_mov_b32 v10, s58
    v_mov_b32 v11, s59
    s_lshl_b32 s26, s22, 3
    s_add_u32 s26, s26, s3
    s_add_u32 s26, s26, 557056
    s_waitcnt vmcnt(0) lgkmcnt(0)
    s_barrier
    s_cmp_lg_u32 s20, 0
    s_cbranch_scc1 L_qf66
    s_cmp_eq_u32 s61, 0
    s_cbranch_scc1 L_sf67
    s_mov_b64 exec, 1
    buffer_store_dwordx2 v[10:11], off, s[8:11], s26
    s_mov_b64 exec, -1
L_sd68:
L_qf66:
    s_mov_b32 s16, s36
    s_mov_b32 s17, s37
    s_mov_b32 s18, 0x200000
    s_mov_b32 s19, 0x20000
    s_lshl_b32 s33, s21, 4
    s_add_u32 s33, s33, s70
    s_lshl_b32 s33, s33, 14
    s_lshl_b32 s27, s24, 7
    s_add_u32 s33, s33, s27
    v_lshlrev_b32 v128, 10, v6
    v_lshl_add_u32 v128, v7, 3, v128
    s_lshl_b32 s26, s24, 5
    s_lshl_b32 s27, s69, 3
    s_add_u32 s26, s26, s27
    s_add_u32 s26, s26, s3
    s_add_u32 s26, s26, 557056
    s_mov_b64 exec, 1
    s_mov_b32 s60, 0
L_poll69:
    buffer_load_dwordx2 v[10:11], v1, s[8:11], s26 offen sc1
    s_add_u32 s60, s60, 1
    s_cmp_gt_u32 s60, 0x20000
    s_waitcnt vmcnt(0)
    s_cbranch_scc1 L_polld70
    v_cmp_ne_u64 vcc, s[58:59], v[10:11]
    s_cbranch_vccnz L_poll69
L_polld70:
    s_mov_b64 exec, -1
    buffer_load_dwordx4 v[12:15], v3, s[8:11], s72 offen sc1
    buffer_load_dwordx4 v[16:19], v3, s[8:11], s72 offen offset:1024 sc1
    s_waitcnt vmcnt(0)
    s_barrier
    ds_read_b128 v[92:95], v117 offset:0
    ds_read_b128 v[96:99], v117 offset:1024
    ds_read_b128 v[100:103], v116 offset:0
    ds_read_b128 v[104:107], v116 offset:512
    s_waitcnt lgkmcnt(3)
    v_mfma_f32_32x32x16_bf16 v[20:35], v[92:95], v[12:15], 0
    v_mov_b32 v130, 28772
    s_sub_u32 s35, s5, 4096
    s_cmp_eq_u32 s69, 3
    s_cselect_b32 s35, s35, s7
.p2align 3
    s_waitcnt lgkmcnt(0)
    s_nop 0
    v_mfma_f32_32x32x16_bf16 v[36:51], v[92:95], v[16:19], 0
    s_waitcnt lgkmcnt(0)
    s_nop 3
    v_exp_f32 v20, v20
    v_exp_f32_e64 v21, v21
    v_exp_f32 v22, v22
    v_exp_f32 v23, v23
    v_cvt_pk_bf16_f32 v84, v20, v21
    v_exp_f32 v24, v24
    v_exp_f32 v25, v25
    v_cvt_pk_bf16_f32 v85, v22, v23
    ds_read_b128 v[108:111], v116 offset:1024
    ds_read_b128 v[112:115], v116 offset:1536
    ds_read_b128 v[92:95], v117 offset:2048
    v_exp_f32 v26, v26
    v_exp_f32 v27, v27
    v_cvt_pk_bf16_f32 v86, v24, v25
    v_exp_f32 v28, v28
    v_exp_f32 v29, v29
    v_cvt_pk_bf16_f32 v87, v26, v27
    v_exp_f32 v30, v30
    v_exp_f32 v31, v31
    v_mfma_f32_32x32x16_bf16 v[52:67], v[100:103], v[84:87], 0
    v_cvt_pk_bf16_f32 v88, v28, v29
    v_exp_f32 v32, v32
    v_exp_f32 v33, v33
    v_cvt_pk_bf16_f32 v89, v30, v31
    v_exp_f32 v34, v34
    v_exp_f32 v35, v35
    v_cvt_pk_bf16_f32 v90, v32, v33
    v_cvt_pk_bf16_f32 v91, v34, v35
    v_mfma_f32_32x32x16_bf16 v[20:35], v[96:99], v[12:15], 0
    v_exp_f32 v36, v36
    v_exp_f32 v37, v37
    v_exp_f32 v38, v38
    v_exp_f32 v39, v39
    v_cvt_pk_bf16_f32 v84, v36, v37
    v_exp_f32 v40, v40
    v_exp_f32 v41, v41
    v_cvt_pk_bf16_f32 v85, v38, v39
    v_mfma_f32_32x32x16_bf16 v[52:67], v[104:107], v[88:91], v[52:67]
    v_exp_f32 v42, v42
    v_exp_f32 v43, v43
    v_cvt_pk_bf16_f32 v86, v40, v41
    v_exp_f32 v44, v44
    v_exp_f32 v45, v45
    v_cvt_pk_bf16_f32 v87, v42, v43
    v_exp_f32 v46, v46
    v_exp_f32 v47, v47
    v_mfma_f32_32x32x16_bf16 v[68:83], v[100:103], v[84:87], 0
    v_cvt_pk_bf16_f32 v88, v44, v45
    v_exp_f32 v48, v48
    v_exp_f32 v49, v49
    v_cvt_pk_bf16_f32 v89, v46, v47
    v_exp_f32 v50, v50
    v_exp_f32 v51, v51
    v_cvt_pk_bf16_f32 v90, v48, v49
    v_cvt_pk_bf16_f32 v91, v50, v51
    v_mfma_f32_32x32x16_bf16 v[36:51], v[96:99], v[16:19], 0
    s_waitcnt lgkmcnt(0)
    v_exp_f32 v20, v20
    v_exp_f32_e64 v21, v21
    v_exp_f32 v22, v22
    v_exp_f32 v23, v23
    v_cvt_pk_bf16_f32 v84, v20, v21
    v_exp_f32 v24, v24
    v_exp_f32 v25, v25
    v_cvt_pk_bf16_f32 v85, v22, v23
    v_mfma_f32_32x32x16_bf16 v[68:83], v[104:107], v[88:91], v[68:83]
    ds_read_b128 v[100:103], v116 offset:2048
    ds_read_b128 v[104:107], v116 offset:2560
    ds_read_b128 v[96:99], v117 offset:3072
    v_exp_f32 v26, v26
    v_exp_f32 v27, v27
    v_cvt_pk_bf16_f32 v86, v24, v25
    v_exp_f32 v28, v28
    v_exp_f32 v29, v29
    v_cvt_pk_bf16_f32 v87, v26, v27
    v_exp_f32 v30, v30
    v_exp_f32 v31, v31
    v_mfma_f32_32x32x16_bf16 v[52:67], v[108:111], v[84:87], v[52:67]
    v_cvt_pk_bf16_f32 v88, v28, v29
    v_exp_f32 v32, v32
    v_exp_f32 v33, v33
    v_cvt_pk_bf16_f32 v89, v30, v31
    v_exp_f32 v34, v34
    v_exp_f32 v35, v35
    v_cvt_pk_bf16_f32 v90, v32, v33
    v_cvt_pk_bf16_f32 v91, v34, v35
    v_mfma_f32_32x32x16_bf16 v[20:35], v[92:95], v[12:15], 0
    v_exp_f32 v36, v36
    v_exp_f32 v37, v37
    v_exp_f32 v38, v38
    v_exp_f32 v39, v39
    v_cvt_pk_bf16_f32 v84, v36, v37
    v_exp_f32 v40, v40
    v_exp_f32 v41, v41
    v_cvt_pk_bf16_f32 v85, v38, v39
    v_mfma_f32_32x32x16_bf16 v[52:67], v[112:115], v[88:91], v[52:67]
    v_exp_f32 v42, v42
    v_exp_f32 v43, v43
    v_cvt_pk_bf16_f32 v86, v40, v41
    v_exp_f32 v44, v44
    v_exp_f32 v45, v45
    v_cvt_pk_bf16_f32 v87, v42, v43
    v_exp_f32 v46, v46
    v_exp_f32 v47, v47
    v_mfma_f32_32x32x16_bf16 v[68:83], v[108:111], v[84:87], v[68:83]
    v_cvt_pk_bf16_f32 v88, v44, v45
    v_exp_f32 v48, v48
    v_exp_f32 v49, v49
    v_cvt_pk_bf16_f32 v89, v46, v47
    v_exp_f32 v50, v50
    v_exp_f32 v51, v51
    v_cvt_pk_bf16_f32 v90, v48, v49
    v_cvt_pk_bf16_f32 v91, v50, v51
    v_mfma_f32_32x32x16_bf16 v[36:51], v[92:95], v[16:19], 0
    s_waitcnt lgkmcnt(0)
    v_exp_f32 v20, v20
    v_exp_f32_e64 v21, v21
    v_exp_f32 v22, v22
    v_exp_f32 v23, v23
    v_cvt_pk_bf16_f32 v84, v20, v21
    v_exp_f32 v24, v24
    v_exp_f32 v25, v25
    v_cvt_pk_bf16_f32 v85, v22, v23
    v_mfma_f32_32x32x16_bf16 v[68:83], v[112:115], v[88:91], v[68:83]
    ds_read_b128 v[108:111], v116 offset:3072
    ds_read_b128 v[112:115], v116 offset:3584
    ds_read_b128 v[92:95], v117 offset:8192
    v_exp_f32 v26, v26
    v_exp_f32 v27, v27
    v_cvt_pk_bf16_f32 v86, v24, v25
    v_exp_f32 v28, v28
    v_exp_f32 v29, v29
    v_cvt_pk_bf16_f32 v87, v26, v27
    v_exp_f32 v30, v30
    v_exp_f32 v31, v31
    v_mfma_f32_32x32x16_bf16 v[52:67], v[100:103], v[84:87], v[52:67]
    v_cvt_pk_bf16_f32 v88, v28, v29
    v_exp_f32 v32, v32
    v_exp_f32 v33, v33
    v_cvt_pk_bf16_f32 v89, v30, v31
    v_exp_f32 v34, v34
    v_exp_f32 v35, v35
    v_cvt_pk_bf16_f32 v90, v32, v33
    v_cvt_pk_bf16_f32 v91, v34, v35
    v_mfma_f32_32x32x16_bf16 v[20:35], v[96:99], v[12:15], 0
    v_exp_f32 v36, v36
    v_exp_f32 v37, v37
    v_exp_f32 v38, v38
    v_exp_f32 v39, v39
    v_cvt_pk_bf16_f32 v84, v36, v37
    v_add_u32 v116, v118, v116
    v_exp_f32 v40, v40
    v_exp_f32_e64 v41, v41
    v_cvt_pk_bf16_f32 v85, v38, v39
    v_mfma_f32_32x32x16_bf16 v[52:67], v[104:107], v[88:91], v[52:67]
    v_exp_f32 v42, v42
    v_exp_f32 v43, v43
    v_cvt_pk_bf16_f32 v86, v40, v41
    v_exp_f32 v44, v44
    v_exp_f32 v45, v45
    v_cvt_pk_bf16_f32 v87, v42, v43
    v_exp_f32 v46, v46
    v_exp_f32 v47, v47
    v_mfma_f32_32x32x16_bf16 v[68:83], v[100:103], v[84:87], v[68:83]
    v_cvt_pk_bf16_f32 v88, v44, v45
    v_exp_f32 v48, v48
    v_exp_f32 v49, v49
    v_cvt_pk_bf16_f32 v89, v46, v47
    v_exp_f32 v50, v50
    v_exp_f32 v51, v51
    v_cvt_pk_bf16_f32 v90, v48, v49
    v_cvt_pk_bf16_f32 v91, v50, v51
    v_mfma_f32_32x32x16_bf16 v[36:51], v[96:99], v[16:19], 0
    s_waitcnt lgkmcnt(0)
    v_exp_f32 v20, v20
    v_exp_f32_e64 v21, v21
    v_exp_f32 v22, v22
    v_exp_f32 v23, v23
    v_cvt_pk_bf16_f32 v84, v20, v21
    v_exp_f32 v24, v24
    v_exp_f32 v25, v25
    v_cvt_pk_bf16_f32 v85, v22, v23
    v_mfma_f32_32x32x16_bf16 v[68:83], v[104:107], v[88:91], v[68:83]
    ds_read_b128 v[100:103], v116 offset:0
    ds_read_b128 v[104:107], v116 offset:512
    ds_read_b128 v[96:99], v117 offset:9216
    v_exp_f32 v26, v26
    v_exp_f32 v27, v27
    v_cvt_pk_bf16_f32 v86, v24, v25
    v_exp_f32 v28, v28
    v_exp_f32 v29, v29
    v_cvt_pk_bf16_f32 v87, v26, v27
    v_exp_f32 v30, v30
    v_exp_f32 v31, v31
    v_mfma_f32_32x32x16_bf16 v[52:67], v[108:111], v[84:87], v[52:67]
    v_cvt_pk_bf16_f32 v88, v28, v29
    v_exp_f32 v32, v32
    v_exp_f32 v33, v33
    v_cvt_pk_bf16_f32 v89, v30, v31
    v_exp_f32 v34, v34
    v_exp_f32 v35, v35
    v_cvt_pk_bf16_f32 v90, v32, v33
    v_cvt_pk_bf16_f32 v91, v34, v35
    v_mfma_f32_32x32x16_bf16 v[20:35], v[92:95], v[12:15], 0
    v_exp_f32 v36, v36
    v_exp_f32 v37, v37
    v_exp_f32 v38, v38
    v_exp_f32 v39, v39
    v_cvt_pk_bf16_f32 v84, v36, v37
    v_add_u32 v119, 1, v119
    v_exp_f32 v40, v40
    v_exp_f32_e64 v41, v41
    v_cvt_pk_bf16_f32 v85, v38, v39
    v_mfma_f32_32x32x16_bf16 v[52:67], v[112:115], v[88:91], v[52:67]
    v_exp_f32 v42, v42
    v_exp_f32 v43, v43
    v_cvt_pk_bf16_f32 v86, v40, v41
    v_exp_f32 v44, v44
    v_exp_f32 v45, v45
    v_cvt_pk_bf16_f32 v87, v42, v43
    v_exp_f32 v46, v46
    v_exp_f32 v47, v47
    v_mfma_f32_32x32x16_bf16 v[68:83], v[108:111], v[84:87], v[68:83]
    v_cvt_pk_bf16_f32 v88, v44, v45
    v_exp_f32 v48, v48
    v_exp_f32 v49, v49
    v_cvt_pk_bf16_f32 v89, v46, v47
    v_exp_f32 v50, v50
    v_exp_f32 v51, v51
    v_cvt_pk_bf16_f32 v90, v48, v49
    v_cvt_pk_bf16_f32 v91, v50, v51
    v_mfma_f32_32x32x16_bf16 v[36:51], v[92:95], v[16:19], 0
    s_waitcnt lgkmcnt(0)
    v_exp_f32 v20, v20
    v_exp_f32_e64 v21, v21
    v_exp_f32 v22, v22
    v_exp_f32 v23, v23
    v_cvt_pk_bf16_f32 v84, v20, v21
    v_exp_f32 v24, v24
    v_exp_f32 v25, v25
    v_cvt_pk_bf16_f32 v85, v22, v23
    v_mfma_f32_32x32x16_bf16 v[68:83], v[112:115], v[88:91], v[68:83]
    ds_read_b128 v[108:111], v116 offset:1024
    ds_read_b128 v[112:115], v116 offset:1536
    ds_read_b128 v[92:95], v117 offset:10240
    v_exp_f32 v26, v26
    v_exp_f32 v27, v27
    v_cvt_pk_bf16_f32 v86, v24, v25
    v_exp_f32 v28, v28
    v_exp_f32 v29, v29
    v_cvt_pk_bf16_f32 v87, v26, v27
    v_exp_f32 v30, v30
    v_exp_f32 v31, v31
    v_mfma_f32_32x32x16_bf16 v[52:67], v[100:103], v[84:87], v[52:67]
    v_cvt_pk_bf16_f32 v88, v28, v29
    v_exp_f32 v32, v32
    v_exp_f32 v33, v33
    v_cvt_pk_bf16_f32 v89, v30, v31
    v_exp_f32 v34, v34
    v_exp_f32 v35, v35
    v_cvt_pk_bf16_f32 v90, v32, v33
    v_cvt_pk_bf16_f32 v91, v34, v35
    v_mfma_f32_32x32x16_bf16 v[20:35], v[96:99], v[12:15], 0
    v_exp_f32 v36, v36
    v_exp_f32 v37, v37
    v_exp_f32 v38, v38
    v_exp_f32 v39, v39
    v_cvt_pk_bf16_f32 v84, v36, v37
    v_exp_f32 v40, v40
    v_exp_f32 v41, v41
    v_cvt_pk_bf16_f32 v85, v38, v39
    v_mfma_f32_32x32x16_bf16 v[52:67], v[104:107], v[88:91], v[52:67]
    v_exp_f32 v42, v42
    v_exp_f32 v43, v43
    v_cvt_pk_bf16_f32 v86, v40, v41
    v_exp_f32 v44, v44
    v_exp_f32 v45, v45
    v_cvt_pk_bf16_f32 v87, v42, v43
    v_exp_f32 v46, v46
    v_exp_f32 v47, v47
    v_mfma_f32_32x32x16_bf16 v[68:83], v[100:103], v[84:87], v[68:83]
    v_cvt_pk_bf16_f32 v88, v44, v45
    v_exp_f32 v48, v48
    v_exp_f32 v49, v49
    v_cvt_pk_bf16_f32 v89, v46, v47
    v_exp_f32 v50, v50
    v_exp_f32 v51, v51
    v_cvt_pk_bf16_f32 v90, v48, v49
    v_cvt_pk_bf16_f32 v91, v50, v51
    v_mfma_f32_32x32x16_bf16 v[36:51], v[96:99], v[16:19], 0
    s_waitcnt lgkmcnt(0)
    v_exp_f32 v20, v20
    v_exp_f32_e64 v21, v21
    v_exp_f32 v22, v22
    v_exp_f32 v23, v23
    v_cvt_pk_bf16_f32 v84, v20, v21
    v_exp_f32 v24, v24
    v_exp_f32 v25, v25
    v_cvt_pk_bf16_f32 v85, v22, v23
    v_mfma_f32_32x32x16_bf16 v[68:83], v[104:107], v[88:91], v[68:83]
    ds_read_b128 v[100:103], v116 offset:2048
    ds_read_b128 v[104:107], v116 offset:2560
    ds_read_b128 v[96:99], v117 offset:11264
    v_exp_f32 v26, v26
    v_exp_f32 v27, v27
    v_cvt_pk_bf16_f32 v86, v24, v25
    v_exp_f32 v28, v28
    v_exp_f32 v29, v29
    v_cvt_pk_bf16_f32 v87, v26, v27
    v_exp_f32 v30, v30
    v_exp_f32 v31, v31
    v_mfma_f32_32x32x16_bf16 v[52:67], v[108:111], v[84:87], v[52:67]
    v_cvt_pk_bf16_f32 v88, v28, v29
    v_exp_f32 v32, v32
    v_exp_f32 v33, v33
    v_cvt_pk_bf16_f32 v89, v30, v31
    v_exp_f32 v34, v34
    v_exp_f32 v35, v35
    v_cvt_pk_bf16_f32 v90, v32, v33
    v_cvt_pk_bf16_f32 v91, v34, v35
    v_mfma_f32_32x32x16_bf16 v[20:35], v[92:95], v[12:15], 0
    ds_read_b32 v131, v130 offset:0
    v_exp_f32 v36, v36
    v_exp_f32 v37, v37
    v_exp_f32 v38, v38
    v_exp_f32 v39, v39
    v_cvt_pk_bf16_f32 v84, v36, v37
    v_exp_f32 v40, v40
    v_exp_f32 v41, v41
    v_cvt_pk_bf16_f32 v85, v38, v39
    v_mfma_f32_32x32x16_bf16 v[52:67], v[112:115], v[88:91], v[52:67]
    v_exp_f32 v42, v42
    v_exp_f32 v43, v43
    v_cvt_pk_bf16_f32 v86, v40, v41
    v_exp_f32 v44, v44
    v_exp_f32 v45, v45
    v_cvt_pk_bf16_f32 v87, v42, v43
    v_exp_f32 v46, v46
    v_exp_f32 v47, v47
    v_mfma_f32_32x32x16_bf16 v[68:83], v[108:111], v[84:87], v[68:83]
    v_cvt_pk_bf16_f32 v88, v44, v45
    v_exp_f32 v48, v48
    v_exp_f32 v49, v49
    v_cvt_pk_bf16_f32 v89, v46, v47
    v_exp_f32 v50, v50
    v_exp_f32 v51, v51
    v_cvt_pk_bf16_f32 v90, v48, v49
    v_cvt_pk_bf16_f32 v91, v50, v51
    v_mfma_f32_32x32x16_bf16 v[36:51], v[92:95], v[16:19], 0
    s_waitcnt lgkmcnt(0)
    v_exp_f32 v20, v20
    v_exp_f32_e64 v21, v21
L_kw71:
    v_cmp_gt_u32 vcc, 4, v131
    s_cbranch_vccz L_ko72
    ds_read_b32 v131, v130 offset:0
    s_waitcnt lgkmcnt(0)
    s_branch L_kw71
L_ko72:
    v_exp_f32 v22, v22
    v_exp_f32 v23, v23
    v_cvt_pk_bf16_f32 v84, v20, v21
    v_exp_f32 v24, v24
    v_exp_f32 v25, v25
    v_cvt_pk_bf16_f32 v85, v22, v23
    v_mfma_f32_32x32x16_bf16 v[68:83], v[112:115], v[88:91], v[68:83]
    ds_read_b128 v[108:111], v116 offset:3072
    ds_read_b128 v[112:115], v116 offset:3584
    ds_read_b128 v[92:95], v117 offset:16384
    v_exp_f32 v26, v26
    v_exp_f32 v27, v27
    v_cvt_pk_bf16_f32 v86, v24, v25
    v_exp_f32 v28, v28
    v_exp_f32 v29, v29
    v_cvt_pk_bf16_f32 v87, v26, v27
    v_exp_f32 v30, v30
    v_exp_f32 v31, v31
    v_mfma_f32_32x32x16_bf16 v[52:67], v[100:103], v[84:87], v[52:67]
    v_cvt_pk_bf16_f32 v88, v28, v29
    v_exp_f32 v32, v32
    v_exp_f32 v33, v33
    v_cvt_pk_bf16_f32 v89, v30, v31
    v_exp_f32 v34, v34
    v_exp_f32 v35, v35
    v_cvt_pk_bf16_f32 v90, v32, v33
    v_cvt_pk_bf16_f32 v91, v34, v35
    v_mfma_f32_32x32x16_bf16 v[20:35], v[96:99], v[12:15], 0
    v_exp_f32 v36, v36
    v_exp_f32 v37, v37
    v_exp_f32 v38, v38
    v_exp_f32 v39, v39
    v_cvt_pk_bf16_f32 v84, v36, v37
    v_add_u32 v116, v118, v116
    v_exp_f32 v40, v40
    v_exp_f32_e64 v41, v41
    v_cvt_pk_bf16_f32 v85, v38, v39
    v_mfma_f32_32x32x16_bf16 v[52:67], v[104:107], v[88:91], v[52:67]
    v_exp_f32 v42, v42
    v_exp_f32 v43, v43
    v_cvt_pk_bf16_f32 v86, v40, v41
    v_exp_f32 v44, v44
    v_exp_f32 v45, v45
    v_cvt_pk_bf16_f32 v87, v42, v43
    v_exp_f32 v46, v46
    v_exp_f32 v47, v47
    v_mfma_f32_32x32x16_bf16 v[68:83], v[100:103], v[84:87], v[68:83]
    v_cvt_pk_bf16_f32 v88, v44, v45
    v_exp_f32 v48, v48
    v_exp_f32 v49, v49
    v_cvt_pk_bf16_f32 v89, v46, v47
    v_exp_f32 v50, v50
    v_exp_f32 v51, v51
    v_cvt_pk_bf16_f32 v90, v48, v49
    v_cvt_pk_bf16_f32 v91, v50, v51
    v_mfma_f32_32x32x16_bf16 v[36:51], v[96:99], v[16:19], 0
    s_waitcnt lgkmcnt(0)
    v_exp_f32 v20, v20
    v_exp_f32_e64 v21, v21
    v_exp_f32 v22, v22
    v_exp_f32 v23, v23
    v_cvt_pk_bf16_f32 v84, v20, v21
    v_exp_f32 v24, v24
    v_exp_f32 v25, v25
    v_cvt_pk_bf16_f32 v85, v22, v23
    v_mfma_f32_32x32x16_bf16 v[68:83], v[104:107], v[88:91], v[68:83]
    ds_read_b128 v[100:103], v116 offset:0
    ds_read_b128 v[104:107], v116 offset:512
    ds_read_b128 v[96:99], v117 offset:17408
    v_exp_f32 v26, v26
    v_exp_f32 v27, v27
    v_cvt_pk_bf16_f32 v86, v24, v25
    v_exp_f32 v28, v28
    v_exp_f32 v29, v29
    v_cvt_pk_bf16_f32 v87, v26, v27
    v_exp_f32 v30, v30
    v_exp_f32 v31, v31
    v_mfma_f32_32x32x16_bf16 v[52:67], v[108:111], v[84:87], v[52:67]
    v_cvt_pk_bf16_f32 v88, v28, v29
    v_exp_f32 v32, v32
    v_exp_f32 v33, v33
    v_cvt_pk_bf16_f32 v89, v30, v31
    v_exp_f32 v34, v34
    v_exp_f32 v35, v35
    v_cvt_pk_bf16_f32 v90, v32, v33
    v_cvt_pk_bf16_f32 v91, v34, v35
    v_mfma_f32_32x32x16_bf16 v[20:35], v[92:95], v[12:15], 0
    v_exp_f32 v36, v36
    v_exp_f32 v37, v37
    v_exp_f32 v38, v38
    v_exp_f32 v39, v39
    v_cvt_pk_bf16_f32 v84, v36, v37
    v_add_u32 v119, 1, v119
    v_exp_f32 v40, v40
    v_exp_f32_e64 v41, v41
    v_cvt_pk_bf16_f32 v85, v38, v39
    v_mfma_f32_32x32x16_bf16 v[52:67], v[112:115], v[88:91], v[52:67]
    v_exp_f32 v42, v42
    v_exp_f32 v43, v43
    v_cvt_pk_bf16_f32 v86, v40, v41
    v_exp_f32 v44, v44
    v_exp_f32 v45, v45
    v_cvt_pk_bf16_f32 v87, v42, v43
    v_add_u32 v117, 0x4000, v117
    v_exp_f32 v46, v46
    v_exp_f32 v47, v47
    v_mfma_f32_32x32x16_bf16 v[68:83], v[108:111], v[84:87], v[68:83]
    v_cvt_pk_bf16_f32 v88, v44, v45
    v_exp_f32 v48, v48
    v_exp_f32 v49, v49
    v_cvt_pk_bf16_f32 v89, v46, v47
    v_exp_f32 v50, v50
    v_exp_f32 v51, v51
    v_cvt_pk_bf16_f32 v90, v48, v49
    v_cvt_pk_bf16_f32 v91, v50, v51
    v_mfma_f32_32x32x16_bf16 v[36:51], v[92:95], v[16:19], 0
    s_waitcnt lgkmcnt(0)
    v_exp_f32 v20, v20
    v_exp_f32_e64 v21, v21
    v_exp_f32 v22, v22
    v_exp_f32 v23, v23
    v_cvt_pk_bf16_f32 v84, v20, v21
    v_exp_f32 v24, v24
    v_exp_f32 v25, v25
    v_cvt_pk_bf16_f32 v85, v22, v23
    v_mfma_f32_32x32x16_bf16 v[68:83], v[112:115], v[88:91], v[68:83]
    ds_read_b128 v[108:111], v116 offset:1024
    ds_read_b128 v[112:115], v116 offset:1536
    ds_read_b128 v[92:95], v117 offset:2048
    v_exp_f32 v26, v26
    v_exp_f32 v27, v27
    v_cvt_pk_bf16_f32 v86, v24, v25
    v_exp_f32 v28, v28
    v_exp_f32 v29, v29
    v_cvt_pk_bf16_f32 v87, v26, v27
    v_exp_f32 v30, v30
    v_exp_f32 v31, v31
    v_mfma_f32_32x32x16_bf16 v[52:67], v[100:103], v[84:87], v[52:67]
    v_cvt_pk_bf16_f32 v88, v28, v29
    v_exp_f32 v32, v32
    v_exp_f32 v33, v33
    v_cvt_pk_bf16_f32 v89, v30, v31
    v_exp_f32 v34, v34
    v_exp_f32 v35, v35
    v_cvt_pk_bf16_f32 v90, v32, v33
    v_cvt_pk_bf16_f32 v91, v34, v35
    v_mfma_f32_32x32x16_bf16 v[20:35], v[96:99], v[12:15], 0
    v_exp_f32 v36, v36
    v_exp_f32 v37, v37
    v_exp_f32 v38, v38
    v_exp_f32 v39, v39
    v_cvt_pk_bf16_f32 v84, v36, v37
    v_exp_f32 v40, v40
    v_exp_f32 v41, v41
    v_cvt_pk_bf16_f32 v85, v38, v39
    v_mfma_f32_32x32x16_bf16 v[52:67], v[104:107], v[88:91], v[52:67]
    v_exp_f32 v42, v42
    v_exp_f32 v43, v43
    v_cvt_pk_bf16_f32 v86, v40, v41
    v_exp_f32 v44, v44
    v_exp_f32 v45, v45
    v_cvt_pk_bf16_f32 v87, v42, v43
    v_exp_f32 v46, v46
    v_exp_f32 v47, v47
    v_mfma_f32_32x32x16_bf16 v[68:83], v[100:103], v[84:87], v[68:83]
    v_cvt_pk_bf16_f32 v88, v44, v45
    v_exp_f32 v48, v48
    v_exp_f32 v49, v49
    v_cvt_pk_bf16_f32 v89, v46, v47
    v_exp_f32 v50, v50
    v_exp_f32 v51, v51
    v_cvt_pk_bf16_f32 v90, v48, v49
    v_cvt_pk_bf16_f32 v91, v50, v51
    v_mfma_f32_32x32x16_bf16 v[36:51], v[96:99], v[16:19], 0
    s_waitcnt lgkmcnt(0)
    v_exp_f32 v20, v20
    v_exp_f32_e64 v21, v21
    v_exp_f32 v22, v22
    v_exp_f32 v23, v23
    v_cvt_pk_bf16_f32 v84, v20, v21
    v_exp_f32 v24, v24
    v_exp_f32 v25, v25
    v_cvt_pk_bf16_f32 v85, v22, v23
    v_mfma_f32_32x32x16_bf16 v[68:83], v[104:107], v[88:91], v[68:83]
    ds_read_b128 v[100:103], v116 offset:2048
    ds_read_b128 v[104:107], v116 offset:2560
    ds_read_b128 v[96:99], v117 offset:3072
    v_exp_f32 v26, v26
    v_exp_f32 v27, v27
    v_cvt_pk_bf16_f32 v86, v24, v25
    v_exp_f32 v28, v28
    v_exp_f32 v29, v29
    v_cvt_pk_bf16_f32 v87, v26, v27
    v_exp_f32 v30, v30
    v_exp_f32 v31, v31
    v_mfma_f32_32x32x16_bf16 v[52:67], v[108:111], v[84:87], v[52:67]
    v_cvt_pk_bf16_f32 v88, v28, v29
    v_exp_f32 v32, v32
    v_exp_f32 v33, v33
    v_cvt_pk_bf16_f32 v89, v30, v31
    v_exp_f32 v34, v34
    v_exp_f32 v35, v35
    v_cvt_pk_bf16_f32 v90, v32, v33
    v_cvt_pk_bf16_f32 v91, v34, v35
    v_mfma_f32_32x32x16_bf16 v[20:35], v[92:95], v[12:15], 0
    v_exp_f32 v36, v36
    v_exp_f32 v37, v37
    v_exp_f32 v38, v38
    v_exp_f32 v39, v39
    v_cvt_pk_bf16_f32 v84, v36, v37
    v_exp_f32 v40, v40
    v_exp_f32 v41, v41
    v_cvt_pk_bf16_f32 v85, v38, v39
    v_mfma_f32_32x32x16_bf16 v[52:67], v[112:115], v[88:91], v[52:67]
    v_exp_f32 v42, v42
    v_exp_f32 v43, v43
    v_cvt_pk_bf16_f32 v86, v40, v41
    v_exp_f32 v44, v44
    v_exp_f32 v45, v45
    v_cvt_pk_bf16_f32 v87, v42, v43
    v_exp_f32 v46, v46
    v_exp_f32 v47, v47
    v_mfma_f32_32x32x16_bf16 v[68:83], v[108:111], v[84:87], v[68:83]
    v_cvt_pk_bf16_f32 v88, v44, v45
    v_exp_f32 v48, v48
    v_exp_f32 v49, v49
    v_cvt_pk_bf16_f32 v89, v46, v47
    v_exp_f32 v50, v50
    v_exp_f32 v51, v51
    v_cvt_pk_bf16_f32 v90, v48, v49
    v_cvt_pk_bf16_f32 v91, v50, v51
    v_mfma_f32_32x32x16_bf16 v[36:51], v[92:95], v[16:19], 0
    s_waitcnt lgkmcnt(0)
    v_exp_f32 v20, v20
    v_exp_f32_e64 v21, v21
    v_exp_f32 v22, v22
    v_exp_f32 v23, v23
    v_cvt_pk_bf16_f32 v84, v20, v21
    v_exp_f32 v24, v24
    v_exp_f32 v25, v25
    v_cvt_pk_bf16_f32 v85, v22, v23
    v_mfma_f32_32x32x16_bf16 v[68:83], v[112:115], v[88:91], v[68:83]
    ds_read_b128 v[108:111], v116 offset:3072
    ds_read_b128 v[112:115], v116 offset:3584
    ds_read_b128 v[92:95], v117 offset:8192
    v_exp_f32 v26, v26
    v_exp_f32 v27, v27
    v_cvt_pk_bf16_f32 v86, v24, v25
    v_exp_f32 v28, v28
    v_exp_f32 v29, v29
    v_cvt_pk_bf16_f32 v87, v26, v27
    v_exp_f32 v30, v30
    v_exp_f32 v31, v31
    v_mfma_f32_32x32x16_bf16 v[52:67], v[100:103], v[84:87], v[52:67]
    v_cvt_pk_bf16_f32 v88, v28, v29
    v_exp_f32 v32, v32
    v_exp_f32 v33, v33
    v_cvt_pk_bf16_f32 v89, v30, v31
    v_exp_f32 v34, v34
    v_exp_f32 v35, v35
    v_cvt_pk_bf16_f32 v90, v32, v33
    v_cvt_pk_bf16_f32 v91, v34, v35
    v_mfma_f32_32x32x16_bf16 v[20:35], v[96:99], v[12:15], 0
    v_exp_f32 v36, v36
    v_exp_f32 v37, v37
    v_exp_f32 v38, v38
    v_exp_f32 v39, v39
    v_cvt_pk_bf16_f32 v84, v36, v37
    v_add_u32 v116, v118, v116
    v_exp_f32 v40, v40
    v_exp_f32_e64 v41, v41
    v_cvt_pk_bf16_f32 v85, v38, v39
    v_mfma_f32_32x32x16_bf16 v[52:67], v[104:107], v[88:91], v[52:67]
    v_exp_f32 v42, v42
    v_exp_f32 v43, v43
    v_cvt_pk_bf16_f32 v86, v40, v41
    v_exp_f32 v44, v44
    v_exp_f32 v45, v45
    v_cvt_pk_bf16_f32 v87, v42, v43
    v_exp_f32 v46, v46
    v_exp_f32 v47, v47
    v_mfma_f32_32x32x16_bf16 v[68:83], v[100:103], v[84:87], v[68:83]
    v_cvt_pk_bf16_f32 v88, v44, v45
    v_exp_f32 v48, v48
    v_exp_f32 v49, v49
    v_cvt_pk_bf16_f32 v89, v46, v47
    v_exp_f32 v50, v50
    v_exp_f32 v51, v51
    v_cvt_pk_bf16_f32 v90, v48, v49
    v_cvt_pk_bf16_f32 v91, v50, v51
    v_mfma_f32_32x32x16_bf16 v[36:51], v[96:99], v[16:19], 0
    s_waitcnt lgkmcnt(0)
    v_exp_f32 v20, v20
    v_exp_f32_e64 v21, v21
    v_exp_f32 v22, v22
    v_exp_f32 v23, v23
    v_cvt_pk_bf16_f32 v84, v20, v21
    v_exp_f32 v24, v24
    v_exp_f32 v25, v25
    v_cvt_pk_bf16_f32 v85, v22, v23
    v_mfma_f32_32x32x16_bf16 v[68:83], v[104:107], v[88:91], v[68:83]
    ds_read_b128 v[100:103], v116 offset:0
    ds_read_b128 v[104:107], v116 offset:512
    ds_read_b128 v[96:99], v117 offset:9216
    v_exp_f32 v26, v26
    v_exp_f32 v27, v27
    v_cvt_pk_bf16_f32 v86, v24, v25
    v_exp_f32 v28, v28
    v_exp_f32 v29, v29
    v_cvt_pk_bf16_f32 v87, v26, v27
    v_exp_f32 v30, v30
    v_exp_f32 v31, v31
    v_mfma_f32_32x32x16_bf16 v[52:67], v[108:111], v[84:87], v[52:67]
    v_cvt_pk_bf16_f32 v88, v28, v29
    v_exp_f32 v32, v32
    v_exp_f32 v33, v33
    v_cvt_pk_bf16_f32 v89, v30, v31
    v_exp_f32 v34, v34
    v_exp_f32 v35, v35
    v_cvt_pk_bf16_f32 v90, v32, v33
    v_cvt_pk_bf16_f32 v91, v34, v35
    v_mfma_f32_32x32x16_bf16 v[20:35], v[92:95], v[12:15], 0
    v_exp_f32 v36, v36
    v_exp_f32 v37, v37
    v_exp_f32 v38, v38
    v_exp_f32 v39, v39
    v_cvt_pk_bf16_f32 v84, v36, v37
    v_add_u32 v119, 1, v119
    v_exp_f32 v40, v40
    v_exp_f32_e64 v41, v41
    v_cvt_pk_bf16_f32 v85, v38, v39
    v_mfma_f32_32x32x16_bf16 v[52:67], v[112:115], v[88:91], v[52:67]
    v_exp_f32 v42, v42
    v_exp_f32 v43, v43
    v_cvt_pk_bf16_f32 v86, v40, v41
    v_exp_f32 v44, v44
    v_exp_f32 v45, v45
    v_cvt_pk_bf16_f32 v87, v42, v43
    v_exp_f32 v46, v46
    v_exp_f32 v47, v47
    v_mfma_f32_32x32x16_bf16 v[68:83], v[108:111], v[84:87], v[68:83]
    v_cvt_pk_bf16_f32 v88, v44, v45
    v_exp_f32 v48, v48
    v_exp_f32 v49, v49
    v_cvt_pk_bf16_f32 v89, v46, v47
    v_exp_f32 v50, v50
    v_exp_f32 v51, v51
    v_cvt_pk_bf16_f32 v90, v48, v49
    v_cvt_pk_bf16_f32 v91, v50, v51
    v_mfma_f32_32x32x16_bf16 v[36:51], v[92:95], v[16:19], 0
    s_waitcnt lgkmcnt(0)
    v_exp_f32 v20, v20
    v_exp_f32_e64 v21, v21
    v_exp_f32 v22, v22
    v_exp_f32 v23, v23
    v_cvt_pk_bf16_f32 v84, v20, v21
    v_exp_f32 v24, v24
    v_exp_f32 v25, v25
    v_cvt_pk_bf16_f32 v85, v22, v23
    v_mfma_f32_32x32x16_bf16 v[68:83], v[112:115], v[88:91], v[68:83]
    ds_read_b128 v[108:111], v116 offset:1024
    ds_read_b128 v[112:115], v116 offset:1536
    ds_read_b128 v[92:95], v117 offset:10240
    v_exp_f32 v26, v26
    v_exp_f32 v27, v27
    v_cvt_pk_bf16_f32 v86, v24, v25
    v_exp_f32 v28, v28
    v_exp_f32 v29, v29
    v_cvt_pk_bf16_f32 v87, v26, v27
    v_exp_f32 v30, v30
    v_exp_f32 v31, v31
    v_mfma_f32_32x32x16_bf16 v[52:67], v[100:103], v[84:87], v[52:67]
    v_cvt_pk_bf16_f32 v88, v28, v29
    v_exp_f32 v32, v32
    v_exp_f32 v33, v33
    v_cvt_pk_bf16_f32 v89, v30, v31
    v_exp_f32 v34, v34
    v_exp_f32 v35, v35
    v_cvt_pk_bf16_f32 v90, v32, v33
    v_cvt_pk_bf16_f32 v91, v34, v35
    v_mfma_f32_32x32x16_bf16 v[20:35], v[96:99], v[12:15], 0
    v_exp_f32 v36, v36
    v_exp_f32 v37, v37
    v_exp_f32 v38, v38
    v_exp_f32 v39, v39
    v_cvt_pk_bf16_f32 v84, v36, v37
    v_exp_f32 v40, v40
    v_exp_f32 v41, v41
    v_cvt_pk_bf16_f32 v85, v38, v39
    v_mfma_f32_32x32x16_bf16 v[52:67], v[104:107], v[88:91], v[52:67]
    v_exp_f32 v42, v42
    v_exp_f32 v43, v43
    v_cvt_pk_bf16_f32 v86, v40, v41
    v_exp_f32 v44, v44
    v_exp_f32 v45, v45
    v_cvt_pk_bf16_f32 v87, v42, v43
    v_exp_f32 v46, v46
    v_exp_f32 v47, v47
    v_mfma_f32_32x32x16_bf16 v[68:83], v[100:103], v[84:87], v[68:83]
    v_cvt_pk_bf16_f32 v88, v44, v45
    v_exp_f32 v48, v48
    v_exp_f32 v49, v49
    v_cvt_pk_bf16_f32 v89, v46, v47
    v_exp_f32 v50, v50
    v_exp_f32 v51, v51
    v_cvt_pk_bf16_f32 v90, v48, v49
    v_cvt_pk_bf16_f32 v91, v50, v51
    v_mfma_f32_32x32x16_bf16 v[36:51], v[96:99], v[16:19], 0
    s_waitcnt lgkmcnt(0)
    v_exp_f32 v20, v20
    v_exp_f32_e64 v21, v21
    v_exp_f32 v22, v22
    v_exp_f32 v23, v23
    v_cvt_pk_bf16_f32 v84, v20, v21
    v_exp_f32 v24, v24
    v_exp_f32 v25, v25
    v_cvt_pk_bf16_f32 v85, v22, v23
    v_mfma_f32_32x32x16_bf16 v[68:83], v[104:107], v[88:91], v[68:83]
    ds_read_b128 v[100:103], v116 offset:2048
    ds_read_b128 v[104:107], v116 offset:2560
    ds_read_b128 v[96:99], v117 offset:11264
    v_exp_f32 v26, v26
    v_exp_f32 v27, v27
    v_cvt_pk_bf16_f32 v86, v24, v25
    v_exp_f32 v28, v28
    v_exp_f32 v29, v29
    v_cvt_pk_bf16_f32 v87, v26, v27
    v_exp_f32 v30, v30
    v_exp_f32 v31, v31
    v_mfma_f32_32x32x16_bf16 v[52:67], v[108:111], v[84:87], v[52:67]
    v_cvt_pk_bf16_f32 v88, v28, v29
    v_exp_f32 v32, v32
    v_exp_f32 v33, v33
    v_cvt_pk_bf16_f32 v89, v30, v31
    v_exp_f32 v34, v34
    v_exp_f32 v35, v35
    v_cvt_pk_bf16_f32 v90, v32, v33
    v_cvt_pk_bf16_f32 v91, v34, v35
    v_mfma_f32_32x32x16_bf16 v[20:35], v[92:95], v[12:15], 0
    ds_read_b32 v131, v130 offset:4
    v_exp_f32 v36, v36
    v_exp_f32 v37, v37
    v_exp_f32 v38, v38
    v_exp_f32 v39, v39
    v_cvt_pk_bf16_f32 v84, v36, v37
    v_exp_f32 v40, v40
    v_exp_f32 v41, v41
    v_cvt_pk_bf16_f32 v85, v38, v39
    v_mfma_f32_32x32x16_bf16 v[52:67], v[112:115], v[88:91], v[52:67]
    v_exp_f32 v42, v42
    v_exp_f32 v43, v43
    v_cvt_pk_bf16_f32 v86, v40, v41
    v_exp_f32 v44, v44
    v_exp_f32 v45, v45
    v_cvt_pk_bf16_f32 v87, v42, v43
    v_exp_f32 v46, v46
    v_exp_f32 v47, v47
    v_mfma_f32_32x32x16_bf16 v[68:83], v[108:111], v[84:87], v[68:83]
    v_cvt_pk_bf16_f32 v88, v44, v45
    v_exp_f32 v48, v48
    v_exp_f32 v49, v49
    v_cvt_pk_bf16_f32 v89, v46, v47
    v_exp_f32 v50, v50
    v_exp_f32 v51, v51
    v_cvt_pk_bf16_f32 v90, v48, v49
    v_cvt_pk_bf16_f32 v91, v50, v51
    v_mfma_f32_32x32x16_bf16 v[36:51], v[92:95], v[16:19], 0
    s_waitcnt lgkmcnt(0)
    v_exp_f32 v20, v20
    v_exp_f32_e64 v21, v21
L_kw73:
    v_cmp_gt_u32 vcc, 4, v131
    s_cbranch_vccz L_ko74
    ds_read_b32 v131, v130 offset:4
    s_waitcnt lgkmcnt(0)
    s_branch L_kw73
L_ko74:
    v_exp_f32 v22, v22
    v_exp_f32 v23, v23
    v_cvt_pk_bf16_f32 v84, v20, v21
    v_exp_f32 v24, v24
    v_exp_f32 v25, v25
    v_cvt_pk_bf16_f32 v85, v22, v23
    v_mfma_f32_32x32x16_bf16 v[68:83], v[112:115], v[88:91], v[68:83]
    ds_read_b128 v[108:111], v116 offset:3072
    ds_read_b128 v[112:115], v116 offset:3584
    ds_read_b128 v[92:95], v117 offset:16384
    v_exp_f32 v26, v26
    v_exp_f32 v27, v27
    v_cvt_pk_bf16_f32 v86, v24, v25
    v_exp_f32 v28, v28
    v_exp_f32 v29, v29
    v_cvt_pk_bf16_f32 v87, v26, v27
    v_exp_f32 v30, v30
    v_exp_f32 v31, v31
    v_mfma_f32_32x32x16_bf16 v[52:67], v[100:103], v[84:87], v[52:67]
    v_cvt_pk_bf16_f32 v88, v28, v29
    v_exp_f32 v32, v32
    v_exp_f32 v33, v33
    v_cvt_pk_bf16_f32 v89, v30, v31
    v_exp_f32 v34, v34
    v_exp_f32 v35, v35
    v_cvt_pk_bf16_f32 v90, v32, v33
    v_cvt_pk_bf16_f32 v91, v34, v35
    v_mfma_f32_32x32x16_bf16 v[20:35], v[96:99], v[12:15], 0
    v_exp_f32 v36, v36
    v_exp_f32 v37, v37
    v_exp_f32 v38, v38
    v_exp_f32 v39, v39
    v_cvt_pk_bf16_f32 v84, v36, v37
    v_add_u32 v116, v118, v116
    v_exp_f32 v40, v40
    v_exp_f32_e64 v41, v41
    v_cvt_pk_bf16_f32 v85, v38, v39
    v_mfma_f32_32x32x16_bf16 v[52:67], v[104:107], v[88:91], v[52:67]
    v_exp_f32 v42, v42
    v_exp_f32 v43, v43
    v_cvt_pk_bf16_f32 v86, v40, v41
    v_exp_f32 v44, v44
    v_exp_f32 v45, v45
    v_cvt_pk_bf16_f32 v87, v42, v43
    v_exp_f32 v46, v46
    v_exp_f32 v47, v47
    v_mfma_f32_32x32x16_bf16 v[68:83], v[100:103], v[84:87], v[68:83]
    v_cvt_pk_bf16_f32 v88, v44, v45
    v_exp_f32 v48, v48
    v_exp_f32 v49, v49
    v_cvt_pk_bf16_f32 v89, v46, v47
    v_exp_f32 v50, v50
    v_exp_f32 v51, v51
    v_cvt_pk_bf16_f32 v90, v48, v49
    v_cvt_pk_bf16_f32 v91, v50, v51
    v_mfma_f32_32x32x16_bf16 v[36:51], v[96:99], v[16:19], 0
    s_waitcnt lgkmcnt(0)
    v_exp_f32 v20, v20
    v_exp_f32_e64 v21, v21
    v_exp_f32 v22, v22
    v_exp_f32 v23, v23
    v_cvt_pk_bf16_f32 v84, v20, v21
    v_exp_f32 v24, v24
    v_exp_f32 v25, v25
    v_cvt_pk_bf16_f32 v85, v22, v23
    v_mfma_f32_32x32x16_bf16 v[68:83], v[104:107], v[88:91], v[68:83]
    ds_read_b128 v[100:103], v116 offset:0
    ds_read_b128 v[104:107], v116 offset:512
    ds_read_b128 v[96:99], v117 offset:17408
    v_exp_f32 v26, v26
    v_exp_f32 v27, v27
    v_cvt_pk_bf16_f32 v86, v24, v25
    v_exp_f32 v28, v28
    v_exp_f32 v29, v29
    v_cvt_pk_bf16_f32 v87, v26, v27
    v_exp_f32 v30, v30
    v_exp_f32 v31, v31
    v_mfma_f32_32x32x16_bf16 v[52:67], v[108:111], v[84:87], v[52:67]
    v_cvt_pk_bf16_f32 v88, v28, v29
    v_exp_f32 v32, v32
    v_exp_f32 v33, v33
    v_cvt_pk_bf16_f32 v89, v30, v31
    v_exp_f32 v34, v34
    v_exp_f32 v35, v35
    v_cvt_pk_bf16_f32 v90, v32, v33
    v_cvt_pk_bf16_f32 v91, v34, v35
    v_mfma_f32_32x32x16_bf16 v[20:35], v[92:95], v[12:15], 0
    v_exp_f32 v36, v36
    v_exp_f32 v37, v37
    v_exp_f32 v38, v38
    v_exp_f32 v39, v39
    v_cvt_pk_bf16_f32 v84, v36, v37
    v_add_u32 v119, 1, v119
    v_exp_f32 v40, v40
    v_exp_f32_e64 v41, v41
    v_cvt_pk_bf16_f32 v85, v38, v39
    v_mfma_f32_32x32x16_bf16 v[52:67], v[112:115], v[88:91], v[52:67]
    v_exp_f32 v42, v42
    v_exp_f32 v43, v43
    v_cvt_pk_bf16_f32 v86, v40, v41
    v_exp_f32 v44, v44
    v_exp_f32 v45, v45
    v_cvt_pk_bf16_f32 v87, v42, v43
    v_add_u32 v117, 0x4000, v117
    v_exp_f32 v46, v46
    v_exp_f32 v47, v47
    v_mfma_f32_32x32x16_bf16 v[68:83], v[108:111], v[84:87], v[68:83]
    v_cvt_pk_bf16_f32 v88, v44, v45
    v_exp_f32 v48, v48
    v_exp_f32 v49, v49
    v_cvt_pk_bf16_f32 v89, v46, v47
    v_exp_f32 v50, v50
    v_exp_f32 v51, v51
    v_cvt_pk_bf16_f32 v90, v48, v49
    v_cvt_pk_bf16_f32 v91, v50, v51
    s_mov_b32 s34, 0
.p2align 6
L_alp75:
    v_mfma_f32_32x32x16_bf16 v[36:51], v[92:95], v[16:19], 0
    s_waitcnt lgkmcnt(0)
    v_exp_f32 v20, v20
    v_exp_f32_e64 v21, v21
    v_exp_f32 v22, v22
    v_exp_f32 v23, v23
    v_cvt_pk_bf16_f32 v84, v20, v21
    v_exp_f32 v24, v24
    v_exp_f32 v25, v25
    v_cvt_pk_bf16_f32 v85, v22, v23
    v_mfma_f32_32x32x16_bf16 v[68:83], v[112:115], v[88:91], v[68:83]
    ds_read_b128 v[108:111], v116 offset:1024
    ds_read_b128 v[112:115], v116 offset:1536
    ds_read_b128 v[92:95], v117 offset:2048
    v_exp_f32 v26, v26
    v_exp_f32 v27, v27
    v_cvt_pk_bf16_f32 v86, v24, v25
    v_exp_f32 v28, v28
    v_exp_f32 v29, v29
    v_cvt_pk_bf16_f32 v87, v26, v27
    v_exp_f32 v30, v30
    v_exp_f32 v31, v31
    v_mfma_f32_32x32x16_bf16 v[52:67], v[100:103], v[84:87], v[52:67]
    v_cvt_pk_bf16_f32 v88, v28, v29
    v_exp_f32 v32, v32
    v_exp_f32 v33, v33
    v_cvt_pk_bf16_f32 v89, v30, v31
    v_exp_f32 v34, v34
    v_exp_f32 v35, v35
    v_cvt_pk_bf16_f32 v90, v32, v33
    v_cvt_pk_bf16_f32 v91, v34, v35
    v_mfma_f32_32x32x16_bf16 v[20:35], v[96:99], v[12:15], 0
    v_exp_f32 v36, v36
    v_exp_f32 v37, v37
    v_exp_f32 v38, v38
    v_exp_f32 v39, v39
    v_cvt_pk_bf16_f32 v84, v36, v37
    v_exp_f32 v40, v40
    v_exp_f32 v41, v41
    v_cvt_pk_bf16_f32 v85, v38, v39
    v_mfma_f32_32x32x16_bf16 v[52:67], v[104:107], v[88:91], v[52:67]
    ds_write_b32 v129, v119
    v_exp_f32 v42, v42
    v_exp_f32 v43, v43
    v_cvt_pk_bf16_f32 v86, v40, v41
    v_exp_f32 v44, v44
    v_exp_f32 v45, v45
    v_cvt_pk_bf16_f32 v87, v42, v43
    v_exp_f32 v46, v46
    v_exp_f32 v47, v47
    v_mfma_f32_32x32x16_bf16 v[68:83], v[100:103], v[84:87], v[68:83]
    v_cvt_pk_bf16_f32 v88, v44, v45
    v_exp_f32 v48, v48
    v_exp_f32 v49, v49
    v_cvt_pk_bf16_f32 v89, v46, v47
    v_exp_f32 v50, v50
    v_exp_f32 v51, v51
    v_cvt_pk_bf16_f32 v90, v48, v49
    v_cvt_pk_bf16_f32 v91, v50, v51
    v_mfma_f32_32x32x16_bf16 v[36:51], v[96:99], v[16:19], 0
    s_waitcnt lgkmcnt(0)
    v_exp_f32 v20, v20
    v_exp_f32_e64 v21, v21
    v_exp_f32 v22, v22
    v_exp_f32 v23, v23
    v_cvt_pk_bf16_f32 v84, v20, v21
    v_exp_f32 v24, v24
    v_exp_f32 v25, v25
    v_cvt_pk_bf16_f32 v85, v22, v23
    v_mfma_f32_32x32x16_bf16 v[68:83], v[104:107], v[88:91], v[68:83]
    ds_read_b128 v[100:103], v116 offset:2048
    ds_read_b128 v[104:107], v116 offset:2560
    ds_read_b128 v[96:99], v117 offset:3072
    v_exp_f32 v26, v26
    v_exp_f32 v27, v27
    v_cvt_pk_bf16_f32 v86, v24, v25
    v_exp_f32 v28, v28
    v_exp_f32 v29, v29
    v_cvt_pk_bf16_f32 v87, v26, v27
    v_exp_f32 v30, v30
    v_exp_f32 v31, v31
    v_mfma_f32_32x32x16_bf16 v[52:67], v[108:111], v[84:87], v[52:67]
    v_cvt_pk_bf16_f32 v88, v28, v29
    v_exp_f32 v32, v32
    v_exp_f32 v33, v33
    v_cvt_pk_bf16_f32 v89, v30, v31
    v_exp_f32 v34, v34
    v_exp_f32 v35, v35
    v_cvt_pk_bf16_f32 v90, v32, v33
    v_cvt_pk_bf16_f32 v91, v34, v35
    v_mfma_f32_32x32x16_bf16 v[20:35], v[92:95], v[12:15], 0
    v_exp_f32 v36, v36
    v_exp_f32 v37, v37
    v_exp_f32 v38, v38
    v_exp_f32 v39, v39
    v_cvt_pk_bf16_f32 v84, v36, v37
    v_exp_f32 v40, v40
    v_exp_f32 v41, v41
    v_cvt_pk_bf16_f32 v85, v38, v39
    v_mfma_f32_32x32x16_bf16 v[52:67], v[112:115], v[88:91], v[52:67]
    v_exp_f32 v42, v42
    v_exp_f32 v43, v43
    v_cvt_pk_bf16_f32 v86, v40, v41
    v_exp_f32 v44, v44
    v_exp_f32 v45, v45
    v_cvt_pk_bf16_f32 v87, v42, v43
    v_exp_f32 v46, v46
    v_exp_f32 v47, v47
    v_mfma_f32_32x32x16_bf16 v[68:83], v[108:111], v[84:87], v[68:83]
    v_cvt_pk_bf16_f32 v88, v44, v45
    v_exp_f32 v48, v48
    v_exp_f32 v49, v49
    v_cvt_pk_bf16_f32 v89, v46, v47
    v_exp_f32 v50, v50
    v_exp_f32 v51, v51
    v_cvt_pk_bf16_f32 v90, v48, v49
    v_cvt_pk_bf16_f32 v91, v50, v51
    v_mfma_f32_32x32x16_bf16 v[36:51], v[92:95], v[16:19], 0
    s_waitcnt lgkmcnt(0)
    v_exp_f32 v20, v20
    v_exp_f32_e64 v21, v21
    v_exp_f32 v22, v22
    v_exp_f32 v23, v23
    v_cvt_pk_bf16_f32 v84, v20, v21
    v_exp_f32 v24, v24
    v_exp_f32 v25, v25
    v_cvt_pk_bf16_f32 v85, v22, v23
    v_mfma_f32_32x32x16_bf16 v[68:83], v[112:115], v[88:91], v[68:83]
    ds_read_b128 v[108:111], v116 offset:3072
    ds_read_b128 v[112:115], v116 offset:3584
    ds_read_b128 v[92:95], v117 offset:8192
    v_exp_f32 v26, v26
    v_exp_f32 v27, v27
    v_cvt_pk_bf16_f32 v86, v24, v25
    v_exp_f32 v28, v28
    v_exp_f32 v29, v29
    v_cvt_pk_bf16_f32 v87, v26, v27
    v_exp_f32 v30, v30
    v_exp_f32 v31, v31
    v_mfma_f32_32x32x16_bf16 v[52:67], v[100:103], v[84:87], v[52:67]
    v_cvt_pk_bf16_f32 v88, v28, v29
    v_exp_f32 v32, v32
    v_exp_f32 v33, v33
    v_cvt_pk_bf16_f32 v89, v30, v31
    v_exp_f32 v34, v34
    v_exp_f32 v35, v35
    v_cvt_pk_bf16_f32 v90, v32, v33
    v_cvt_pk_bf16_f32 v91, v34, v35
    v_mfma_f32_32x32x16_bf16 v[20:35], v[96:99], v[12:15], 0
    v_exp_f32 v36, v36
    v_exp_f32 v37, v37
    v_exp_f32 v38, v38
    v_exp_f32 v39, v39
    v_cvt_pk_bf16_f32 v84, v36, v37
    v_add_u32 v116, v118, v116
    v_exp_f32 v40, v40
    v_exp_f32_e64 v41, v41
    v_cvt_pk_bf16_f32 v85, v38, v39
    v_mfma_f32_32x32x16_bf16 v[52:67], v[104:107], v[88:91], v[52:67]
    v_exp_f32 v42, v42
    v_exp_f32 v43, v43
    v_cvt_pk_bf16_f32 v86, v40, v41
    v_exp_f32 v44, v44
    v_exp_f32 v45, v45
    v_cvt_pk_bf16_f32 v87, v42, v43
    v_exp_f32 v46, v46
    v_exp_f32 v47, v47
    v_mfma_f32_32x32x16_bf16 v[68:83], v[100:103], v[84:87], v[68:83]
    v_cvt_pk_bf16_f32 v88, v44, v45
    v_exp_f32 v48, v48
    v_exp_f32 v49, v49
    v_cvt_pk_bf16_f32 v89, v46, v47
    v_exp_f32 v50, v50
    v_exp_f32 v51, v51
    v_cvt_pk_bf16_f32 v90, v48, v49
    v_cvt_pk_bf16_f32 v91, v50, v51
    v_mfma_f32_32x32x16_bf16 v[36:51], v[96:99], v[16:19], 0
    s_waitcnt lgkmcnt(0)
    v_exp_f32 v20, v20
    v_exp_f32_e64 v21, v21
    v_exp_f32 v22, v22
    v_exp_f32 v23, v23
    v_cvt_pk_bf16_f32 v84, v20, v21
    v_exp_f32 v24, v24
    v_exp_f32 v25, v25
    v_cvt_pk_bf16_f32 v85, v22, v23
    v_mfma_f32_32x32x16_bf16 v[68:83], v[104:107], v[88:91], v[68:83]
    ds_read_b128 v[100:103], v116 offset:0
    ds_read_b128 v[104:107], v116 offset:512
    ds_read_b128 v[96:99], v117 offset:9216
    v_exp_f32 v26, v26
    v_exp_f32 v27, v27
    v_cvt_pk_bf16_f32 v86, v24, v25
    v_exp_f32 v28, v28
    v_exp_f32 v29, v29
    v_cvt_pk_bf16_f32 v87, v26, v27
    v_exp_f32 v30, v30
    v_exp_f32 v31, v31
    v_mfma_f32_32x32x16_bf16 v[52:67], v[108:111], v[84:87], v[52:67]
    v_cvt_pk_bf16_f32 v88, v28, v29
    v_exp_f32 v32, v32
    v_exp_f32 v33, v33
    v_cvt_pk_bf16_f32 v89, v30, v31
    v_exp_f32 v34, v34
    v_exp_f32 v35, v35
    v_cvt_pk_bf16_f32 v90, v32, v33
    v_cvt_pk_bf16_f32 v91, v34, v35
    v_mfma_f32_32x32x16_bf16 v[20:35], v[92:95], v[12:15], 0
    v_exp_f32 v36, v36
    v_exp_f32 v37, v37
    v_exp_f32 v38, v38
    v_exp_f32 v39, v39
    v_cvt_pk_bf16_f32 v84, v36, v37
    v_add_u32 v119, 1, v119
    v_exp_f32 v40, v40
    v_exp_f32_e64 v41, v41
    v_cvt_pk_bf16_f32 v85, v38, v39
    v_mfma_f32_32x32x16_bf16 v[52:67], v[112:115], v[88:91], v[52:67]
    v_exp_f32 v42, v42
    v_exp_f32 v43, v43
    v_cvt_pk_bf16_f32 v86, v40, v41
    v_exp_f32 v44, v44
    v_exp_f32 v45, v45
    v_cvt_pk_bf16_f32 v87, v42, v43
    v_exp_f32 v46, v46
    v_exp_f32 v47, v47
    v_mfma_f32_32x32x16_bf16 v[68:83], v[108:111], v[84:87], v[68:83]
    v_cvt_pk_bf16_f32 v88, v44, v45
    v_exp_f32 v48, v48
    v_exp_f32 v49, v49
    v_cvt_pk_bf16_f32 v89, v46, v47
    v_exp_f32 v50, v50
    v_exp_f32 v51, v51
    v_cvt_pk_bf16_f32 v90, v48, v49
    v_cvt_pk_bf16_f32 v91, v50, v51
    v_mfma_f32_32x32x16_bf16 v[36:51], v[92:95], v[16:19], 0
    s_waitcnt lgkmcnt(0)
    v_exp_f32 v20, v20
    v_exp_f32_e64 v21, v21
    v_exp_f32 v22, v22
    v_exp_f32 v23, v23
    v_cvt_pk_bf16_f32 v84, v20, v21
    v_exp_f32 v24, v24
    v_exp_f32 v25, v25
    v_cvt_pk_bf16_f32 v85, v22, v23
    v_mfma_f32_32x32x16_bf16 v[68:83], v[112:115], v[88:91], v[68:83]
    ds_read_b128 v[108:111], v116 offset:1024
    ds_read_b128 v[112:115], v116 offset:1536
    ds_read_b128 v[92:95], v117 offset:10240
    v_exp_f32 v26, v26
    v_exp_f32 v27, v27
    v_cvt_pk_bf16_f32 v86, v24, v25
    v_exp_f32 v28, v28
    v_exp_f32 v29, v29
    v_cvt_pk_bf16_f32 v87, v26, v27
    v_exp_f32 v30, v30
    v_exp_f32 v31, v31
    v_mfma_f32_32x32x16_bf16 v[52:67], v[100:103], v[84:87], v[52:67]
    v_cvt_pk_bf16_f32 v88, v28, v29
    v_exp_f32 v32, v32
    v_exp_f32 v33, v33
    v_cvt_pk_bf16_f32 v89, v30, v31
    v_exp_f32 v34, v34
    v_exp_f32 v35, v35
    v_cvt_pk_bf16_f32 v90, v32, v33
    v_cvt_pk_bf16_f32 v91, v34, v35
    v_mfma_f32_32x32x16_bf16 v[20:35], v[96:99], v[12:15], 0
    v_exp_f32 v36, v36
    v_exp_f32 v37, v37
    v_exp_f32 v38, v38
    v_exp_f32 v39, v39
    v_cvt_pk_bf16_f32 v84, v36, v37
    v_exp_f32 v40, v40
    v_exp_f32 v41, v41
    v_cvt_pk_bf16_f32 v85, v38, v39
    v_mfma_f32_32x32x16_bf16 v[52:67], v[104:107], v[88:91], v[52:67]
    ds_write_b32 v129, v119
    v_exp_f32 v42, v42
    v_exp_f32 v43, v43
    v_cvt_pk_bf16_f32 v86, v40, v41
    v_exp_f32 v44, v44
    v_exp_f32 v45, v45
    v_cvt_pk_bf16_f32 v87, v42, v43
    v_exp_f32 v46, v46
    v_exp_f32 v47, v47
    v_mfma_f32_32x32x16_bf16 v[68:83], v[100:103], v[84:87], v[68:83]
    v_cvt_pk_bf16_f32 v88, v44, v45
    v_exp_f32 v48, v48
    v_exp_f32 v49, v49
    v_cvt_pk_bf16_f32 v89, v46, v47
    v_exp_f32 v50, v50
    v_exp_f32 v51, v51
    v_cvt_pk_bf16_f32 v90, v48, v49
    v_cvt_pk_bf16_f32 v91, v50, v51
    v_mfma_f32_32x32x16_bf16 v[36:51], v[96:99], v[16:19], 0
    s_waitcnt lgkmcnt(0)
    v_exp_f32 v20, v20
    v_exp_f32_e64 v21, v21
    v_exp_f32 v22, v22
    v_exp_f32 v23, v23
    v_cvt_pk_bf16_f32 v84, v20, v21
    v_exp_f32 v24, v24
    v_exp_f32 v25, v25
    v_cvt_pk_bf16_f32 v85, v22, v23
    v_mfma_f32_32x32x16_bf16 v[68:83], v[104:107], v[88:91], v[68:83]
    ds_read_b128 v[100:103], v116 offset:2048
    ds_read_b128 v[104:107], v116 offset:2560
    ds_read_b128 v[96:99], v117 offset:11264
    v_exp_f32 v26, v26
    v_exp_f32 v27, v27
    v_cvt_pk_bf16_f32 v86, v24, v25
    v_exp_f32 v28, v28
    v_exp_f32 v29, v29
    v_cvt_pk_bf16_f32 v87, v26, v27
    v_exp_f32 v30, v30
    v_exp_f32 v31, v31
    v_mfma_f32_32x32x16_bf16 v[52:67], v[108:111], v[84:87], v[52:67]
    v_cvt_pk_bf16_f32 v88, v28, v29
    v_exp_f32 v32, v32
    v_exp_f32 v33, v33
    v_cvt_pk_bf16_f32 v89, v30, v31
    v_exp_f32 v34, v34
    v_exp_f32 v35, v35
    v_cvt_pk_bf16_f32 v90, v32, v33
    v_cvt_pk_bf16_f32 v91, v34, v35
    v_mfma_f32_32x32x16_bf16 v[20:35], v[92:95], v[12:15], 0
    v_exp_f32 v36, v36
    v_exp_f32 v37, v37
    v_exp_f32 v38, v38
    v_exp_f32 v39, v39
    v_cvt_pk_bf16_f32 v84, v36, v37
    v_exp_f32 v40, v40
    v_exp_f32 v41, v41
    v_cvt_pk_bf16_f32 v85, v38, v39
    v_mfma_f32_32x32x16_bf16 v[52:67], v[112:115], v[88:91], v[52:67]
    v_exp_f32 v42, v42
    v_exp_f32 v43, v43
    v_cvt_pk_bf16_f32 v86, v40, v41
    v_exp_f32 v44, v44
    v_exp_f32 v45, v45
    v_cvt_pk_bf16_f32 v87, v42, v43
    v_exp_f32 v46, v46
    v_exp_f32 v47, v47
    v_mfma_f32_32x32x16_bf16 v[68:83], v[108:111], v[84:87], v[68:83]
    v_cvt_pk_bf16_f32 v88, v44, v45
    v_exp_f32 v48, v48
    v_exp_f32 v49, v49
    v_cvt_pk_bf16_f32 v89, v46, v47
    v_exp_f32 v50, v50
    v_exp_f32 v51, v51
    v_cvt_pk_bf16_f32 v90, v48, v49
    v_cvt_pk_bf16_f32 v91, v50, v51
    v_mfma_f32_32x32x16_bf16 v[36:51], v[92:95], v[16:19], 0
    s_waitcnt lgkmcnt(0)
    v_exp_f32 v20, v20
    v_exp_f32_e64 v21, v21
    v_exp_f32 v22, v22
    v_exp_f32 v23, v23
    v_cvt_pk_bf16_f32 v84, v20, v21
    v_exp_f32 v24, v24
    v_exp_f32 v25, v25
    v_cvt_pk_bf16_f32 v85, v22, v23
    v_mfma_f32_32x32x16_bf16 v[68:83], v[112:115], v[88:91], v[68:83]
    ds_read_b128 v[108:111], v116 offset:3072
    ds_read_b128 v[112:115], v116 offset:3584
    ds_read_b128 v[92:95], v117 offset:16384
    v_exp_f32 v26, v26
    v_exp_f32 v27, v27
    v_cvt_pk_bf16_f32 v86, v24, v25
    v_exp_f32 v28, v28
    v_exp_f32 v29, v29
    v_cvt_pk_bf16_f32 v87, v26, v27
    v_exp_f32 v30, v30
    v_exp_f32 v31, v31
    v_mfma_f32_32x32x16_bf16 v[52:67], v[100:103], v[84:87], v[52:67]
    v_cvt_pk_bf16_f32 v88, v28, v29
    v_exp_f32 v32, v32
    v_exp_f32 v33, v33
    v_cvt_pk_bf16_f32 v89, v30, v31
    v_exp_f32 v34, v34
    v_exp_f32 v35, v35
    v_cvt_pk_bf16_f32 v90, v32, v33
    v_cvt_pk_bf16_f32 v91, v34, v35
    v_mfma_f32_32x32x16_bf16 v[20:35], v[96:99], v[12:15], 0
    v_exp_f32 v36, v36
    v_exp_f32 v37, v37
    v_exp_f32 v38, v38
    v_exp_f32 v39, v39
    v_cvt_pk_bf16_f32 v84, v36, v37
    v_add_u32 v116, v118, v116
    v_exp_f32 v40, v40
    v_exp_f32_e64 v41, v41
    v_cvt_pk_bf16_f32 v85, v38, v39
    v_mfma_f32_32x32x16_bf16 v[52:67], v[104:107], v[88:91], v[52:67]
    v_exp_f32 v42, v42
    v_exp_f32 v43, v43
    v_cvt_pk_bf16_f32 v86, v40, v41
    v_exp_f32 v44, v44
    v_exp_f32 v45, v45
    v_cvt_pk_bf16_f32 v87, v42, v43
    v_exp_f32 v46, v46
    v_exp_f32 v47, v47
    v_mfma_f32_32x32x16_bf16 v[68:83], v[100:103], v[84:87], v[68:83]
    v_cvt_pk_bf16_f32 v88, v44, v45
    v_exp_f32 v48, v48
    v_exp_f32 v49, v49
    v_cvt_pk_bf16_f32 v89, v46, v47
    v_exp_f32 v50, v50
    v_exp_f32 v51, v51
    v_cvt_pk_bf16_f32 v90, v48, v49
    v_cvt_pk_bf16_f32 v91, v50, v51
    v_mfma_f32_32x32x16_bf16 v[36:51], v[96:99], v[16:19], 0
    s_waitcnt lgkmcnt(0)
    v_exp_f32 v20, v20
    v_exp_f32_e64 v21, v21
    v_exp_f32 v22, v22
    v_exp_f32 v23, v23
    v_cvt_pk_bf16_f32 v84, v20, v21
    v_exp_f32 v24, v24
    v_exp_f32 v25, v25
    v_cvt_pk_bf16_f32 v85, v22, v23
    v_mfma_f32_32x32x16_bf16 v[68:83], v[104:107], v[88:91], v[68:83]
    ds_read_b128 v[100:103], v116 offset:0
    ds_read_b128 v[104:107], v116 offset:512
    ds_read_b128 v[96:99], v117 offset:17408
    v_exp_f32 v26, v26
    v_exp_f32 v27, v27
    v_cvt_pk_bf16_f32 v86, v24, v25
    v_exp_f32 v28, v28
    v_exp_f32 v29, v29
    v_cvt_pk_bf16_f32 v87, v26, v27
    v_exp_f32 v30, v30
    v_exp_f32 v31, v31
    v_mfma_f32_32x32x16_bf16 v[52:67], v[108:111], v[84:87], v[52:67]
    v_cvt_pk_bf16_f32 v88, v28, v29
    v_exp_f32 v32, v32
    v_exp_f32 v33, v33
    v_cvt_pk_bf16_f32 v89, v30, v31
    v_exp_f32 v34, v34
    v_exp_f32 v35, v35
    v_cvt_pk_bf16_f32 v90, v32, v33
    v_cvt_pk_bf16_f32 v91, v34, v35
    v_mfma_f32_32x32x16_bf16 v[20:35], v[92:95], v[12:15], 0
    v_exp_f32 v36, v36
    v_exp_f32 v37, v37
    v_exp_f32 v38, v38
    v_exp_f32 v39, v39
    v_cvt_pk_bf16_f32 v84, v36, v37
    v_add_u32 v119, 1, v119
    v_exp_f32 v40, v40
    v_exp_f32_e64 v41, v41
    v_cvt_pk_bf16_f32 v85, v38, v39
    v_mfma_f32_32x32x16_bf16 v[52:67], v[112:115], v[88:91], v[52:67]
    v_exp_f32 v42, v42
    v_exp_f32 v43, v43
    v_cvt_pk_bf16_f32 v86, v40, v41
    v_exp_f32 v44, v44
    v_exp_f32 v45, v45
    v_cvt_pk_bf16_f32 v87, v42, v43
    v_add_u32 v117, 0x4000, v117
    v_exp_f32 v46, v46
    v_exp_f32 v47, v47
    v_mfma_f32_32x32x16_bf16 v[68:83], v[108:111], v[84:87], v[68:83]
    s_add_u32 s34, s34, 1
    s_cmp_lt_u32 s34, 5
    v_cvt_pk_bf16_f32 v88, v44, v45
    v_exp_f32 v48, v48
    v_exp_f32 v49, v49
    v_cvt_pk_bf16_f32 v89, v46, v47
    v_exp_f32 v50, v50
    v_exp_f32 v51, v51
    v_cvt_pk_bf16_f32 v90, v48, v49
    v_cvt_pk_bf16_f32 v91, v50, v51
    s_cbranch_scc1 L_alp75
    v_mov_b32 v130, 28768
L_cpw76:
    ds_read_b32 v131, v130
    s_waitcnt lgkmcnt(0)
    v_cmp_gt_u32 vcc, 8, v131
    s_cbranch_vccnz L_cpw76
.p2align 3
    v_mfma_f32_32x32x16_bf16 v[36:51], v[92:95], v[16:19], 0
    s_add_u32 s30, s35, 8192
    buffer_load_dwordx4 v[160:163], v3, s[8:11], s30 offen offset:0 sc1
    s_waitcnt lgkmcnt(0)
    v_exp_f32 v20, v20
    v_exp_f32_e64 v21, v21
    v_exp_f32 v22, v22
    v_exp_f32 v23, v23
    v_cvt_pk_bf16_f32 v84, v20, v21
    v_exp_f32 v24, v24
    v_exp_f32 v25, v25
    v_cvt_pk_bf16_f32 v85, v22, v23
    v_mfma_f32_32x32x16_bf16 v[68:83], v[112:115], v[88:91], v[68:83]
    ds_read_b128 v[108:111], v116 offset:1024
    ds_read_b128 v[112:115], v116 offset:1536
    ds_read_b128 v[92:95], v117 offset:2048
    v_exp_f32 v26, v26
    v_exp_f32 v27, v27
    v_cvt_pk_bf16_f32 v86, v24, v25
    v_exp_f32 v28, v28
    v_exp_f32 v29, v29
    v_cvt_pk_bf16_f32 v87, v26, v27
    v_exp_f32 v30, v30
    v_exp_f32 v31, v31
    v_mfma_f32_32x32x16_bf16 v[52:67], v[100:103], v[84:87], v[52:67]
    buffer_load_dwordx4 v[164:167], v3, s[8:11], s30 offen offset:1024 sc1
    v_cvt_pk_bf16_f32 v88, v28, v29
    v_exp_f32 v32, v32
    v_exp_f32 v33, v33
    v_cvt_pk_bf16_f32 v89, v30, v31
    v_exp_f32 v34, v34
    v_exp_f32 v35, v35
    v_cvt_pk_bf16_f32 v90, v32, v33
    v_cvt_pk_bf16_f32 v91, v34, v35
    v_mfma_f32_32x32x16_bf16 v[20:35], v[96:99], v[12:15], 0
    buffer_load_dwordx4 v[168:171], v3, s[8:11], s30 offen offset:2048 sc1
    v_exp_f32 v36, v36
    v_exp_f32 v37, v37
    v_exp_f32 v38, v38
    v_exp_f32 v39, v39
    v_cvt_pk_bf16_f32 v84, v36, v37
    v_exp_f32 v40, v40
    v_exp_f32 v41, v41
    v_cvt_pk_bf16_f32 v85, v38, v39
    v_mfma_f32_32x32x16_bf16 v[52:67], v[104:107], v[88:91], v[52:67]
    buffer_load_dwordx4 v[172:175], v3, s[8:11], s30 offen offset:3072 sc1
    v_exp_f32 v42, v42
    v_exp_f32 v43, v43
    v_cvt_pk_bf16_f32 v86, v40, v41
    v_exp_f32 v44, v44
    v_exp_f32 v45, v45
    v_cvt_pk_bf16_f32 v87, v42, v43
    v_exp_f32 v46, v46
    v_exp_f32 v47, v47
    v_mfma_f32_32x32x16_bf16 v[68:83], v[100:103], v[84:87], v[68:83]
    s_add_u32 s30, s35, 12288
    buffer_load_dwordx4 v[176:179], v3, s[8:11], s30 offen offset:0 sc1
    v_cvt_pk_bf16_f32 v88, v44, v45
    v_exp_f32 v48, v48
    v_exp_f32 v49, v49
    v_cvt_pk_bf16_f32 v89, v46, v47
    v_exp_f32 v50, v50
    v_exp_f32 v51, v51
    v_cvt_pk_bf16_f32 v90, v48, v49
    v_cvt_pk_bf16_f32 v91, v50, v51
    v_mfma_f32_32x32x16_bf16 v[36:51], v[96:99], v[16:19], 0
    buffer_load_dwordx4 v[180:183], v3, s[8:11], s30 offen offset:1024 sc1
    s_waitcnt lgkmcnt(0)
    v_exp_f32 v20, v20
    v_exp_f32_e64 v21, v21
    v_exp_f32 v22, v22
    v_exp_f32 v23, v23
    v_cvt_pk_bf16_f32 v84, v20, v21
    v_exp_f32 v24, v24
    v_exp_f32 v25, v25
    v_cvt_pk_bf16_f32 v85, v22, v23
    v_mfma_f32_32x32x16_bf16 v[68:83], v[104:107], v[88:91], v[68:83]
    ds_read_b128 v[100:103], v116 offset:2048
    ds_read_b128 v[104:107], v116 offset:2560
    ds_read_b128 v[96:99], v117 offset:3072
    v_exp_f32 v26, v26
    v_exp_f32 v27, v27
    v_cvt_pk_bf16_f32 v86, v24, v25
    v_exp_f32 v28, v28
    v_exp_f32 v29, v29
    v_cvt_pk_bf16_f32 v87, v26, v27
    v_exp_f32 v30, v30
    v_exp_f32 v31, v31
    v_mfma_f32_32x32x16_bf16 v[52:67], v[108:111], v[84:87], v[52:67]
    buffer_load_dwordx4 v[184:187], v3, s[8:11], s30 offen offset:2048 sc1
    v_cvt_pk_bf16_f32 v88, v28, v29
    v_exp_f32 v32, v32
    v_exp_f32 v33, v33
    v_cvt_pk_bf16_f32 v89, v30, v31
    v_exp_f32 v34, v34
    v_exp_f32 v35, v35
    v_cvt_pk_bf16_f32 v90, v32, v33
    v_cvt_pk_bf16_f32 v91, v34, v35
    v_mfma_f32_32x32x16_bf16 v[20:35], v[92:95], v[12:15], 0
    buffer_load_dwordx4 v[188:191], v3, s[8:11], s30 offen offset:3072 sc1
    v_exp_f32 v36, v36
    v_exp_f32 v37, v37
    v_exp_f32 v38, v38
    v_exp_f32 v39, v39
    v_cvt_pk_bf16_f32 v84, v36, v37
    v_exp_f32 v40, v40
    v_exp_f32 v41, v41
    v_cvt_pk_bf16_f32 v85, v38, v39
    v_mfma_f32_32x32x16_bf16 v[52:67], v[112:115], v[88:91], v[52:67]
    s_add_u32 s30, s35, 16384
    buffer_load_dwordx4 v[192:195], v3, s[8:11], s30 offen offset:0 sc1
    v_exp_f32 v42, v42
    v_exp_f32 v43, v43
    v_cvt_pk_bf16_f32 v86, v40, v41
    v_exp_f32 v44, v44
    v_exp_f32 v45, v45
    v_cvt_pk_bf16_f32 v87, v42, v43
    v_exp_f32 v46, v46
    v_exp_f32 v47, v47
    v_mfma_f32_32x32x16_bf16 v[68:83], v[108:111], v[84:87], v[68:83]
    buffer_load_dwordx4 v[196:199], v3, s[8:11], s30 offen offset:1024 sc1
    v_cvt_pk_bf16_f32 v88, v44, v45
    v_exp_f32 v48, v48
    v_exp_f32 v49, v49
    v_cvt_pk_bf16_f32 v89, v46, v47
    v_exp_f32 v50, v50
    v_exp_f32 v51, v51
    v_cvt_pk_bf16_f32 v90, v48, v49
    v_cvt_pk_bf16_f32 v91, v50, v51
    v_mfma_f32_32x32x16_bf16 v[36:51], v[92:95], v[16:19], 0
    buffer_load_dwordx4 v[200:203], v3, s[8:11], s30 offen offset:2048 sc1
    s_waitcnt lgkmcnt(0)
    v_exp_f32 v20, v20
    v_exp_f32_e64 v21, v21
    v_exp_f32 v22, v22
    v_exp_f32 v23, v23
    v_cvt_pk_bf16_f32 v84, v20, v21
    v_exp_f32 v24, v24
    v_exp_f32 v25, v25
    v_cvt_pk_bf16_f32 v85, v22, v23
    v_mfma_f32_32x32x16_bf16 v[68:83], v[112:115], v[88:91], v[68:83]
    ds_read_b128 v[108:111], v116 offset:3072
    ds_read_b128 v[112:115], v116 offset:3584
    ds_read_b128 v[92:95], v117 offset:8192
    v_exp_f32 v26, v26
    v_exp_f32 v27, v27
    v_cvt_pk_bf16_f32 v86, v24, v25
    v_exp_f32 v28, v28
    v_exp_f32 v29, v29
    v_cvt_pk_bf16_f32 v87, v26, v27
    v_exp_f32 v30, v30
    v_exp_f32 v31, v31
    v_mfma_f32_32x32x16_bf16 v[52:67], v[100:103], v[84:87], v[52:67]
    buffer_load_dwordx4 v[204:207], v3, s[8:11], s30 offen offset:3072 sc1
    v_cvt_pk_bf16_f32 v88, v28, v29
    v_exp_f32 v32, v32
    v_exp_f32 v33, v33
    v_cvt_pk_bf16_f32 v89, v30, v31
    v_exp_f32 v34, v34
    v_exp_f32 v35, v35
    v_cvt_pk_bf16_f32 v90, v32, v33
    v_cvt_pk_bf16_f32 v91, v34, v35
    v_mfma_f32_32x32x16_bf16 v[20:35], v[96:99], v[12:15], 0
    s_add_u32 s30, s5, 16384
    buffer_load_dwordx4 v[208:211], v3, s[8:11], s30 offen offset:0 sc1
    v_exp_f32 v36, v36
    v_exp_f32 v37, v37
    v_exp_f32 v38, v38
    v_exp_f32 v39, v39
    v_cvt_pk_bf16_f32 v84, v36, v37
    v_add_u32 v116, v118, v116
    v_exp_f32 v40, v40
    v_exp_f32_e64 v41, v41
    v_cvt_pk_bf16_f32 v85, v38, v39
    v_mfma_f32_32x32x16_bf16 v[52:67], v[104:107], v[88:91], v[52:67]
    buffer_load_dwordx4 v[212:215], v3, s[8:11], s30 offen offset:1024 sc1
    v_exp_f32 v42, v42
    v_exp_f32 v43, v43
    v_cvt_pk_bf16_f32 v86, v40, v41
    v_exp_f32 v44, v44
    v_exp_f32 v45, v45
    v_cvt_pk_bf16_f32 v87, v42, v43
    v_exp_f32 v46, v46
    v_exp_f32 v47, v47
    v_mfma_f32_32x32x16_bf16 v[68:83], v[100:103], v[84:87], v[68:83]
    buffer_load_dwordx4 v[216:219], v3, s[8:11], s30 offen offset:2048 sc1
    v_cvt_pk_bf16_f32 v88, v44, v45
    v_exp_f32 v48, v48
    v_exp_f32 v49, v49
    v_cvt_pk_bf16_f32 v89, v46, v47
    v_exp_f32 v50, v50
    v_exp_f32 v51, v51
    v_cvt_pk_bf16_f32 v90, v48, v49
    v_cvt_pk_bf16_f32 v91, v50, v51
    v_mfma_f32_32x32x16_bf16 v[36:51], v[96:99], v[16:19], 0
    buffer_load_dwordx4 v[220:223], v3, s[8:11], s30 offen offset:3072 sc1
    s_waitcnt lgkmcnt(0)
    v_exp_f32 v20, v20
    v_exp_f32_e64 v21, v21
    v_exp_f32 v22, v22
    v_exp_f32 v23, v23
    v_cvt_pk_bf16_f32 v84, v20, v21
    v_exp_f32 v24, v24
    v_exp_f32 v25, v25
    v_cvt_pk_bf16_f32 v85, v22, v23
    v_mfma_f32_32x32x16_bf16 v[68:83], v[104:107], v[88:91], v[68:83]
    ds_read_b128 v[100:103], v116 offset:0
    ds_read_b128 v[104:107], v116 offset:512
    ds_read_b128 v[96:99], v117 offset:9216
    v_exp_f32 v26, v26
    v_exp_f32 v27, v27
    v_cvt_pk_bf16_f32 v86, v24, v25
    v_exp_f32 v28, v28
    v_exp_f32 v29, v29
    v_cvt_pk_bf16_f32 v87, v26, v27
    v_exp_f32 v30, v30
    v_exp_f32 v31, v31
    v_mfma_f32_32x32x16_bf16 v[52:67], v[108:111], v[84:87], v[52:67]
    s_add_u32 s30, s5, 20480
    buffer_load_dwordx4 v[224:227], v3, s[8:11], s30 offen offset:0 sc1
    v_cvt_pk_bf16_f32 v88, v28, v29
    v_exp_f32 v32, v32
    v_exp_f32 v33, v33
    v_cvt_pk_bf16_f32 v89, v30, v31
    v_exp_f32 v34, v34
    v_exp_f32 v35, v35
    v_cvt_pk_bf16_f32 v90, v32, v33
    v_cvt_pk_bf16_f32 v91, v34, v35
    v_mfma_f32_32x32x16_bf16 v[20:35], v[92:95], v[12:15], 0
    buffer_load_dwordx4 v[228:231], v3, s[8:11], s30 offen offset:1024 sc1
    v_exp_f32 v36, v36
    v_exp_f32 v37, v37
    v_exp_f32 v38, v38
    v_exp_f32 v39, v39
    v_cvt_pk_bf16_f32 v84, v36, v37
    v_exp_f32 v40, v40
    v_exp_f32 v41, v41
    v_cvt_pk_bf16_f32 v85, v38, v39
    v_mfma_f32_32x32x16_bf16 v[52:67], v[112:115], v[88:91], v[52:67]
    buffer_load_dwordx4 v[232:235], v3, s[8:11], s30 offen offset:2048 sc1
    v_exp_f32 v42, v42
    v_exp_f32 v43, v43
    v_cvt_pk_bf16_f32 v86, v40, v41
    v_exp_f32 v44, v44
    v_exp_f32 v45, v45
    v_cvt_pk_bf16_f32 v87, v42, v43
    v_exp_f32 v46, v46
    v_exp_f32 v47, v47
    v_mfma_f32_32x32x16_bf16 v[68:83], v[108:111], v[84:87], v[68:83]
    buffer_load_dwordx4 v[236:239], v3, s[8:11], s30 offen offset:3072 sc1
    v_cvt_pk_bf16_f32 v88, v44, v45
    v_exp_f32 v48, v48
    v_exp_f32 v49, v49
    v_cvt_pk_bf16_f32 v89, v46, v47
    v_exp_f32 v50, v50
    v_exp_f32 v51, v51
    v_cvt_pk_bf16_f32 v90, v48, v49
    v_cvt_pk_bf16_f32 v91, v50, v51
    v_mfma_f32_32x32x16_bf16 v[36:51], v[92:95], v[16:19], 0
    s_add_u32 s30, s5, 24576
    buffer_load_dwordx4 v[240:243], v3, s[8:11], s30 offen offset:0 sc1
    s_waitcnt lgkmcnt(0)
    v_exp_f32 v20, v20
    v_exp_f32_e64 v21, v21
    v_exp_f32 v22, v22
    v_exp_f32 v23, v23
    v_cvt_pk_bf16_f32 v84, v20, v21
    v_exp_f32 v24, v24
    v_exp_f32 v25, v25
    v_cvt_pk_bf16_f32 v85, v22, v23
    v_mfma_f32_32x32x16_bf16 v[68:83], v[112:115], v[88:91], v[68:83]
    ds_read_b128 v[108:111], v116 offset:1024
    ds_read_b128 v[112:115], v116 offset:1536
    ds_read_b128 v[92:95], v117 offset:10240
    v_exp_f32 v26, v26
    v_exp_f32 v27, v27
    v_cvt_pk_bf16_f32 v86, v24, v25
    v_exp_f32 v28, v28
    v_exp_f32 v29, v29
    v_cvt_pk_bf16_f32 v87, v26, v27
    v_exp_f32 v30, v30
    v_exp_f32 v31, v31
    v_mfma_f32_32x32x16_bf16 v[52:67], v[100:103], v[84:87], v[52:67]
    buffer_load_dwordx4 v[244:247], v3, s[8:11], s30 offen offset:1024 sc1
    v_cvt_pk_bf16_f32 v88, v28, v29
    v_exp_f32 v32, v32
    v_exp_f32 v33, v33
    v_cvt_pk_bf16_f32 v89, v30, v31
    v_exp_f32 v34, v34
    v_exp_f32 v35, v35
    v_cvt_pk_bf16_f32 v90, v32, v33
    v_cvt_pk_bf16_f32 v91, v34, v35
    v_mfma_f32_32x32x16_bf16 v[20:35], v[96:99], v[12:15], 0
    buffer_load_dwordx4 v[248:251], v3, s[8:11], s30 offen offset:2048 sc1
    v_exp_f32 v36, v36
    v_exp_f32 v37, v37
    v_exp_f32 v38, v38
    v_exp_f32 v39, v39
    v_cvt_pk_bf16_f32 v84, v36, v37
    v_exp_f32 v40, v40
    v_exp_f32 v41, v41
    v_cvt_pk_bf16_f32 v85, v38, v39
    v_mfma_f32_32x32x16_bf16 v[52:67], v[104:107], v[88:91], v[52:67]
    buffer_load_dwordx4 v[252:255], v3, s[8:11], s30 offen offset:3072 sc1
    v_exp_f32 v42, v42
    v_exp_f32 v43, v43
    v_cvt_pk_bf16_f32 v86, v40, v41
    v_exp_f32 v44, v44
    v_exp_f32 v45, v45
    v_cvt_pk_bf16_f32 v87, v42, v43
    v_exp_f32 v46, v46
    v_exp_f32 v47, v47
    v_mfma_f32_32x32x16_bf16 v[68:83], v[100:103], v[84:87], v[68:83]
    v_cvt_pk_bf16_f32 v88, v44, v45
    v_exp_f32 v48, v48
    v_exp_f32 v49, v49
    v_cvt_pk_bf16_f32 v89, v46, v47
    v_exp_f32 v50, v50
    v_exp_f32 v51, v51
    v_cvt_pk_bf16_f32 v90, v48, v49
    v_cvt_pk_bf16_f32 v91, v50, v51
    v_mfma_f32_32x32x16_bf16 v[36:51], v[96:99], v[16:19], 0
    s_waitcnt lgkmcnt(0)
    v_exp_f32 v20, v20
    v_exp_f32_e64 v21, v21
    v_exp_f32 v22, v22
    v_exp_f32 v23, v23
    v_cvt_pk_bf16_f32 v84, v20, v21
    v_exp_f32 v24, v24
    v_exp_f32 v25, v25
    v_cvt_pk_bf16_f32 v85, v22, v23
    v_mfma_f32_32x32x16_bf16 v[68:83], v[104:107], v[88:91], v[68:83]
    ds_read_b128 v[100:103], v116 offset:2048
    ds_read_b128 v[104:107], v116 offset:2560
    ds_read_b128 v[96:99], v117 offset:11264
    v_exp_f32 v26, v26
    v_exp_f32 v27, v27
    v_cvt_pk_bf16_f32 v86, v24, v25
    v_exp_f32 v28, v28
    v_exp_f32 v29, v29
    v_cvt_pk_bf16_f32 v87, v26, v27
    v_exp_f32 v30, v30
    v_exp_f32 v31, v31
    v_mfma_f32_32x32x16_bf16 v[52:67], v[108:111], v[84:87], v[52:67]
    buffer_load_dwordx2 v[120:121], v128, s[16:19], s33 offen offset:0
    v_cvt_pk_bf16_f32 v88, v28, v29
    v_exp_f32 v32, v32
    v_exp_f32 v33, v33
    v_cvt_pk_bf16_f32 v89, v30, v31
    v_exp_f32 v34, v34
    v_exp_f32 v35, v35
    v_cvt_pk_bf16_f32 v90, v32, v33
    v_cvt_pk_bf16_f32 v91, v34, v35
    v_mfma_f32_32x32x16_bf16 v[20:35], v[92:95], v[12:15], 0
    v_exp_f32 v36, v36
    v_exp_f32 v37, v37
    v_exp_f32 v38, v38
    v_exp_f32 v39, v39
    v_cvt_pk_bf16_f32 v84, v36, v37
    v_exp_f32 v40, v40
    v_exp_f32 v41, v41
    v_cvt_pk_bf16_f32 v85, v38, v39
    v_mfma_f32_32x32x16_bf16 v[52:67], v[112:115], v[88:91], v[52:67]
    v_exp_f32 v42, v42
    v_exp_f32 v43, v43
    v_cvt_pk_bf16_f32 v86, v40, v41
    v_exp_f32 v44, v44
    v_exp_f32 v45, v45
    v_cvt_pk_bf16_f32 v87, v42, v43
    v_exp_f32 v46, v46
    v_exp_f32 v47, v47
    v_mfma_f32_32x32x16_bf16 v[68:83], v[108:111], v[84:87], v[68:83]
    buffer_load_dwordx2 v[122:123], v128, s[16:19], s33 offen offset:32
    v_cvt_pk_bf16_f32 v88, v44, v45
    v_exp_f32 v48, v48
    v_exp_f32 v49, v49
    v_cvt_pk_bf16_f32 v89, v46, v47
    v_exp_f32 v50, v50
    v_exp_f32 v51, v51
    v_cvt_pk_bf16_f32 v90, v48, v49
    v_cvt_pk_bf16_f32 v91, v50, v51
    v_mfma_f32_32x32x16_bf16 v[36:51], v[92:95], v[16:19], 0
    s_waitcnt lgkmcnt(0)
    v_exp_f32 v20, v20
    v_exp_f32_e64 v21, v21
    v_exp_f32 v22, v22
    v_exp_f32 v23, v23
    v_cvt_pk_bf16_f32 v84, v20, v21
    v_exp_f32 v24, v24
    v_exp_f32 v25, v25
    v_cvt_pk_bf16_f32 v85, v22, v23
    v_mfma_f32_32x32x16_bf16 v[68:83], v[112:115], v[88:91], v[68:83]
    ds_read_b128 v[108:111], v116 offset:3072
    ds_read_b128 v[112:115], v116 offset:3584
    ds_read_b128 v[92:95], v117 offset:16384
    v_exp_f32 v26, v26
    v_exp_f32 v27, v27
    v_cvt_pk_bf16_f32 v86, v24, v25
    v_exp_f32 v28, v28
    v_exp_f32 v29, v29
    v_cvt_pk_bf16_f32 v87, v26, v27
    v_exp_f32 v30, v30
    v_exp_f32 v31, v31
    v_mfma_f32_32x32x16_bf16 v[52:67], v[100:103], v[84:87], v[52:67]
    buffer_load_dwordx2 v[124:125], v128, s[16:19], s33 offen offset:64
    v_cvt_pk_bf16_f32 v88, v28, v29
    v_exp_f32 v32, v32
    v_exp_f32 v33, v33
    v_cvt_pk_bf16_f32 v89, v30, v31
    v_exp_f32 v34, v34
    v_exp_f32 v35, v35
    v_cvt_pk_bf16_f32 v90, v32, v33
    v_cvt_pk_bf16_f32 v91, v34, v35
    v_mfma_f32_32x32x16_bf16 v[20:35], v[96:99], v[12:15], 0
    v_exp_f32 v36, v36
    v_exp_f32 v37, v37
    v_exp_f32 v38, v38
    v_exp_f32 v39, v39
    v_cvt_pk_bf16_f32 v84, v36, v37
    v_add_u32 v116, v118, v116
    v_exp_f32 v40, v40
    v_exp_f32_e64 v41, v41
    v_cvt_pk_bf16_f32 v85, v38, v39
    v_mfma_f32_32x32x16_bf16 v[52:67], v[104:107], v[88:91], v[52:67]
    v_exp_f32 v42, v42
    v_exp_f32 v43, v43
    v_cvt_pk_bf16_f32 v86, v40, v41
    v_exp_f32 v44, v44
    v_exp_f32 v45, v45
    v_cvt_pk_bf16_f32 v87, v42, v43
    v_exp_f32 v46, v46
    v_exp_f32 v47, v47
    v_mfma_f32_32x32x16_bf16 v[68:83], v[100:103], v[84:87], v[68:83]
    buffer_load_dwordx2 v[126:127], v128, s[16:19], s33 offen offset:96
    v_cvt_pk_bf16_f32 v88, v44, v45
    v_exp_f32 v48, v48
    v_exp_f32 v49, v49
    v_cvt_pk_bf16_f32 v89, v46, v47
    v_exp_f32 v50, v50
    v_exp_f32 v51, v51
    v_cvt_pk_bf16_f32 v90, v48, v49
    v_cvt_pk_bf16_f32 v91, v50, v51
    v_mfma_f32_32x32x16_bf16 v[36:51], v[96:99], v[16:19], 0
    s_waitcnt lgkmcnt(0)
    v_exp_f32 v20, v20
    v_exp_f32_e64 v21, v21
    v_exp_f32 v22, v22
    v_exp_f32 v23, v23
    v_cvt_pk_bf16_f32 v84, v20, v21
    v_exp_f32 v24, v24
    v_exp_f32 v25, v25
    v_cvt_pk_bf16_f32 v85, v22, v23
    v_mfma_f32_32x32x16_bf16 v[68:83], v[104:107], v[88:91], v[68:83]
    ds_read_b128 v[100:103], v116 offset:0
    ds_read_b128 v[104:107], v116 offset:512
    ds_read_b128 v[96:99], v117 offset:17408
    v_exp_f32 v26, v26
    v_exp_f32 v27, v27
    v_cvt_pk_bf16_f32 v86, v24, v25
    v_exp_f32 v28, v28
    v_exp_f32 v29, v29
    v_cvt_pk_bf16_f32 v87, v26, v27
    v_exp_f32 v30, v30
    v_exp_f32 v31, v31
    v_mfma_f32_32x32x16_bf16 v[52:67], v[108:111], v[84:87], v[52:67]
    v_cvt_pk_bf16_f32 v88, v28, v29
    v_exp_f32 v32, v32
    v_exp_f32 v33, v33
    v_cvt_pk_bf16_f32 v89, v30, v31
    v_exp_f32 v34, v34
    v_exp_f32 v35, v35
    v_cvt_pk_bf16_f32 v90, v32, v33
    v_cvt_pk_bf16_f32 v91, v34, v35
    v_mfma_f32_32x32x16_bf16 v[20:35], v[92:95], v[12:15], 0
    v_exp_f32 v36, v36
    v_exp_f32 v37, v37
    v_exp_f32 v38, v38
    v_exp_f32 v39, v39
    v_cvt_pk_bf16_f32 v84, v36, v37
    v_exp_f32 v40, v40
    v_exp_f32 v41, v41
    v_cvt_pk_bf16_f32 v85, v38, v39
    v_mfma_f32_32x32x16_bf16 v[52:67], v[112:115], v[88:91], v[52:67]
    v_exp_f32 v42, v42
    v_exp_f32 v43, v43
    v_cvt_pk_bf16_f32 v86, v40, v41
    v_exp_f32 v44, v44
    v_exp_f32 v45, v45
    v_cvt_pk_bf16_f32 v87, v42, v43
    v_exp_f32 v46, v46
    v_exp_f32 v47, v47
    v_mfma_f32_32x32x16_bf16 v[68:83], v[108:111], v[84:87], v[68:83]
    v_cvt_pk_bf16_f32 v88, v44, v45
    v_exp_f32 v48, v48
    v_exp_f32 v49, v49
    v_cvt_pk_bf16_f32 v89, v46, v47
    v_exp_f32 v50, v50
    v_exp_f32 v51, v51
    v_cvt_pk_bf16_f32 v90, v48, v49
    v_cvt_pk_bf16_f32 v91, v50, v51
    s_waitcnt lgkmcnt(0)
    s_nop 0
    v_mfma_f32_32x32x16_bf16 v[68:83], v[112:115], v[88:91], v[68:83]
    s_barrier
    s_xor_b32 s29, s21, 5
    s_lshl_b32 s29, s29, 2
    s_add_u32 s29, s29, s23
    s_lshl_b32 s26, s24, 21
    s_lshl_b32 s27, s69, 16
    s_add_u32 s26, s26, s27
    s_lshl_b32 s27, s29, 9
    s_add_u32 s26, s26, s27
    s_add_u32 s26, s26, 8388608
    s_add_u32 s27, s26, 32768
    s_lshl_b32 s28, s24, 14
    s_lshl_b32 s30, s69, 12
    s_add_u32 s28, s28, s30
    s_lshl_b32 s30, s29, 7
    s_add_u32 s28, s28, s30
    s_add_u32 s28, s28, 30670848
    v_lshrrev_b32 v92, 4, v4
    v_lshlrev_b32 v92, 14, v92
    v_lshl_add_u32 v92, v5, 8, v92
    v_lshl_add_u32 v92, v6, 4, v92
    v_max3_f32 v20, |v52|, |v53|, |v54|
    v_max3_f32 v20, |v55|, |v56|, v20
    v_max3_f32 v20, |v57|, |v58|, v20
    v_max3_f32 v21, |v68|, |v69|, |v70|
    v_max3_f32 v21, |v71|, |v72|, v21
    v_max3_f32 v21, |v73|, |v74|, v21
    v_max3_f32 v20, |v59|, |v75|, v20
    v_max_f32 v20, v20, v21
    v_mul_f32 v20, 0x21800000, v20
    v_max3_f32 v20, v60, v76, v20
    v_min_f32 v21, v60, v76
    v_mov_b32 v22, 0x5d800000
    v_cmp_nle_f32 vcc, v20, v22
    v_cmp_u_f32 s[30:31], v60, v76
    v_mov_b32 v23, 0x21800000
    v_cmp_ngt_f32 s[32:33], v21, v23
    s_or_b64 vcc, vcc, s[30:31]
    s_or_b64 vcc, vcc, s[32:33]
    s_cbranch_vccnz L_fb77
L_fbr78:
    v_rcp_f32 v20, v60
    v_rcp_f32 v22, v76
    v_pk_mul_f32 v[52:53], v[52:53], v[20:21] op_sel_hi:[1,0]
    v_pk_mul_f32 v[54:55], v[54:55], v[20:21] op_sel_hi:[1,0]
    v_pk_mul_f32 v[56:57], v[56:57], v[20:21] op_sel_hi:[1,0]
    v_pk_mul_f32 v[58:59], v[58:59], v[20:21] op_sel_hi:[1,0]
    v_cvt_pk_bf16_f32 v84, v52, v53
    v_cvt_pk_bf16_f32 v85, v54, v55
    v_cvt_pk_bf16_f32 v86, v56, v57
    v_cvt_pk_bf16_f32 v87, v58, v59
    v_pk_mul_f32 v[68:69], v[68:69], v[22:23] op_sel_hi:[1,0]
    v_pk_mul_f32 v[70:71], v[70:71], v[22:23] op_sel_hi:[1,0]
    v_pk_mul_f32 v[72:73], v[72:73], v[22:23] op_sel_hi:[1,0]
    v_pk_mul_f32 v[74:75], v[74:75], v[22:23] op_sel_hi:[1,0]
    v_cvt_pk_bf16_f32 v88, v68, v69
    v_cvt_pk_bf16_f32 v89, v70, v71
    v_cvt_pk_bf16_f32 v90, v72, v73
    v_cvt_pk_bf16_f32 v91, v74, v75
    buffer_store_dwordx4 v[84:87], v92, s[8:11], s26 offen sc1
    buffer_store_dwordx4 v[88:91], v92, s[8:11], s27 offen sc1
    s_mov_b32 s39, s28
    s_waitcnt vmcnt(2)
    v_add_u32 v14, 32768, v3
    v_add_u32 v15, 98304, v3
    ds_read_b128 v[128:131], v14 offset:0
    ds_read_b128 v[132:135], v14 offset:1024
    ds_read_b128 v[136:139], v14 offset:2048
    ds_read_b128 v[140:143], v14 offset:3072
    ds_read_b128 v[144:147], v14 offset:4096
    ds_read_b128 v[148:151], v14 offset:5120
    ds_read_b128 v[152:155], v14 offset:6144
    ds_read_b128 v[156:159], v14 offset:7168
    v_lshlrev_b32 v32, 16, v120
    v_and_b32 v33, 0xffff0000, v120
    v_lshlrev_b32 v34, 16, v121
    v_and_b32 v35, 0xffff0000, v121
    v_lshlrev_b32 v36, 16, v122
    v_and_b32 v37, 0xffff0000, v122
    v_lshlrev_b32 v38, 16, v123
    v_and_b32 v39, 0xffff0000, v123
    v_lshlrev_b32 v40, 16, v124
    v_and_b32 v41, 0xffff0000, v124
    v_lshlrev_b32 v42, 16, v125
    v_and_b32 v43, 0xffff0000, v125
    v_lshlrev_b32 v44, 16, v126
    v_and_b32 v45, 0xffff0000, v126
    v_lshlrev_b32 v46, 16, v127
    v_and_b32 v47, 0xffff0000, v127
    s_lshl_b32 s26, s70, 14
    s_add_u32 s26, s26, s3
    s_add_u32 s29, s26, 0
    s_lshl_b32 s27, s24, 11
    s_add_u32 s33, s26, s27
    s_add_u32 s33, s33, 262144
    s_lshl_b32 s27, s24, 3
    s_add_u32 s27, s27, s3
    s_lshl_b32 s34, s70, 10
    s_add_u32 s34, s34, s27
    s_add_u32 s34, s34, 524288
    s_lshl_b32 s35, s70, 6
    s_add_u32 s35, s35, s27
    s_add_u32 s35, s35, 558080
    s_mov_b32 s36, s26
    v_lshlrev_b32 v31, 6, v6
    v_lshl_add_u32 v101, v7, 4, v31
    v_lshlrev_b32 v102, 4, v7
    v_mov_b32 v12, 0xc0135761
    v_mov_b32 v13, 0xc0135761
    s_lshl_b32 s37, s70, 6
    s_add_u32 s37, s37, s3
    s_add_u32 s37, s37, 558080
    s_lshl_b32 s38, s70, 10
    s_add_u32 s38, s38, s3
    s_add_u32 s38, s38, 524288
    v_mov_b32 v104, s58
    v_mov_b32 v105, s59
    s_waitcnt vmcnt(0)
    s_mov_b64 exec, 1
    buffer_store_dwordx2 v[104:105], off, s[8:11], s39 sc1
    s_mov_b64 exec, -1
    s_lshl_b32 s27, s21, 4
    s_add_u32 s27, s27, s70
    s_bfe_u32 s28, s24, 0x10001
    s_cmp_eq_u32 s28, 1
    s_cselect_b32 s28, 0, 15
    s_cmp_eq_u32 s70, s28
    s_cselect_b32 s73, 1, 0
    s_add_u32 s28, s27, 1
    s_and_b32 s28, s28, 126
    s_cmp_eq_u32 s28, 0
    s_cselect_b32 s73, 0, s73
    s_cmp_eq_u32 s73, 1
    s_cselect_b32 s71, 0, s61
    s_cmp_eq_u32 s70, 0
    s_mov_b32 s74, 2670592
    s_cselect_b32 s74, 4293444608, s74
    s_add_u32 s74, s74, s3
    s_lshl_b32 s28, s24, 7
    s_add_u32 s74, s74, s28
    s_mov_b32 s40, 0xccff33
    s_cmp_eq_u32 s27, 0
    s_cselect_b32 s40, 0xccff00, s40
    s_cmp_eq_u32 s27, 127
    s_cselect_b32 s40, 0x00ff33, s40
    s_mov_b32 s41, 0
    s_lshl_b32 s26, s27, 4
    s_lshl_b32 s28, s70, 6
    s_add_u32 s28, s28, 559168
    v_add_u32 v100, s28, v1
    v_lshrrev_b32 v10, 3, v2
    s_sub_u32 s27, s70, 1
    v_add_u32 v10, s27, v10
    v_cmp_lt_u32 vcc, 15, v10
    v_and_b32 v10, 7, v2
    v_lshl_add_u32 v10, v7, 3, v10
    v_lshlrev_b32 v10, 7, v10
    v_add_u32 v10, 573440, v10
    v_cndmask_b32 v100, v100, v10, vcc
    v_add_u32 v10, s26, v6
    v_add_u32 v10, -1, v10
    v_bfe_u32 v11, v10, 4, 4
    v_lshlrev_b32 v11, 14, v11
    v_lshrrev_b32 v26, 8, v10
    v_lshl_add_u32 v11, v26, 21, v11
    v_and_b32 v26, 15, v10
    v_lshl_add_u32 v11, v26, 4, v11
    v_lshl_add_u32 v11, v7, 8, v11
    v_cmp_gt_u32 vcc, 0x800, v10
    v_mov_b32 v26, 0x70000000
    s_nop 0
    v_cndmask_b32 v96, v26, v11, vcc
    v_add_u32 v10, s26, v6
    v_add_u32 v10, 1, v10
    v_bfe_u32 v11, v10, 4, 4
    v_lshlrev_b32 v11, 14, v11
    v_lshrrev_b32 v26, 8, v10
    v_lshl_add_u32 v11, v26, 21, v11
    v_and_b32 v26, 15, v10
    v_lshl_add_u32 v11, v26, 4, v11
    v_lshl_add_u32 v11, v7, 8, v11
    v_cmp_gt_u32 vcc, 0x800, v10
    v_mov_b32 v26, 0x70000000
    s_nop 0
    v_cndmask_b32 v97, v26, v11, vcc
    v_add_u32 v10, s26, v6
    v_add_u32 v10, -2, v10
    v_bfe_u32 v11, v10, 4, 4
    v_lshlrev_b32 v11, 14, v11
    v_lshrrev_b32 v26, 8, v10
    v_lshl_add_u32 v11, v26, 21, v11
    v_and_b32 v26, 15, v10
    v_lshl_add_u32 v11, v26, 4, v11
    v_lshl_add_u32 v11, v7, 8, v11
    v_cmp_gt_u32 vcc, 0x800, v10
    v_mov_b32 v26, 0x70000000
    s_nop 0
    v_cndmask_b32 v98, v26, v11, vcc
    v_add_u32 v10, s26, v6
    v_add_u32 v10, 2, v10
    v_bfe_u32 v11, v10, 4, 4
    v_lshlrev_b32 v11, 14, v11
    v_lshrrev_b32 v26, 8, v10
    v_lshl_add_u32 v11, v26, 21, v11
    v_and_b32 v26, 15, v10
    v_lshl_add_u32 v11, v26, 4, v11
    v_lshl_add_u32 v11, v7, 8, v11
    v_cmp_gt_u32 vcc, 0x800, v10
    v_mov_b32 v26, 0x70000000
    s_nop 0
    v_cndmask_b32 v99, v26, v11, vcc
    s_barrier
    buffer_load_dwordx4 v[48:51], v3, s[8:11], s29 offen offset:0 sc1
    buffer_load_dwordx4 v[52:55], v3, s[8:11], s29 offen offset:1024 sc1
    buffer_load_dwordx4 v[56:59], v3, s[8:11], s29 offen offset:2048 sc1
    buffer_load_dwordx4 v[60:63], v3, s[8:11], s29 offen offset:3072 sc1
    s_add_u32 s29, s29, 4096
    buffer_load_dwordx4 v[64:67], v3, s[8:11], s29 offen offset:0 sc1
    buffer_load_dwordx4 v[68:71], v3, s[8:11], s29 offen offset:1024 sc1
    buffer_load_dwordx4 v[72:75], v3, s[8:11], s29 offen offset:2048 sc1
    s_waitcnt vmcnt(6) lgkmcnt(4)
    v_mfma_f32_16x16x32_bf16 v[32:35], v[128:131], v[48:51], v[32:35]
    ds_read_b128 v[128:131], v14 offset:8192
    v_mfma_f32_16x16x32_bf16 v[36:39], v[132:135], v[48:51], v[36:39]
    ds_read_b128 v[132:135], v14 offset:9216
    buffer_load_dwordx4 v[76:79], v3, s[8:11], s29 offen offset:3072 sc1
    v_mfma_f32_16x16x32_bf16 v[40:43], v[136:139], v[48:51], v[40:43]
    ds_read_b128 v[136:139], v14 offset:10240
    v_mfma_f32_16x16x32_bf16 v[44:47], v[140:143], v[48:51], v[44:47]
    ds_read_b128 v[140:143], v14 offset:11264
    s_add_u32 s29, s29, 4096
    buffer_load_dwordx4 v[80:83], v3, s[8:11], s29 offen offset:0 sc1
    s_waitcnt vmcnt(7) lgkmcnt(4)
    v_mfma_f32_16x16x32_bf16 v[32:35], v[144:147], v[52:55], v[32:35]
    ds_read_b128 v[144:147], v14 offset:12288
    v_mfma_f32_16x16x32_bf16 v[36:39], v[148:151], v[52:55], v[36:39]
    ds_read_b128 v[148:151], v14 offset:13312
    buffer_load_dwordx4 v[84:87], v3, s[8:11], s29 offen offset:1024 sc1
    v_mfma_f32_16x16x32_bf16 v[40:43], v[152:155], v[52:55], v[40:43]
    ds_read_b128 v[152:155], v14 offset:14336
    v_mfma_f32_16x16x32_bf16 v[44:47], v[156:159], v[52:55], v[44:47]
    ds_read_b128 v[156:159], v14 offset:15360
    buffer_load_dwordx4 v[88:91], v3, s[8:11], s29 offen offset:2048 sc1
    s_waitcnt vmcnt(8) lgkmcnt(4)
    v_mfma_f32_16x16x32_bf16 v[32:35], v[128:131], v[56:59], v[32:35]
    ds_read_b128 v[128:131], v14 offset:16384
    v_mfma_f32_16x16x32_bf16 v[36:39], v[132:135], v[56:59], v[36:39]
    ds_read_b128 v[132:135], v14 offset:17408
    buffer_load_dwordx4 v[92:95], v3, s[8:11], s29 offen offset:3072 sc1
    v_mfma_f32_16x16x32_bf16 v[40:43], v[136:139], v[56:59], v[40:43]
    ds_read_b128 v[136:139], v14 offset:18432
    v_mfma_f32_16x16x32_bf16 v[44:47], v[140:143], v[56:59], v[44:47]
    ds_read_b128 v[140:143], v14 offset:19456
    s_add_u32 s29, s29, 4096
    buffer_load_dwordx4 v[48:51], v3, s[8:11], s29 offen offset:0 sc1
    s_waitcnt vmcnt(9) lgkmcnt(4)
    v_mfma_f32_16x16x32_bf16 v[32:35], v[144:147], v[60:63], v[32:35]
    ds_read_b128 v[144:147], v14 offset:20480
    v_mfma_f32_16x16x32_bf16 v[36:39], v[148:151], v[60:63], v[36:39]
    ds_read_b128 v[148:151], v14 offset:21504
    buffer_load_dwordx4 v[52:55], v3, s[8:11], s29 offen offset:1024 sc1
    v_mfma_f32_16x16x32_bf16 v[40:43], v[152:155], v[60:63], v[40:43]
    ds_read_b128 v[152:155], v14 offset:22528
    v_mfma_f32_16x16x32_bf16 v[44:47], v[156:159], v[60:63], v[44:47]
    ds_read_b128 v[156:159], v14 offset:23552
    buffer_load_dwordx4 v[56:59], v3, s[8:11], s29 offen offset:2048 sc1
    s_waitcnt vmcnt(10) lgkmcnt(4)
    v_mfma_f32_16x16x32_bf16 v[32:35], v[128:131], v[64:67], v[32:35]
    ds_read_b128 v[128:131], v14 offset:24576
    v_mfma_f32_16x16x32_bf16 v[36:39], v[132:135], v[64:67], v[36:39]
    ds_read_b128 v[132:135], v14 offset:25600
    buffer_load_dwordx4 v[60:63], v3, s[8:11], s29 offen offset:3072 sc1
    v_mfma_f32_16x16x32_bf16 v[40:43], v[136:139], v[64:67], v[40:43]
    ds_read_b128 v[136:139], v14 offset:26624
    v_mfma_f32_16x16x32_bf16 v[44:47], v[140:143], v[64:67], v[44:47]
    ds_read_b128 v[140:143], v14 offset:27648
    s_waitcnt vmcnt(10) lgkmcnt(4)
    v_mfma_f32_16x16x32_bf16 v[32:35], v[144:147], v[68:71], v[32:35]
    ds_read_b128 v[144:147], v14 offset:28672
    v_mfma_f32_16x16x32_bf16 v[36:39], v[148:151], v[68:71], v[36:39]
    ds_read_b128 v[148:151], v14 offset:29696
    v_mfma_f32_16x16x32_bf16 v[40:43], v[152:155], v[68:71], v[40:43]
    ds_read_b128 v[152:155], v14 offset:30720
    v_mfma_f32_16x16x32_bf16 v[44:47], v[156:159], v[68:71], v[44:47]
    ds_read_b128 v[156:159], v14 offset:31744
    s_waitcnt vmcnt(9) lgkmcnt(4)
    v_mfma_f32_16x16x32_bf16 v[32:35], v[128:131], v[72:75], v[32:35]
    ds_read_b128 v[128:131], v14 offset:32768
    v_mfma_f32_16x16x32_bf16 v[36:39], v[132:135], v[72:75], v[36:39]
    ds_read_b128 v[132:135], v14 offset:33792
    v_mfma_f32_16x16x32_bf16 v[40:43], v[136:139], v[72:75], v[40:43]
    ds_read_b128 v[136:139], v14 offset:34816
    v_mfma_f32_16x16x32_bf16 v[44:47], v[140:143], v[72:75], v[44:47]
    ds_read_b128 v[140:143], v14 offset:35840
    s_waitcnt vmcnt(8) lgkmcnt(4)
    v_mfma_f32_16x16x32_bf16 v[32:35], v[144:147], v[76:79], v[32:35]
    ds_read_b128 v[144:147], v14 offset:36864
    v_mfma_f32_16x16x32_bf16 v[36:39], v[148:151], v[76:79], v[36:39]
    ds_read_b128 v[148:151], v14 offset:37888
    v_mfma_f32_16x16x32_bf16 v[40:43], v[152:155], v[76:79], v[40:43]
    ds_read_b128 v[152:155], v14 offset:38912
    v_mfma_f32_16x16x32_bf16 v[44:47], v[156:159], v[76:79], v[44:47]
    ds_read_b128 v[156:159], v14 offset:39936
    s_waitcnt vmcnt(7) lgkmcnt(4)
    v_mfma_f32_16x16x32_bf16 v[32:35], v[128:131], v[80:83], v[32:35]
    ds_read_b128 v[128:131], v14 offset:40960
    v_mfma_f32_16x16x32_bf16 v[36:39], v[132:135], v[80:83], v[36:39]
    ds_read_b128 v[132:135], v14 offset:41984
    v_mfma_f32_16x16x32_bf16 v[40:43], v[136:139], v[80:83], v[40:43]
    ds_read_b128 v[136:139], v14 offset:43008
    v_mfma_f32_16x16x32_bf16 v[44:47], v[140:143], v[80:83], v[44:47]
    ds_read_b128 v[140:143], v14 offset:44032
    s_waitcnt vmcnt(6) lgkmcnt(4)
    v_mfma_f32_16x16x32_bf16 v[32:35], v[144:147], v[84:87], v[32:35]
    ds_read_b128 v[144:147], v14 offset:45056
    v_mfma_f32_16x16x32_bf16 v[36:39], v[148:151], v[84:87], v[36:39]
    ds_read_b128 v[148:151], v14 offset:46080
    v_mfma_f32_16x16x32_bf16 v[40:43], v[152:155], v[84:87], v[40:43]
    ds_read_b128 v[152:155], v14 offset:47104
    v_mfma_f32_16x16x32_bf16 v[44:47], v[156:159], v[84:87], v[44:47]
    ds_read_b128 v[156:159], v14 offset:48128
    s_waitcnt vmcnt(5) lgkmcnt(4)
    v_mfma_f32_16x16x32_bf16 v[32:35], v[128:131], v[88:91], v[32:35]
    ds_read_b128 v[128:131], v14 offset:49152
    v_mfma_f32_16x16x32_bf16 v[36:39], v[132:135], v[88:91], v[36:39]
    ds_read_b128 v[132:135], v14 offset:50176
    v_mfma_f32_16x16x32_bf16 v[40:43], v[136:139], v[88:91], v[40:43]
    ds_read_b128 v[136:139], v14 offset:51200
    v_mfma_f32_16x16x32_bf16 v[44:47], v[140:143], v[88:91], v[44:47]
    ds_read_b128 v[140:143], v14 offset:52224
    s_waitcnt vmcnt(4) lgkmcnt(4)
    v_mfma_f32_16x16x32_bf16 v[32:35], v[144:147], v[92:95], v[32:35]
    ds_read_b128 v[144:147], v14 offset:53248
    v_mfma_f32_16x16x32_bf16 v[36:39], v[148:151], v[92:95], v[36:39]
    ds_read_b128 v[148:151], v14 offset:54272
    v_mfma_f32_16x16x32_bf16 v[40:43], v[152:155], v[92:95], v[40:43]
    ds_read_b128 v[152:155], v14 offset:55296
    v_mfma_f32_16x16x32_bf16 v[44:47], v[156:159], v[92:95], v[44:47]
    ds_read_b128 v[156:159], v14 offset:56320
    s_waitcnt vmcnt(3) lgkmcnt(4)
    v_mfma_f32_16x16x32_bf16 v[32:35], v[128:131], v[48:51], v[32:35]
    ds_read_b128 v[128:131], v14 offset:57344
    v_mfma_f32_16x16x32_bf16 v[36:39], v[132:135], v[48:51], v[36:39]
    ds_read_b128 v[132:135], v14 offset:58368
    v_mfma_f32_16x16x32_bf16 v[40:43], v[136:139], v[48:51], v[40:43]
    ds_read_b128 v[136:139], v14 offset:59392
    v_mfma_f32_16x16x32_bf16 v[44:47], v[140:143], v[48:51], v[44:47]
    ds_read_b128 v[140:143], v14 offset:60416
    s_waitcnt vmcnt(2) lgkmcnt(4)
    v_mfma_f32_16x16x32_bf16 v[32:35], v[144:147], v[52:55], v[32:35]
    ds_read_b128 v[144:147], v14 offset:61440
    v_mfma_f32_16x16x32_bf16 v[36:39], v[148:151], v[52:55], v[36:39]
    ds_read_b128 v[148:151], v14 offset:62464
    v_mfma_f32_16x16x32_bf16 v[40:43], v[152:155], v[52:55], v[40:43]
    ds_read_b128 v[152:155], v14 offset:63488
    v_mfma_f32_16x16x32_bf16 v[44:47], v[156:159], v[52:55], v[44:47]
    ds_read_b128 v[156:159], v14 offset:64512
    s_waitcnt vmcnt(1) lgkmcnt(4)
    v_mfma_f32_16x16x32_bf16 v[32:35], v[128:131], v[56:59], v[32:35]
    v_mfma_f32_16x16x32_bf16 v[36:39], v[132:135], v[56:59], v[36:39]
    v_mfma_f32_16x16x32_bf16 v[40:43], v[136:139], v[56:59], v[40:43]
    v_mfma_f32_16x16x32_bf16 v[44:47], v[140:143], v[56:59], v[44:47]
    s_waitcnt vmcnt(0) lgkmcnt(0)
    v_mfma_f32_16x16x32_bf16 v[32:35], v[144:147], v[60:63], v[32:35]
    v_mfma_f32_16x16x32_bf16 v[36:39], v[148:151], v[60:63], v[36:39]
    v_mfma_f32_16x16x32_bf16 v[40:43], v[152:155], v[60:63], v[40:43]
    v_mfma_f32_16x16x32_bf16 v[44:47], v[156:159], v[60:63], v[44:47]
    s_nop 4
    v_cvt_pk_bf16_f32 v16, v32, v33
    v_cvt_pk_bf16_f32 v17, v34, v35
    v_cvt_pk_bf16_f32 v18, v36, v37
    v_cvt_pk_bf16_f32 v19, v38, v39
    v_cvt_pk_bf16_f32 v20, v40, v41
    v_cvt_pk_bf16_f32 v21, v42, v43
    v_cvt_pk_bf16_f32 v22, v44, v45
    v_cvt_pk_bf16_f32 v23, v46, v47
    s_cmp_eq_u32 s61, 0
    s_cbranch_scc1 L_sf79
    buffer_store_dwordx4 v[16:19], v3, s[8:11], s33 offen
    buffer_store_dwordx4 v[20:23], v3, s[8:11], s33 offen offset:1024
    v_pk_add_f32 v[48:49], v[32:33], v[34:35]
    v_pk_mul_f32 v[50:51], v[32:33], v[32:33]
    v_pk_fma_f32 v[50:51], v[34:35], v[34:35], v[50:51]
    v_pk_add_f32 v[48:49], v[48:49], v[36:37]
    v_pk_fma_f32 v[50:51], v[36:37], v[36:37], v[50:51]
    v_pk_add_f32 v[48:49], v[48:49], v[38:39]
    v_pk_fma_f32 v[50:51], v[38:39], v[38:39], v[50:51]
    v_pk_add_f32 v[48:49], v[48:49], v[40:41]
    v_pk_fma_f32 v[50:51], v[40:41], v[40:41], v[50:51]
    v_pk_add_f32 v[48:49], v[48:49], v[42:43]
    v_pk_fma_f32 v[50:51], v[42:43], v[42:43], v[50:51]
    v_pk_add_f32 v[48:49], v[48:49], v[44:45]
    v_pk_fma_f32 v[50:51], v[44:45], v[44:45], v[50:51]
    v_pk_add_f32 v[48:49], v[48:49], v[46:47]
    v_pk_fma_f32 v[50:51], v[46:47], v[46:47], v[50:51]
    v_add_f32 v48, v48, v49
    v_add_f32 v49, v50, v51
    v_mov_b32 v50, v48
    v_mov_b32 v51, v49
    s_nop 0
    v_permlane16_swap_b32 v48, v50
    v_permlane16_swap_b32 v49, v51
    v_add_f32 v48, v48, v50
    v_add_f32 v49, v49, v51
    v_mov_b32 v50, v48
    v_mov_b32 v51, v49
    s_nop 0
    v_permlane32_swap_b32 v48, v50
    v_permlane32_swap_b32 v49, v51
    v_add_f32 v48, v48, v50
    v_add_f32 v49, v49, v51
    s_mov_b64 exec, 0xffff
    buffer_store_dwordx2 v[48:49], v31, s[8:11], s34 offen
    s_mov_b64 exec, -1
    s_barrier
    ds_read_b128 v[128:131], v15 offset:0
    ds_read_b128 v[132:135], v15 offset:1024
    ds_read_b128 v[136:139], v15 offset:2048
    ds_read_b128 v[140:143], v15 offset:3072
    ds_read_b128 v[144:147], v15 offset:4096
    ds_read_b128 v[148:151], v15 offset:5120
    ds_read_b128 v[152:155], v15 offset:6144
    ds_read_b128 v[156:159], v15 offset:7168
    ds_read_b128 v[112:115], v102 offset:28672
    ds_read_b128 v[116:119], v102 offset:28736
    ds_read_b128 v[120:123], v102 offset:28800
    ds_read_b128 v[124:127], v102 offset:28864
    s_waitcnt vmcnt(0)
    s_mov_b64 exec, 1
    buffer_store_dwordx2 v[104:105], off, s[8:11], s35
    s_mov_b64 exec, -1
L_sd80:
    s_add_u32 s29, s36, 262144
    s_add_u32 s33, s33, 4294705152
    s_add_u32 s35, s35, 1152
    s_mov_b64 exec, 0xff
    s_mov_b32 s60, 0
L_poll81:
    buffer_load_dwordx2 v[10:11], v1, s[8:11], s37 offen sc1
    s_add_u32 s60, s60, 1
    s_cmp_gt_u32 s60, 0x20000
    s_waitcnt vmcnt(0)
    s_cbranch_scc1 L_polld82
    v_cmp_ne_u64 vcc, s[58:59], v[10:11]
    s_cbranch_vccnz L_poll81
L_polld82:
    s_mov_b64 exec, -1
    buffer_load_dwordx4 v[26:29], v101, s[8:11], s38 offen sc1
    s_waitcnt lgkmcnt(0)
    buffer_load_dwordx4 v[48:51], v3, s[8:11], s29 offen offset:0 sc1
    buffer_load_dwordx4 v[52:55], v3, s[8:11], s29 offen offset:1024 sc1
    buffer_load_dwordx4 v[56:59], v3, s[8:11], s29 offen offset:2048 sc1
    buffer_load_dwordx4 v[60:63], v3, s[8:11], s29 offen offset:3072 sc1
    s_add_u32 s29, s29, 4096
    buffer_load_dwordx4 v[64:67], v3, s[8:11], s29 offen offset:0 sc1
    buffer_load_dwordx4 v[68:71], v3, s[8:11], s29 offen offset:1024 sc1
    buffer_load_dwordx4 v[72:75], v3, s[8:11], s29 offen offset:2048 sc1
    s_waitcnt vmcnt(6) lgkmcnt(4)
    v_mfma_f32_16x16x32_bf16 v[32:35], v[128:131], v[48:51], 0
    ds_read_b128 v[128:131], v15 offset:8192
    v_mfma_f32_16x16x32_bf16 v[36:39], v[132:135], v[48:51], 0
    ds_read_b128 v[132:135], v15 offset:9216
    buffer_load_dwordx4 v[76:79], v3, s[8:11], s29 offen offset:3072 sc1
    v_mfma_f32_16x16x32_bf16 v[40:43], v[136:139], v[48:51], 0
    ds_read_b128 v[136:139], v15 offset:10240
    v_mfma_f32_16x16x32_bf16 v[44:47], v[140:143], v[48:51], 0
    ds_read_b128 v[140:143], v15 offset:11264
    s_add_u32 s29, s29, 4096
    buffer_load_dwordx4 v[80:83], v3, s[8:11], s29 offen offset:0 sc1
    s_waitcnt vmcnt(7) lgkmcnt(4)
    v_mfma_f32_16x16x32_bf16 v[32:35], v[144:147], v[52:55], v[32:35]
    ds_read_b128 v[144:147], v15 offset:12288
    v_mfma_f32_16x16x32_bf16 v[36:39], v[148:151], v[52:55], v[36:39]
    ds_read_b128 v[148:151], v15 offset:13312
    buffer_load_dwordx4 v[84:87], v3, s[8:11], s29 offen offset:1024 sc1
    v_mfma_f32_16x16x32_bf16 v[40:43], v[152:155], v[52:55], v[40:43]
    ds_read_b128 v[152:155], v15 offset:14336
    v_mfma_f32_16x16x32_bf16 v[44:47], v[156:159], v[52:55], v[44:47]
    ds_read_b128 v[156:159], v15 offset:15360
    buffer_load_dwordx4 v[88:91], v3, s[8:11], s29 offen offset:2048 sc1
    s_waitcnt vmcnt(8) lgkmcnt(4)
    v_mfma_f32_16x16x32_bf16 v[32:35], v[128:131], v[56:59], v[32:35]
    ds_read_b128 v[128:131], v15 offset:16384
    v_mfma_f32_16x16x32_bf16 v[36:39], v[132:135], v[56:59], v[36:39]
    ds_read_b128 v[132:135], v15 offset:17408
    buffer_load_dwordx4 v[92:95], v3, s[8:11], s29 offen offset:3072 sc1
    v_mfma_f32_16x16x32_bf16 v[40:43], v[136:139], v[56:59], v[40:43]
    ds_read_b128 v[136:139], v15 offset:18432
    v_mfma_f32_16x16x32_bf16 v[44:47], v[140:143], v[56:59], v[44:47]
    ds_read_b128 v[140:143], v15 offset:19456
    s_add_u32 s29, s29, 4096
    buffer_load_dwordx4 v[48:51], v3, s[8:11], s29 offen offset:0 sc1
    s_waitcnt vmcnt(9) lgkmcnt(4)
    v_mfma_f32_16x16x32_bf16 v[32:35], v[144:147], v[60:63], v[32:35]
    ds_read_b128 v[144:147], v15 offset:20480
    v_mfma_f32_16x16x32_bf16 v[36:39], v[148:151], v[60:63], v[36:39]
    ds_read_b128 v[148:151], v15 offset:21504
    buffer_load_dwordx4 v[52:55], v3, s[8:11], s29 offen offset:1024 sc1
    v_mfma_f32_16x16x32_bf16 v[40:43], v[152:155], v[60:63], v[40:43]
    ds_read_b128 v[152:155], v15 offset:22528
    v_mfma_f32_16x16x32_bf16 v[44:47], v[156:159], v[60:63], v[44:47]
    ds_read_b128 v[156:159], v15 offset:23552
    buffer_load_dwordx4 v[56:59], v3, s[8:11], s29 offen offset:2048 sc1
    s_waitcnt vmcnt(10) lgkmcnt(4)
    v_mfma_f32_16x16x32_bf16 v[32:35], v[128:131], v[64:67], v[32:35]
    ds_read_b128 v[128:131], v15 offset:24576
    v_add_f32 v26, v26, v28
    v_mfma_f32_16x16x32_bf16 v[36:39], v[132:135], v[64:67], v[36:39]
    ds_read_b128 v[132:135], v15 offset:25600
    buffer_load_dwordx4 v[60:63], v3, s[8:11], s29 offen offset:3072 sc1
    v_add_f32 v27, v27, v29
    v_mfma_f32_16x16x32_bf16 v[40:43], v[136:139], v[64:67], v[40:43]
    ds_read_b128 v[136:139], v15 offset:26624
    v_mov_b32 v28, v26
    v_mfma_f32_16x16x32_bf16 v[44:47], v[140:143], v[64:67], v[44:47]
    ds_read_b128 v[140:143], v15 offset:27648
    v_mov_b32 v29, v27
    s_waitcnt vmcnt(10) lgkmcnt(4)
    v_mfma_f32_16x16x32_bf16 v[32:35], v[144:147], v[68:71], v[32:35]
    ds_read_b128 v[144:147], v15 offset:28672
    v_permlane16_swap_b32 v26, v28
    v_mfma_f32_16x16x32_bf16 v[36:39], v[148:151], v[68:71], v[36:39]
    ds_read_b128 v[148:151], v15 offset:29696
    v_permlane16_swap_b32 v27, v29
    v_mfma_f32_16x16x32_bf16 v[40:43], v[152:155], v[68:71], v[40:43]
    ds_read_b128 v[152:155], v15 offset:30720
    v_add_f32 v26, v26, v28
    v_mfma_f32_16x16x32_bf16 v[44:47], v[156:159], v[68:71], v[44:47]
    ds_read_b128 v[156:159], v15 offset:31744
    v_add_f32 v27, v27, v29
    s_waitcnt vmcnt(9) lgkmcnt(4)
    v_mfma_f32_16x16x32_bf16 v[32:35], v[128:131], v[72:75], v[32:35]
    ds_read_b128 v[128:131], v3 offset:0
    v_mov_b32 v28, v26
    v_mfma_f32_16x16x32_bf16 v[36:39], v[132:135], v[72:75], v[36:39]
    ds_read_b128 v[132:135], v3 offset:1024
    v_mov_b32 v29, v27
    v_mfma_f32_16x16x32_bf16 v[40:43], v[136:139], v[72:75], v[40:43]
    ds_read_b128 v[136:139], v3 offset:2048
    v_permlane32_swap_b32 v26, v28
    v_mfma_f32_16x16x32_bf16 v[44:47], v[140:143], v[72:75], v[44:47]
    ds_read_b128 v[140:143], v3 offset:3072
    v_permlane32_swap_b32 v27, v29
    s_waitcnt vmcnt(8) lgkmcnt(4)
    v_mfma_f32_16x16x32_bf16 v[32:35], v[144:147], v[76:79], v[32:35]
    ds_read_b128 v[144:147], v3 offset:4096
    v_add_f32 v26, v26, v28
    v_mfma_f32_16x16x32_bf16 v[36:39], v[148:151], v[76:79], v[36:39]
    ds_read_b128 v[148:151], v3 offset:5120
    v_add_f32 v27, v27, v29
    v_mfma_f32_16x16x32_bf16 v[40:43], v[152:155], v[76:79], v[40:43]
    ds_read_b128 v[152:155], v3 offset:6144
    v_mul_f32 v24, 0xbb000000, v26
    v_mfma_f32_16x16x32_bf16 v[44:47], v[156:159], v[76:79], v[44:47]
    ds_read_b128 v[156:159], v3 offset:7168
    v_mul_f32 v27, 0x3b000000, v27
    s_waitcnt vmcnt(7) lgkmcnt(4)
    v_mfma_f32_16x16x32_bf16 v[32:35], v[128:131], v[80:83], v[32:35]
    ds_read_b128 v[128:131], v3 offset:8192
    v_fma_f32 v27, -v24, v24, v27
    v_mfma_f32_16x16x32_bf16 v[36:39], v[132:135], v[80:83], v[36:39]
    ds_read_b128 v[132:135], v3 offset:9216
    v_max_f32 v27, 0, v27
    v_mfma_f32_16x16x32_bf16 v[40:43], v[136:139], v[80:83], v[40:43]
    ds_read_b128 v[136:139], v3 offset:10240
    v_add_f32 v28, 0x3727c5ac, v27
    v_mfma_f32_16x16x32_bf16 v[44:47], v[140:143], v[80:83], v[44:47]
    ds_read_b128 v[140:143], v3 offset:11264
    v_rsq_f32 v26, v28
    s_waitcnt vmcnt(6) lgkmcnt(4)
    v_mfma_f32_16x16x32_bf16 v[32:35], v[144:147], v[84:87], v[32:35]
    ds_read_b128 v[144:147], v3 offset:12288
    v_mul_f32 v28, v26, v26
    v_mfma_f32_16x16x32_bf16 v[36:39], v[148:151], v[84:87], v[36:39]
    ds_read_b128 v[148:151], v3 offset:13312
    v_fmaak_f32 v28, v28, v27, 0x3727c5ac
    v_mfma_f32_16x16x32_bf16 v[40:43], v[152:155], v[84:87], v[40:43]
    ds_read_b128 v[152:155], v3 offset:14336
    v_rsq_f32 v28, v28
    v_mfma_f32_16x16x32_bf16 v[44:47], v[156:159], v[84:87], v[44:47]
    ds_read_b128 v[156:159], v3 offset:15360
    v_mul_f32 v28, v28, v26
    s_waitcnt vmcnt(5) lgkmcnt(4)
    v_mfma_f32_16x16x32_bf16 v[32:35], v[128:131], v[88:91], v[32:35]
    ds_read_b128 v[128:131], v3 offset:16384
    v_mul_f32 v29, v28, v24
    v_mfma_f32_16x16x32_bf16 v[36:39], v[132:135], v[88:91], v[36:39]
    ds_read_b128 v[132:135], v3 offset:17408
    v_mul_f32 v24, v24, v26
    v_mfma_f32_16x16x32_bf16 v[40:43], v[136:139], v[88:91], v[40:43]
    ds_read_b128 v[136:139], v3 offset:18432
    v_mul_f32 v112, v29, v112
    v_mfma_f32_16x16x32_bf16 v[44:47], v[140:143], v[88:91], v[44:47]
    ds_read_b128 v[140:143], v3 offset:19456
    v_mul_f32 v113, v29, v113
    s_waitcnt vmcnt(4) lgkmcnt(4)
    v_mfma_f32_16x16x32_bf16 v[32:35], v[144:147], v[92:95], v[32:35]
    ds_read_b128 v[144:147], v3 offset:20480
    v_mul_f32 v114, v29, v114
    v_mfma_f32_16x16x32_bf16 v[36:39], v[148:151], v[92:95], v[36:39]
    ds_read_b128 v[148:151], v3 offset:21504
    v_mul_f32 v115, v29, v115
    v_mfma_f32_16x16x32_bf16 v[40:43], v[152:155], v[92:95], v[40:43]
    ds_read_b128 v[152:155], v3 offset:22528
    v_mul_f32 v116, v29, v116
    v_mfma_f32_16x16x32_bf16 v[44:47], v[156:159], v[92:95], v[44:47]
    ds_read_b128 v[156:159], v3 offset:23552
    v_mul_f32 v117, v29, v117
    s_waitcnt vmcnt(3) lgkmcnt(4)
    v_mfma_f32_16x16x32_bf16 v[32:35], v[128:131], v[48:51], v[32:35]
    ds_read_b128 v[128:131], v3 offset:24576
    v_mul_f32 v118, v29, v118
    v_mfma_f32_16x16x32_bf16 v[36:39], v[132:135], v[48:51], v[36:39]
    ds_read_b128 v[132:135], v3 offset:25600
    v_mul_f32 v119, v29, v119
    v_mfma_f32_16x16x32_bf16 v[40:43], v[136:139], v[48:51], v[40:43]
    ds_read_b128 v[136:139], v3 offset:26624
    v_mul_f32 v120, v29, v120
    v_mfma_f32_16x16x32_bf16 v[44:47], v[140:143], v[48:51], v[44:47]
    ds_read_b128 v[140:143], v3 offset:27648
    v_mul_f32 v121, v29, v121
    s_waitcnt vmcnt(2) lgkmcnt(4)
    v_mfma_f32_16x16x32_bf16 v[32:35], v[144:147], v[52:55], v[32:35]
    ds_read_b128 v[144:147], v15 offset:32768
    v_mul_f32 v122, v29, v122
    v_mfma_f32_16x16x32_bf16 v[36:39], v[148:151], v[52:55], v[36:39]
    ds_read_b128 v[148:151], v15 offset:33792
    v_mul_f32 v123, v29, v123
    v_mfma_f32_16x16x32_bf16 v[40:43], v[152:155], v[52:55], v[40:43]
    ds_read_b128 v[152:155], v15 offset:34816
    v_mul_f32 v124, v29, v124
    v_mfma_f32_16x16x32_bf16 v[44:47], v[156:159], v[52:55], v[44:47]
    ds_read_b128 v[156:159], v15 offset:35840
    v_mul_f32 v125, v29, v125
    s_waitcnt vmcnt(1) lgkmcnt(4)
    v_mfma_f32_16x16x32_bf16 v[32:35], v[128:131], v[56:59], v[32:35]
    v_mul_f32 v126, v29, v126
    v_mfma_f32_16x16x32_bf16 v[36:39], v[132:135], v[56:59], v[36:39]
    v_mul_f32 v127, v29, v127
    v_mfma_f32_16x16x32_bf16 v[40:43], v[136:139], v[56:59], v[40:43]
    v_mfma_f32_16x16x32_bf16 v[44:47], v[140:143], v[56:59], v[44:47]
    s_waitcnt vmcnt(0) lgkmcnt(0)
    v_mfma_f32_16x16x32_bf16 v[32:35], v[144:147], v[60:63], v[32:35]
    v_mfma_f32_16x16x32_bf16 v[36:39], v[148:151], v[60:63], v[36:39]
    v_mfma_f32_16x16x32_bf16 v[40:43], v[152:155], v[60:63], v[40:43]
    v_mfma_f32_16x16x32_bf16 v[44:47], v[156:159], v[60:63], v[44:47]
    s_nop 4
    v_pk_fma_f32 v[32:33], v[32:33], v[28:29], v[112:113] op_sel_hi:[1,0,1]
    v_pk_fma_f32 v[34:35], v[34:35], v[28:29], v[114:115] op_sel_hi:[1,0,1]
    v_pk_fma_f32 v[36:37], v[36:37], v[28:29], v[116:117] op_sel_hi:[1,0,1]
    v_pk_fma_f32 v[38:39], v[38:39], v[28:29], v[118:119] op_sel_hi:[1,0,1]
    v_pk_fma_f32 v[40:41], v[40:41], v[28:29], v[120:121] op_sel_hi:[1,0,1]
    v_pk_fma_f32 v[42:43], v[42:43], v[28:29], v[122:123] op_sel_hi:[1,0,1]
    v_pk_fma_f32 v[44:45], v[44:45], v[28:29], v[124:125] op_sel_hi:[1,0,1]
    v_pk_fma_f32 v[46:47], v[46:47], v[28:29], v[126:127] op_sel_hi:[1,0,1]
    v_pk_mul_f32 v[48:49], v[32:33], v[32:33]
    v_pk_mul_f32 v[50:51], v[34:35], v[34:35]
    v_pk_mul_f32 v[52:53], v[36:37], v[36:37]
    v_pk_mul_f32 v[54:55], v[38:39], v[38:39]
    v_pk_mul_f32 v[56:57], v[40:41], v[40:41]
    v_pk_mul_f32 v[58:59], v[42:43], v[42:43]
    v_pk_mul_f32 v[60:61], v[44:45], v[44:45]
    v_pk_mul_f32 v[62:63], v[46:47], v[46:47]
    v_pk_fma_f32 v[48:49], v[48:49], s[62:63], v[12:13]
    v_pk_fma_f32 v[50:51], v[50:51], s[62:63], v[12:13]
    v_pk_fma_f32 v[52:53], v[52:53], s[62:63], v[12:13]
    v_pk_fma_f32 v[54:55], v[54:55], s[62:63], v[12:13]
    v_pk_fma_f32 v[56:57], v[56:57], s[62:63], v[12:13]
    v_pk_fma_f32 v[58:59], v[58:59], s[62:63], v[12:13]
    v_pk_fma_f32 v[60:61], v[60:61], s[62:63], v[12:13]
    v_pk_fma_f32 v[62:63], v[62:63], s[62:63], v[12:13]
    v_pk_mul_f32 v[48:49], v[48:49], v[32:33]
    v_pk_mul_f32 v[50:51], v[50:51], v[34:35]
    v_pk_mul_f32 v[52:53], v[52:53], v[36:37]
    v_pk_mul_f32 v[54:55], v[54:55], v[38:39]
    v_pk_mul_f32 v[56:57], v[56:57], v[40:41]
    v_pk_mul_f32 v[58:59], v[58:59], v[42:43]
    v_pk_mul_f32 v[60:61], v[60:61], v[44:45]
    v_pk_mul_f32 v[62:63], v[62:63], v[46:47]
    v_exp_f32 v48, v48
    v_exp_f32 v49, v49
    v_exp_f32 v50, v50
    v_exp_f32 v51, v51
    v_exp_f32 v52, v52
    v_exp_f32 v53, v53
    v_exp_f32 v54, v54
    v_exp_f32 v55, v55
    v_exp_f32 v56, v56
    v_exp_f32 v57, v57
    v_exp_f32 v58, v58
    v_exp_f32 v59, v59
    v_exp_f32 v60, v60
    v_exp_f32 v61, v61
    v_exp_f32 v62, v62
    v_exp_f32 v63, v63
    v_pk_add_f32 v[48:49], v[48:49], s[64:65]
    v_pk_add_f32 v[50:51], v[50:51], s[64:65]
    v_pk_add_f32 v[52:53], v[52:53], s[64:65]
    v_pk_add_f32 v[54:55], v[54:55], s[64:65]
    v_pk_add_f32 v[56:57], v[56:57], s[64:65]
    v_pk_add_f32 v[58:59], v[58:59], s[64:65]
    v_pk_add_f32 v[60:61], v[60:61], s[64:65]
    v_pk_add_f32 v[62:63], v[62:63], s[64:65]
    v_rcp_f32 v48, v48
    v_rcp_f32 v49, v49
    v_rcp_f32 v50, v50
    v_rcp_f32 v51, v51
    v_rcp_f32 v52, v52
    v_rcp_f32 v53, v53
    v_rcp_f32 v54, v54
    v_rcp_f32 v55, v55
    v_rcp_f32 v56, v56
    v_rcp_f32 v57, v57
    v_rcp_f32 v58, v58
    v_rcp_f32 v59, v59
    v_rcp_f32 v60, v60
    v_rcp_f32 v61, v61
    v_rcp_f32 v62, v62
    v_rcp_f32 v63, v63
    v_pk_mul_f32 v[32:33], v[32:33], v[48:49]
    v_pk_mul_f32 v[34:35], v[34:35], v[50:51]
    v_pk_mul_f32 v[36:37], v[36:37], v[52:53]
    v_pk_mul_f32 v[38:39], v[38:39], v[54:55]
    v_pk_mul_f32 v[40:41], v[40:41], v[56:57]
    v_pk_mul_f32 v[42:43], v[42:43], v[58:59]
    v_pk_mul_f32 v[44:45], v[44:45], v[60:61]
    v_pk_mul_f32 v[46:47], v[46:47], v[62:63]
    v_cvt_pk_bf16_f32 v64, v32, v33
    v_cvt_pk_bf16_f32 v65, v34, v35
    v_cvt_pk_bf16_f32 v66, v36, v37
    v_cvt_pk_bf16_f32 v67, v38, v39
    v_cvt_pk_bf16_f32 v68, v40, v41
    v_cvt_pk_bf16_f32 v69, v42, v43
    v_cvt_pk_bf16_f32 v70, v44, v45
    v_cvt_pk_bf16_f32 v71, v46, v47
    s_cmp_eq_u32 s71, 0
    s_cbranch_scc1 L_sf83
    buffer_store_dwordx4 v[64:67], v3, s[8:11], s33 offen
    buffer_store_dwordx4 v[68:71], v3, s[8:11], s33 offen offset:1024
L_sd84:
    s_barrier
    ds_read_b128 v[128:131], v15 offset:36864
    ds_read_b128 v[132:135], v15 offset:37888
    ds_read_b128 v[136:139], v15 offset:38912
    ds_read_b128 v[140:143], v15 offset:39936
    ds_read_b128 v[144:147], v15 offset:40960
    ds_read_b128 v[148:151], v15 offset:41984
    ds_read_b128 v[152:155], v15 offset:43008
    ds_read_b128 v[156:159], v15 offset:44032
    v_lshlrev_b32 v32, 16, v16
    v_and_b32 v33, 0xffff0000, v16
    v_lshlrev_b32 v34, 16, v17
    v_and_b32 v35, 0xffff0000, v17
    v_lshlrev_b32 v36, 16, v18
    v_and_b32 v37, 0xffff0000, v18
    v_lshlrev_b32 v38, 16, v19
    v_and_b32 v39, 0xffff0000, v19
    v_lshlrev_b32 v40, 16, v20
    v_and_b32 v41, 0xffff0000, v20
    v_lshlrev_b32 v42, 16, v21
    v_and_b32 v43, 0xffff0000, v21
    v_lshlrev_b32 v44, 16, v22
    v_and_b32 v45, 0xffff0000, v22
    v_lshlrev_b32 v46, 16, v23
    v_and_b32 v47, 0xffff0000, v23
    v_pk_fma_f32 v[32:33], v[32:33], v[26:27], v[24:25] op_sel_hi:[1,0,0]
    v_pk_fma_f32 v[34:35], v[34:35], v[26:27], v[24:25] op_sel_hi:[1,0,0]
    v_pk_fma_f32 v[36:37], v[36:37], v[26:27], v[24:25] op_sel_hi:[1,0,0]
    v_pk_fma_f32 v[38:39], v[38:39], v[26:27], v[24:25] op_sel_hi:[1,0,0]
    v_pk_fma_f32 v[40:41], v[40:41], v[26:27], v[24:25] op_sel_hi:[1,0,0]
    v_pk_fma_f32 v[42:43], v[42:43], v[26:27], v[24:25] op_sel_hi:[1,0,0]
    v_pk_fma_f32 v[44:45], v[44:45], v[26:27], v[24:25] op_sel_hi:[1,0,0]
    v_pk_fma_f32 v[46:47], v[46:47], v[26:27], v[24:25] op_sel_hi:[1,0,0]
    s_waitcnt vmcnt(0)
    s_cmp_eq_u32 s61, 0
    s_cbranch_scc1 L_sf85
    s_mov_b64 exec, 1
    buffer_store_dwordx2 v[104:105], off, s[8:11], s35
    s_mov_b64 exec, -1
L_sd86:
    s_cmp_eq_u32 s73, 0
    s_cbranch_scc1 L_hx87
    s_mov_b64 exec, 1
    buffer_store_dwordx2 v[104:105], off, s[8:11], s74 sc1
    s_mov_b64 exec, -1
L_hx87:
    s_add_u32 s33, s33, 262144
    s_add_u32 s34, s34, 16384
    s_add_u32 s35, s35, 1920
    s_mov_b64 exec, s[40:41]
    s_mov_b32 s60, 0
L_poll88:
    buffer_load_dwordx2 v[10:11], v100, s[8:11], s3 offen sc1
    s_add_u32 s60, s60, 1
    s_cmp_gt_u32 s60, 0x20000
    s_waitcnt vmcnt(0)
    s_cbranch_scc1 L_polld89
    v_cmp_ne_u64 vcc, s[58:59], v[10:11]
    s_cbranch_vccnz L_poll88
L_polld89:
    s_mov_b64 exec, -1
    s_mov_b32 s29, 8388608
    buffer_load_dwordx4 v[48:51], v96, s[8:11], s29 offen offset:0 sc1
    buffer_load_dwordx4 v[52:55], v96, s[8:11], s29 offen offset:1024 sc1
    buffer_load_dwordx4 v[56:59], v96, s[8:11], s29 offen offset:2048 sc1
    buffer_load_dwordx4 v[60:63], v96, s[8:11], s29 offen offset:3072 sc1
    s_mov_b32 s29, 8392704
    buffer_load_dwordx4 v[64:67], v97, s[8:11], s29 offen offset:0 sc1
    buffer_load_dwordx4 v[68:71], v97, s[8:11], s29 offen offset:1024 sc1
    buffer_load_dwordx4 v[72:75], v97, s[8:11], s29 offen offset:2048 sc1
    s_waitcnt vmcnt(6) lgkmcnt(4)
    v_mfma_f32_16x16x32_bf16 v[32:35], v[128:131], v[48:51], v[32:35]
    ds_read_b128 v[128:131], v15 offset:45056
    v_mfma_f32_16x16x32_bf16 v[36:39], v[132:135], v[48:51], v[36:39]
    ds_read_b128 v[132:135], v15 offset:46080
    buffer_load_dwordx4 v[76:79], v97, s[8:11], s29 offen offset:3072 sc1
    v_mfma_f32_16x16x32_bf16 v[40:43], v[136:139], v[48:51], v[40:43]
    ds_read_b128 v[136:139], v15 offset:47104
    v_mfma_f32_16x16x32_bf16 v[44:47], v[140:143], v[48:51], v[44:47]
    ds_read_b128 v[140:143], v15 offset:48128
    s_mov_b32 s29, 8396800
    buffer_load_dwordx4 v[80:83], v98, s[8:11], s29 offen offset:0 sc1
    s_waitcnt vmcnt(7) lgkmcnt(4)
    v_mfma_f32_16x16x32_bf16 v[32:35], v[144:147], v[52:55], v[32:35]
    ds_read_b128 v[144:147], v15 offset:49152
    v_mfma_f32_16x16x32_bf16 v[36:39], v[148:151], v[52:55], v[36:39]
    ds_read_b128 v[148:151], v15 offset:50176
    buffer_load_dwordx4 v[84:87], v98, s[8:11], s29 offen offset:1024 sc1
    v_mfma_f32_16x16x32_bf16 v[40:43], v[152:155], v[52:55], v[40:43]
    ds_read_b128 v[152:155], v15 offset:51200
    v_mfma_f32_16x16x32_bf16 v[44:47], v[156:159], v[52:55], v[44:47]
    ds_read_b128 v[156:159], v15 offset:52224
    buffer_load_dwordx4 v[88:91], v98, s[8:11], s29 offen offset:2048 sc1
    s_waitcnt vmcnt(8) lgkmcnt(4)
    v_mfma_f32_16x16x32_bf16 v[32:35], v[128:131], v[56:59], v[32:35]
    ds_read_b128 v[128:131], v15 offset:53248
    v_mfma_f32_16x16x32_bf16 v[36:39], v[132:135], v[56:59], v[36:39]
    ds_read_b128 v[132:135], v15 offset:54272
    buffer_load_dwordx4 v[92:95], v98, s[8:11], s29 offen offset:3072 sc1
    v_mfma_f32_16x16x32_bf16 v[40:43], v[136:139], v[56:59], v[40:43]
    ds_read_b128 v[136:139], v15 offset:55296
    v_mfma_f32_16x16x32_bf16 v[44:47], v[140:143], v[56:59], v[44:47]
    ds_read_b128 v[140:143], v15 offset:56320
    s_mov_b32 s29, 8400896
    buffer_load_dwordx4 v[48:51], v99, s[8:11], s29 offen offset:0 sc1
    s_waitcnt vmcnt(9) lgkmcnt(4)
    v_mfma_f32_16x16x32_bf16 v[32:35], v[144:147], v[60:63], v[32:35]
    ds_read_b128 v[144:147], v15 offset:57344
    v_mfma_f32_16x16x32_bf16 v[36:39], v[148:151], v[60:63], v[36:39]
    ds_read_b128 v[148:151], v15 offset:58368
    buffer_load_dwordx4 v[52:55], v99, s[8:11], s29 offen offset:1024 sc1
    v_mfma_f32_16x16x32_bf16 v[40:43], v[152:155], v[60:63], v[40:43]
    ds_read_b128 v[152:155], v15 offset:59392
    v_mfma_f32_16x16x32_bf16 v[44:47], v[156:159], v[60:63], v[44:47]
    ds_read_b128 v[156:159], v15 offset:60416
    buffer_load_dwordx4 v[56:59], v99, s[8:11], s29 offen offset:2048 sc1
    s_waitcnt vmcnt(10) lgkmcnt(4)
    v_mfma_f32_16x16x32_bf16 v[32:35], v[128:131], v[64:67], v[32:35]
    ds_read_b128 v[128:131], v15 offset:61440
    v_mfma_f32_16x16x32_bf16 v[36:39], v[132:135], v[64:67], v[36:39]
    ds_read_b128 v[132:135], v15 offset:62464
    buffer_load_dwordx4 v[60:63], v99, s[8:11], s29 offen offset:3072 sc1
    v_mfma_f32_16x16x32_bf16 v[40:43], v[136:139], v[64:67], v[40:43]
    ds_read_b128 v[136:139], v15 offset:63488
    v_mfma_f32_16x16x32_bf16 v[44:47], v[140:143], v[64:67], v[44:47]
    ds_read_b128 v[140:143], v15 offset:64512
    s_waitcnt vmcnt(10) lgkmcnt(4)
    v_mfma_f32_16x16x32_bf16 v[32:35], v[144:147], v[68:71], v[32:35]
    ds_read_b128 v[144:147], v14 offset:28672
    v_mfma_f32_16x16x32_bf16 v[36:39], v[148:151], v[68:71], v[36:39]
    ds_read_b128 v[148:151], v14 offset:29696
    v_mfma_f32_16x16x32_bf16 v[40:43], v[152:155], v[68:71], v[40:43]
    ds_read_b128 v[152:155], v14 offset:30720
    v_mfma_f32_16x16x32_bf16 v[44:47], v[156:159], v[68:71], v[44:47]
    ds_read_b128 v[156:159], v14 offset:31744
    s_waitcnt vmcnt(9) lgkmcnt(4)
    v_mfma_f32_16x16x32_bf16 v[32:35], v[128:131], v[72:75], v[32:35]
    ds_read_b128 v[128:131], v14 offset:32768
    v_mfma_f32_16x16x32_bf16 v[36:39], v[132:135], v[72:75], v[36:39]
    ds_read_b128 v[132:135], v14 offset:33792
    v_mfma_f32_16x16x32_bf16 v[40:43], v[136:139], v[72:75], v[40:43]
    ds_read_b128 v[136:139], v14 offset:34816
    v_mfma_f32_16x16x32_bf16 v[44:47], v[140:143], v[72:75], v[44:47]
    ds_read_b128 v[140:143], v14 offset:35840
    s_waitcnt vmcnt(8) lgkmcnt(4)
    v_mfma_f32_16x16x32_bf16 v[32:35], v[144:147], v[76:79], v[32:35]
    ds_read_b128 v[144:147], v14 offset:36864
    v_mfma_f32_16x16x32_bf16 v[36:39], v[148:151], v[76:79], v[36:39]
    ds_read_b128 v[148:151], v14 offset:37888
    v_mfma_f32_16x16x32_bf16 v[40:43], v[152:155], v[76:79], v[40:43]
    ds_read_b128 v[152:155], v14 offset:38912
    v_mfma_f32_16x16x32_bf16 v[44:47], v[156:159], v[76:79], v[44:47]
    ds_read_b128 v[156:159], v14 offset:39936
    s_waitcnt vmcnt(7) lgkmcnt(4)
    v_mfma_f32_16x16x32_bf16 v[32:35], v[128:131], v[80:83], v[32:35]
    ds_read_b128 v[128:131], v14 offset:40960
    v_mfma_f32_16x16x32_bf16 v[36:39], v[132:135], v[80:83], v[36:39]
    ds_read_b128 v[132:135], v14 offset:41984
    v_mfma_f32_16x16x32_bf16 v[40:43], v[136:139], v[80:83], v[40:43]
    ds_read_b128 v[136:139], v14 offset:43008
    v_mfma_f32_16x16x32_bf16 v[44:47], v[140:143], v[80:83], v[44:47]
    ds_read_b128 v[140:143], v14 offset:44032
    s_waitcnt vmcnt(6) lgkmcnt(4)
    v_mfma_f32_16x16x32_bf16 v[32:35], v[144:147], v[84:87], v[32:35]
    ds_read_b128 v[144:147], v14 offset:45056
    v_mfma_f32_16x16x32_bf16 v[36:39], v[148:151], v[84:87], v[36:39]
    ds_read_b128 v[148:151], v14 offset:46080
    v_mfma_f32_16x16x32_bf16 v[40:43], v[152:155], v[84:87], v[40:43]
    ds_read_b128 v[152:155], v14 offset:47104
    v_mfma_f32_16x16x32_bf16 v[44:47], v[156:159], v[84:87], v[44:47]
    ds_read_b128 v[156:159], v14 offset:48128
    s_waitcnt vmcnt(5) lgkmcnt(4)
    v_mfma_f32_16x16x32_bf16 v[32:35], v[128:131], v[88:91], v[32:35]
    ds_read_b128 v[128:131], v14 offset:49152
    v_mfma_f32_16x16x32_bf16 v[36:39], v[132:135], v[88:91], v[36:39]
    ds_read_b128 v[132:135], v14 offset:50176
    v_mfma_f32_16x16x32_bf16 v[40:43], v[136:139], v[88:91], v[40:43]
    ds_read_b128 v[136:139], v14 offset:51200
    v_mfma_f32_16x16x32_bf16 v[44:47], v[140:143], v[88:91], v[44:47]
    ds_read_b128 v[140:143], v14 offset:52224
    s_waitcnt vmcnt(4) lgkmcnt(4)
    v_mfma_f32_16x16x32_bf16 v[32:35], v[144:147], v[92:95], v[32:35]
    ds_read_b128 v[144:147], v14 offset:53248
    v_mfma_f32_16x16x32_bf16 v[36:39], v[148:151], v[92:95], v[36:39]
    ds_read_b128 v[148:151], v14 offset:54272
    v_mfma_f32_16x16x32_bf16 v[40:43], v[152:155], v[92:95], v[40:43]
    ds_read_b128 v[152:155], v14 offset:55296
    v_mfma_f32_16x16x32_bf16 v[44:47], v[156:159], v[92:95], v[44:47]
    ds_read_b128 v[156:159], v14 offset:56320
    s_waitcnt vmcnt(3) lgkmcnt(4)
    v_mfma_f32_16x16x32_bf16 v[32:35], v[128:131], v[48:51], v[32:35]
    ds_read_b128 v[128:131], v14 offset:57344
    v_mfma_f32_16x16x32_bf16 v[36:39], v[132:135], v[48:51], v[36:39]
    ds_read_b128 v[132:135], v14 offset:58368
    v_mfma_f32_16x16x32_bf16 v[40:43], v[136:139], v[48:51], v[40:43]
    ds_read_b128 v[136:139], v14 offset:59392
    v_mfma_f32_16x16x32_bf16 v[44:47], v[140:143], v[48:51], v[44:47]
    ds_read_b128 v[140:143], v14 offset:60416
    s_waitcnt vmcnt(2) lgkmcnt(4)
    v_mfma_f32_16x16x32_bf16 v[32:35], v[144:147], v[52:55], v[32:35]
    ds_read_b128 v[144:147], v14 offset:61440
    v_mfma_f32_16x16x32_bf16 v[36:39], v[148:151], v[52:55], v[36:39]
    ds_read_b128 v[148:151], v14 offset:62464
    v_mfma_f32_16x16x32_bf16 v[40:43], v[152:155], v[52:55], v[40:43]
    ds_read_b128 v[152:155], v14 offset:63488
    v_mfma_f32_16x16x32_bf16 v[44:47], v[156:159], v[52:55], v[44:47]
    ds_read_b128 v[156:159], v14 offset:64512
    s_waitcnt vmcnt(1) lgkmcnt(4)
    v_mfma_f32_16x16x32_bf16 v[32:35], v[128:131], v[56:59], v[32:35]
    v_mfma_f32_16x16x32_bf16 v[36:39], v[132:135], v[56:59], v[36:39]
    v_mfma_f32_16x16x32_bf16 v[40:43], v[136:139], v[56:59], v[40:43]
    v_mfma_f32_16x16x32_bf16 v[44:47], v[140:143], v[56:59], v[44:47]
    s_waitcnt vmcnt(0) lgkmcnt(0)
    v_mfma_f32_16x16x32_bf16 v[32:35], v[144:147], v[60:63], v[32:35]
    v_mfma_f32_16x16x32_bf16 v[36:39], v[148:151], v[60:63], v[36:39]
    v_mfma_f32_16x16x32_bf16 v[40:43], v[152:155], v[60:63], v[40:43]
    v_mfma_f32_16x16x32_bf16 v[44:47], v[156:159], v[60:63], v[44:47]
    s_nop 4
    v_cvt_pk_bf16_f32 v64, v32, v33
    v_cvt_pk_bf16_f32 v65, v34, v35
    v_cvt_pk_bf16_f32 v66, v36, v37
    v_cvt_pk_bf16_f32 v67, v38, v39
    v_cvt_pk_bf16_f32 v68, v40, v41
    v_cvt_pk_bf16_f32 v69, v42, v43
    v_cvt_pk_bf16_f32 v70, v44, v45
    v_cvt_pk_bf16_f32 v71, v46, v47
    s_cmp_eq_u32 s61, 0
    s_cbranch_scc1 L_sf90
    buffer_store_dwordx4 v[64:67], v3, s[8:11], s33 offen
    buffer_store_dwordx4 v[68:71], v3, s[8:11], s33 offen offset:1024
    v_pk_add_f32 v[48:49], v[32:33], v[34:35]
    v_pk_mul_f32 v[50:51], v[32:33], v[32:33]
    v_pk_fma_f32 v[50:51], v[34:35], v[34:35], v[50:51]
    v_pk_add_f32 v[48:49], v[48:49], v[36:37]
    v_pk_fma_f32 v[50:51], v[36:37], v[36:37], v[50:51]
    v_pk_add_f32 v[48:49], v[48:49], v[38:39]
    v_pk_fma_f32 v[50:51], v[38:39], v[38:39], v[50:51]
    v_pk_add_f32 v[48:49], v[48:49], v[40:41]
    v_pk_fma_f32 v[50:51], v[40:41], v[40:41], v[50:51]
    v_pk_add_f32 v[48:49], v[48:49], v[42:43]
    v_pk_fma_f32 v[50:51], v[42:43], v[42:43], v[50:51]
    v_pk_add_f32 v[48:49], v[48:49], v[44:45]
    v_pk_fma_f32 v[50:51], v[44:45], v[44:45], v[50:51]
    v_pk_add_f32 v[48:49], v[48:49], v[46:47]
    v_pk_fma_f32 v[50:51], v[46:47], v[46:47], v[50:51]
    v_add_f32 v48, v48, v49
    v_add_f32 v49, v50, v51
    v_mov_b32 v50, v48
    v_mov_b32 v51, v49
    s_nop 0
    v_permlane16_swap_b32 v48, v50
    v_permlane16_swap_b32 v49, v51
    v_add_f32 v48, v48, v50
    v_add_f32 v49, v49, v51
    v_mov_b32 v50, v48
    v_mov_b32 v51, v49
    s_nop 0
    v_permlane32_swap_b32 v48, v50
    v_permlane32_swap_b32 v49, v51
    v_add_f32 v48, v48, v50
    v_add_f32 v49, v49, v51
    s_mov_b64 exec, 0xffff
    buffer_store_dwordx2 v[48:49], v31, s[8:11], s34 offen
    s_barrier
    s_waitcnt vmcnt(0)
    s_mov_b64 exec, 1
    buffer_store_dwordx2 v[104:105], off, s[8:11], s35
    s_mov_b64 exec, -1
L_sd91:
    s_lshl_b32 s26, s69, 13
    v_add_u32 v15, s26, v15
    ds_read_b128 v[128:131], v15 offset:0
    ds_read_b128 v[132:135], v15 offset:1024
    ds_read_b128 v[136:139], v15 offset:2048
    ds_read_b128 v[140:143], v15 offset:3072
    ds_read_b128 v[144:147], v15 offset:4096
    ds_read_b128 v[148:151], v15 offset:5120
    ds_read_b128 v[152:155], v15 offset:6144
    ds_read_b128 v[156:159], v15 offset:7168
    v_lshlrev_b32 v48, 16, v16
    v_and_b32 v49, 0xffff0000, v16
    v_lshlrev_b32 v50, 16, v17
    v_and_b32 v51, 0xffff0000, v17
    v_lshlrev_b32 v52, 16, v18
    v_and_b32 v53, 0xffff0000, v18
    v_lshlrev_b32 v54, 16, v19
    v_and_b32 v55, 0xffff0000, v19
    v_lshlrev_b32 v56, 16, v20
    v_and_b32 v57, 0xffff0000, v20
    v_lshlrev_b32 v58, 16, v21
    v_and_b32 v59, 0xffff0000, v21
    v_lshlrev_b32 v60, 16, v22
    v_and_b32 v61, 0xffff0000, v22
    v_lshlrev_b32 v62, 16, v23
    v_and_b32 v63, 0xffff0000, v23
    v_pk_add_f32 v[48:49], v[48:49], v[32:33]
    v_pk_add_f32 v[50:51], v[50:51], v[34:35]
    v_pk_add_f32 v[52:53], v[52:53], v[36:37]
    v_pk_add_f32 v[54:55], v[54:55], v[38:39]
    v_pk_add_f32 v[56:57], v[56:57], v[40:41]
    v_pk_add_f32 v[58:59], v[58:59], v[42:43]
    v_pk_add_f32 v[60:61], v[60:61], v[44:45]
    v_pk_add_f32 v[62:63], v[62:63], v[46:47]
    s_add_u32 s26, s26, 98304
    s_cmp_eq_u32 s69, 3
    s_cselect_b32 s26, 122880, s26
    v_xor_b32 v10, v6, v7
    v_lshlrev_b32 v10, 4, v10
    v_lshl_add_u32 v10, v6, 8, v10
    v_add_u32 v10, s26, v10
    v_xor_b32 v26, 0, v10
    ds_write_b128 v26, v[48:51]
    v_xor_b32 v27, 64, v10
    ds_write_b128 v27, v[52:55]
    v_xor_b32 v28, 128, v10
    ds_write_b128 v28, v[56:59]
    v_xor_b32 v29, 192, v10
    ds_write_b128 v29, v[60:63]
    s_waitcnt lgkmcnt(0)
    v_lshrrev_b32 v15, 4, v4
    v_lshlrev_b32 v14, 14, v15
    v_lshl_add_u32 v14, v5, 8, v14
    v_lshl_add_u32 v14, v6, 4, v14
    v_add_u32 v14, 32768, v14
    v_mul_u32_u24 v15, 0xe000, v15
    v_lshl_add_u32 v15, v5, 8, v15
    v_lshl_add_u32 v15, v6, 4, v15
    v_lshlrev_b32 v16, 4, v4
    s_lshl_b32 s26, s4, 7
    s_add_u32 s26, s26, 28928
    v_lshl_add_u32 v17, v5, 4, s26
    ds_read_b128 v[56:59], v17 offset:0
    ds_read_b128 v[60:63], v17 offset:32
    ds_read_b128 v[64:67], v17 offset:64
    ds_read_b128 v[68:71], v17 offset:96
    s_lshl_b32 s26, s4, 12
    v_add_u32 v18, s26, v3
    v_add_u32 v19, 0, v18
    s_lshl_b32 s28, s25, 10
    s_add_u32 s28, s28, s3
    s_add_u32 s28, s28, 540672
    s_mov_b32 s33, s67
    s_lshl_b32 s34, s23, 9
    s_add_u32 s34, s34, s3
    s_add_u32 s34, s34, 562176
    s_lshl_b32 s35, s24, 6
    s_add_u32 s35, s35, s34
    s_lshl_b32 s29, s4, 3
    s_add_u32 s35, s35, s29
    s_add_u32 s29, s35, 2048
    s_lshl_b32 s32, s20, 6
    s_add_u32 s32, s32, s34
    s_mul_i32 s31, s20, 14336
    s_add_u32 s31, s31, s33
    s_lshl_b32 s27, s69, 2
    v_add_u32 v10, s27, v7
    v_xor_b32 v12, v10, v6
    v_lshlrev_b32 v12, 4, v12
    v_lshl_add_u32 v12, v10, 8, v12
    s_cmp_gt_u32 s20, 3
    s_cselect_b32 s26, 8192, 0
    s_mov_b32 s27, 114688
    s_cselect_b32 s27, 122880, s27
    s_add_u32 s26, s26, 98304
    v_add_u32 v20, s26, v12
    v_add_u32 v21, s27, v12
    s_lshl_b32 s27, s20, 13
    v_lshlrev_b32 v13, 4, v5
    v_xor_b32 v13, v13, v3
    v_add_u32 v13, s27, v13
    s_lshl_b32 s27, s20, 2
    v_add_u32 v10, s27, v7
    v_xor_b32 v10, v10, v6
    v_lshlrev_b32 v10, 4, v10
    v_and_b32 v11, 1, v2
    v_lshl_add_u32 v10, v11, 9, v10
    v_lshrrev_b32 v11, 1, v6
    v_lshl_add_u32 v22, v11, 10, v10
    v_add_u32 v23, 0x10000, v22
    v_lshlrev_b32 v12, 10, v7
    v_lshl_add_u32 v12, v6, 3, v12
    s_mov_b32 s16, s52
    s_mov_b32 s17, s53
    s_mov_b32 s18, 0x200000
    s_mov_b32 s19, 0x20000
    s_lshl_b32 s72, s21, 4
    s_add_u32 s72, s72, s25
    s_lshl_b32 s72, s72, 14
    s_lshl_b32 s27, s20, 12
    s_add_u32 s72, s72, s27
    s_lshl_b32 s27, s24, 7
    s_add_u32 s72, s72, s27
    s_add_u32 s73, s72, 32768
    s_mul_i32 s26, s24, 14336
    s_add_u32 s26, s26, s33
    s_lshl_b32 s27, s4, 11
    s_add_u32 s26, s26, s27
    s_add_u32 s27, s26, 114688
L_hjoin62:
    v_mov_b32 v10, s58
    v_mov_b32 v11, s59
    s_waitcnt vmcnt(0)
    s_barrier
    s_cmp_eq_u32 s20, 3
    s_cbranch_scc1 L_help92
    ds_read_b128 v[72:75], v14 offset:0
    ds_read_b128 v[76:79], v14 offset:32768
    ds_read_b128 v[80:83], v14 offset:512
    s_setprio 2
    s_cmp_lt_u32 s20, 4
    s_cbranch_scc1 L_on94
    s_setprio 1
    s_add_u32 m0, s75, 40960
    s_add_u32 s30, s6, 8192
    buffer_load_dwordx4 v3, s[8:11], s30 offen offset:0 sc1 lds
    buffer_load_dwordx4 v3, s[8:11], s30 offen offset:1024 sc1 lds
    buffer_load_dwordx4 v3, s[8:11], s30 offen offset:2048 sc1 lds
    buffer_load_dwordx4 v3, s[8:11], s30 offen offset:3072 sc1 lds
    s_add_u32 m0, s75, 45056
    s_add_u32 s30, s6, 12288
    buffer_load_dwordx4 v3, s[8:11], s30 offen offset:0 sc1 lds
    buffer_load_dwordx4 v3, s[8:11], s30 offen offset:1024 sc1 lds
    buffer_load_dwordx4 v3, s[8:11], s30 offen offset:2048 sc1 lds
    buffer_load_dwordx4 v3, s[8:11], s30 offen offset:3072 sc1 lds
L_on94:
    ds_read_b128 v[84:87], v14 offset:33280
    s_waitcnt lgkmcnt(3)
    v_mfma_f32_32x32x16_bf16 v[24:39], v[128:131], v[72:75], 0
    ds_read_b128 v[72:75], v14 offset:1024
    s_waitcnt lgkmcnt(3)
    v_mfma_f32_32x32x16_bf16 v[40:55], v[128:131], v[76:79], 0
    ds_read_b128 v[76:79], v14 offset:33792
    s_waitcnt lgkmcnt(3)
    v_mfma_f32_32x32x16_bf16 v[24:39], v[132:135], v[80:83], v[24:39]
    ds_read_b128 v[80:83], v14 offset:1536
    s_waitcnt lgkmcnt(3)
    v_mfma_f32_32x32x16_bf16 v[40:55], v[132:135], v[84:87], v[40:55]
    ds_read_b128 v[84:87], v14 offset:34304
    s_waitcnt lgkmcnt(3)
    v_mfma_f32_32x32x16_bf16 v[24:39], v[136:139], v[72:75], v[24:39]
    ds_read_b128 v[72:75], v14 offset:2048
    s_waitcnt lgkmcnt(3)
    v_mfma_f32_32x32x16_bf16 v[40:55], v[136:139], v[76:79], v[40:55]
    ds_read_b128 v[76:79], v14 offset:34816
    s_waitcnt lgkmcnt(3)
    v_mfma_f32_32x32x16_bf16 v[24:39], v[140:143], v[80:83], v[24:39]
    ds_read_b128 v[80:83], v14 offset:2560
    s_waitcnt lgkmcnt(3)
    v_mfma_f32_32x32x16_bf16 v[40:55], v[140:143], v[84:87], v[40:55]
    ds_read_b128 v[84:87], v14 offset:35328
    s_waitcnt lgkmcnt(3)
    v_mfma_f32_32x32x16_bf16 v[24:39], v[144:147], v[72:75], v[24:39]
    ds_read_b128 v[72:75], v14 offset:3072
    s_waitcnt lgkmcnt(3)
    v_mfma_f32_32x32x16_bf16 v[40:55], v[144:147], v[76:79], v[40:55]
    s_add_u32 s30, s7, 20480
    buffer_load_dwordx4 v[96:99], v3, s[8:11], s30 offen offset:0 sc1
    ds_read_b128 v[76:79], v14 offset:35840
    s_waitcnt lgkmcnt(3)
    v_mfma_f32_32x32x16_bf16 v[24:39], v[148:151], v[80:83], v[24:39]
    ds_read_b128 v[80:83], v14 offset:3584
    s_waitcnt lgkmcnt(3)
    v_mfma_f32_32x32x16_bf16 v[40:55], v[148:151], v[84:87], v[40:55]
    s_add_u32 s30, s7, 20480
    buffer_load_dwordx4 v[100:103], v3, s[8:11], s30 offen offset:1024 sc1
    ds_read_b128 v[84:87], v14 offset:36352
    s_waitcnt lgkmcnt(3)
    v_mfma_f32_32x32x16_bf16 v[24:39], v[152:155], v[72:75], v[24:39]
    ds_read_b128 v[72:75], v14 offset:4096
    s_waitcnt lgkmcnt(3)
    v_mfma_f32_32x32x16_bf16 v[40:55], v[152:155], v[76:79], v[40:55]
    s_add_u32 s30, s7, 20480
    buffer_load_dwordx4 v[104:107], v3, s[8:11], s30 offen offset:2048 sc1
    ds_read_b128 v[76:79], v14 offset:36864
    s_waitcnt lgkmcnt(3)
    v_mfma_f32_32x32x16_bf16 v[24:39], v[156:159], v[80:83], v[24:39]
    ds_read_b128 v[80:83], v14 offset:4608
    s_waitcnt lgkmcnt(3)
    v_mfma_f32_32x32x16_bf16 v[40:55], v[156:159], v[84:87], v[40:55]
    s_add_u32 s30, s7, 20480
    buffer_load_dwordx4 v[108:111], v3, s[8:11], s30 offen offset:3072 sc1
    ds_read_b128 v[84:87], v14 offset:37376
    s_waitcnt lgkmcnt(3)
    v_mfma_f32_32x32x16_bf16 v[24:39], v[160:163], v[72:75], v[24:39]
    ds_read_b128 v[72:75], v14 offset:5120
    s_waitcnt lgkmcnt(3)
    v_mfma_f32_32x32x16_bf16 v[40:55], v[160:163], v[76:79], v[40:55]
    s_add_u32 s30, s7, 24576
    buffer_load_dwordx4 v[112:115], v3, s[8:11], s30 offen offset:0 sc1
    ds_read_b128 v[76:79], v14 offset:37888
    s_waitcnt lgkmcnt(3)
    v_mfma_f32_32x32x16_bf16 v[24:39], v[164:167], v[80:83], v[24:39]
    ds_read_b128 v[80:83], v14 offset:5632
    s_waitcnt lgkmcnt(3)
    v_mfma_f32_32x32x16_bf16 v[40:55], v[164:167], v[84:87], v[40:55]
    s_add_u32 s30, s7, 24576
    buffer_load_dwordx4 v[116:119], v3, s[8:11], s30 offen offset:1024 sc1
    ds_read_b128 v[84:87], v14 offset:38400
    s_waitcnt lgkmcnt(3)
    v_mfma_f32_32x32x16_bf16 v[24:39], v[168:171], v[72:75], v[24:39]
    ds_read_b128 v[72:75], v14 offset:6144
    s_waitcnt lgkmcnt(3)
    v_mfma_f32_32x32x16_bf16 v[40:55], v[168:171], v[76:79], v[40:55]
    s_add_u32 s30, s7, 24576
    buffer_load_dwordx4 v[128:131], v3, s[8:11], s30 offen offset:2048 sc1
    ds_read_b128 v[76:79], v14 offset:38912
    s_waitcnt lgkmcnt(3)
    v_mfma_f32_32x32x16_bf16 v[24:39], v[172:175], v[80:83], v[24:39]
    ds_read_b128 v[80:83], v14 offset:6656
    s_waitcnt lgkmcnt(3)
    v_mfma_f32_32x32x16_bf16 v[40:55], v[172:175], v[84:87], v[40:55]
    s_add_u32 s30, s7, 24576
    buffer_load_dwordx4 v[132:135], v3, s[8:11], s30 offen offset:3072 sc1
    ds_read_b128 v[84:87], v14 offset:39424
    s_waitcnt lgkmcnt(3)
    v_mfma_f32_32x32x16_bf16 v[24:39], v[176:179], v[72:75], v[24:39]
    ds_read_b128 v[72:75], v14 offset:7168
    s_waitcnt lgkmcnt(3)
    v_mfma_f32_32x32x16_bf16 v[40:55], v[176:179], v[76:79], v[40:55]
    s_add_u32 s30, s7, 28672
    buffer_load_dwordx4 v[136:139], v3, s[8:11], s30 offen offset:0 sc1
    ds_read_b128 v[76:79], v14 offset:39936
    s_waitcnt lgkmcnt(3)
    v_mfma_f32_32x32x16_bf16 v[24:39], v[180:183], v[80:83], v[24:39]
    ds_read_b128 v[80:83], v14 offset:7680
    s_waitcnt lgkmcnt(3)
    v_mfma_f32_32x32x16_bf16 v[40:55], v[180:183], v[84:87], v[40:55]
    s_add_u32 s30, s7, 28672
    buffer_load_dwordx4 v[140:143], v3, s[8:11], s30 offen offset:1024 sc1
    s_waitcnt vmcnt(9)
    s_barrier
    ds_read_b128 v[84:87], v14 offset:40448
    s_waitcnt lgkmcnt(3)
    v_mfma_f32_32x32x16_bf16 v[24:39], v[184:187], v[72:75], v[24:39]
    ds_read_b128 v[72:75], v14 offset:8192
    s_waitcnt lgkmcnt(3)
    v_mfma_f32_32x32x16_bf16 v[40:55], v[184:187], v[76:79], v[40:55]
    s_add_u32 s30, s5, 0
    buffer_load_dwordx4 v[144:147], v3, s[8:11], s30 offen offset:0 sc1
    ds_read_b128 v[76:79], v14 offset:40960
    s_waitcnt lgkmcnt(3)
    v_mfma_f32_32x32x16_bf16 v[24:39], v[188:191], v[80:83], v[24:39]
    ds_read_b128 v[80:83], v14 offset:8704
    s_waitcnt lgkmcnt(3)
    v_mfma_f32_32x32x16_bf16 v[40:55], v[188:191], v[84:87], v[40:55]
    s_add_u32 s30, s5, 0
    buffer_load_dwordx4 v[148:151], v3, s[8:11], s30 offen offset:1024 sc1
    ds_read_b128 v[84:87], v14 offset:41472
    s_waitcnt lgkmcnt(3)
    v_mfma_f32_32x32x16_bf16 v[24:39], v[192:195], v[72:75], v[24:39]
    ds_read_b128 v[72:75], v14 offset:9216
    s_waitcnt lgkmcnt(3)
    v_mfma_f32_32x32x16_bf16 v[40:55], v[192:195], v[76:79], v[40:55]
    s_add_u32 s30, s5, 0
    buffer_load_dwordx4 v[152:155], v3, s[8:11], s30 offen offset:2048 sc1
    ds_read_b128 v[76:79], v14 offset:41984
    s_waitcnt lgkmcnt(3)
    v_mfma_f32_32x32x16_bf16 v[24:39], v[196:199], v[80:83], v[24:39]
    ds_read_b128 v[80:83], v14 offset:9728
    s_waitcnt lgkmcnt(3)
    v_mfma_f32_32x32x16_bf16 v[40:55], v[196:199], v[84:87], v[40:55]
    s_add_u32 s30, s5, 0
    buffer_load_dwordx4 v[156:159], v3, s[8:11], s30 offen offset:3072 sc1
    ds_read_b128 v[84:87], v14 offset:42496
    s_waitcnt lgkmcnt(3)
    v_mfma_f32_32x32x16_bf16 v[24:39], v[200:203], v[72:75], v[24:39]
    ds_read_b128 v[72:75], v14 offset:10240
    s_waitcnt lgkmcnt(3)
    v_mfma_f32_32x32x16_bf16 v[40:55], v[200:203], v[76:79], v[40:55]
    s_add_u32 s30, s5, 4096
    buffer_load_dwordx4 v[160:163], v3, s[8:11], s30 offen offset:0 sc1
    ds_read_b128 v[76:79], v14 offset:43008
    s_waitcnt lgkmcnt(3)
    v_mfma_f32_32x32x16_bf16 v[24:39], v[204:207], v[80:83], v[24:39]
    ds_read_b128 v[80:83], v14 offset:10752
    s_waitcnt lgkmcnt(3)
    v_mfma_f32_32x32x16_bf16 v[40:55], v[204:207], v[84:87], v[40:55]
    s_add_u32 s30, s5, 4096
    buffer_load_dwordx4 v[164:167], v3, s[8:11], s30 offen offset:1024 sc1
    ds_read_b128 v[84:87], v14 offset:43520
    s_waitcnt lgkmcnt(3)
    v_mfma_f32_32x32x16_bf16 v[24:39], v[96:99], v[72:75], v[24:39]
    ds_read_b128 v[72:75], v14 offset:11264
    s_waitcnt lgkmcnt(3)
    v_mfma_f32_32x32x16_bf16 v[40:55], v[96:99], v[76:79], v[40:55]
    s_add_u32 s30, s7, 28672
    buffer_load_dwordx4 v[96:99], v3, s[8:11], s30 offen offset:2048 sc1
    ds_read_b128 v[76:79], v14 offset:44032
    s_waitcnt vmcnt(15) lgkmcnt(3)
    v_mfma_f32_32x32x16_bf16 v[24:39], v[100:103], v[80:83], v[24:39]
    ds_read_b128 v[80:83], v14 offset:11776
    s_waitcnt lgkmcnt(3)
    v_mfma_f32_32x32x16_bf16 v[40:55], v[100:103], v[84:87], v[40:55]
    s_add_u32 s30, s7, 28672
    buffer_load_dwordx4 v[100:103], v3, s[8:11], s30 offen offset:3072 sc1
    ds_read_b128 v[84:87], v14 offset:44544
    s_waitcnt vmcnt(15) lgkmcnt(3)
    v_mfma_f32_32x32x16_bf16 v[24:39], v[104:107], v[72:75], v[24:39]
    ds_read_b128 v[72:75], v14 offset:12288
    s_waitcnt lgkmcnt(3)
    v_mfma_f32_32x32x16_bf16 v[40:55], v[104:107], v[76:79], v[40:55]
    ds_read_b128 v[76:79], v14 offset:45056
    s_waitcnt vmcnt(14) lgkmcnt(3)
    v_mfma_f32_32x32x16_bf16 v[24:39], v[108:111], v[80:83], v[24:39]
    ds_read_b128 v[80:83], v14 offset:12800
    s_waitcnt lgkmcnt(3)
    v_mfma_f32_32x32x16_bf16 v[40:55], v[108:111], v[84:87], v[40:55]
    ds_read_b128 v[84:87], v14 offset:45568
    s_waitcnt vmcnt(13) lgkmcnt(3)
    v_mfma_f32_32x32x16_bf16 v[24:39], v[112:115], v[72:75], v[24:39]
    ds_read_b128 v[72:75], v14 offset:13312
    s_waitcnt lgkmcnt(3)
    v_mfma_f32_32x32x16_bf16 v[40:55], v[112:115], v[76:79], v[40:55]
    ds_read_b128 v[76:79], v14 offset:46080
    s_waitcnt vmcnt(12) lgkmcnt(3)
    v_mfma_f32_32x32x16_bf16 v[24:39], v[116:119], v[80:83], v[24:39]
    ds_read_b128 v[80:83], v14 offset:13824
    s_waitcnt lgkmcnt(3)
    v_mfma_f32_32x32x16_bf16 v[40:55], v[116:119], v[84:87], v[40:55]
    ds_read_b128 v[84:87], v14 offset:46592
    s_waitcnt vmcnt(11) lgkmcnt(3)
    v_mfma_f32_32x32x16_bf16 v[24:39], v[128:131], v[72:75], v[24:39]
    ds_read_b128 v[72:75], v14 offset:14336
    s_waitcnt lgkmcnt(3)
    v_mfma_f32_32x32x16_bf16 v[40:55], v[128:131], v[76:79], v[40:55]
    ds_read_b128 v[76:79], v14 offset:47104
    s_waitcnt vmcnt(10) lgkmcnt(3)
    v_mfma_f32_32x32x16_bf16 v[24:39], v[132:135], v[80:83], v[24:39]
    ds_read_b128 v[80:83], v14 offset:14848
    s_waitcnt lgkmcnt(3)
    v_mfma_f32_32x32x16_bf16 v[40:55], v[132:135], v[84:87], v[40:55]
    ds_read_b128 v[84:87], v14 offset:47616
    s_waitcnt vmcnt(9) lgkmcnt(3)
    v_mfma_f32_32x32x16_bf16 v[24:39], v[136:139], v[72:75], v[24:39]
    ds_read_b128 v[72:75], v14 offset:15360
    s_waitcnt lgkmcnt(3)
    v_mfma_f32_32x32x16_bf16 v[40:55], v[136:139], v[76:79], v[40:55]
    ds_read_b128 v[76:79], v14 offset:48128
    s_waitcnt vmcnt(8) lgkmcnt(3)
    v_mfma_f32_32x32x16_bf16 v[24:39], v[140:143], v[80:83], v[24:39]
    ds_read_b128 v[80:83], v14 offset:15872
    s_waitcnt lgkmcnt(3)
    v_mfma_f32_32x32x16_bf16 v[40:55], v[140:143], v[84:87], v[40:55]
    ds_read_b128 v[88:91], v16 offset:30720
    ds_read_b128 v[92:95], v16 offset:31232
    ds_read_b128 v[84:87], v14 offset:48640
    s_waitcnt vmcnt(1) lgkmcnt(5)
    v_mfma_f32_32x32x16_bf16 v[24:39], v[96:99], v[72:75], v[24:39]
    s_waitcnt lgkmcnt(4)
    v_mfma_f32_32x32x16_bf16 v[40:55], v[96:99], v[76:79], v[40:55]
    s_waitcnt vmcnt(0) lgkmcnt(3)
    v_mfma_f32_32x32x16_bf16 v[24:39], v[100:103], v[80:83], v[24:39]
    s_waitcnt lgkmcnt(0)
    v_mfma_f32_32x32x16_bf16 v[40:55], v[100:103], v[84:87], v[40:55]
    s_setprio 3
    s_nop 9
    s_cmp_lt_u32 s20, 4
    s_cbranch_scc0 L_on95
    v_fmac_f32 v24, v88, v56
    v_fmac_f32 v25, v88, v57
    v_fmac_f32 v26, v88, v58
    v_fmac_f32 v27, v88, v59
    v_mul_f32 v96, v24, v24
    v_mul_f32 v97, v25, v25
    v_mul_f32 v98, v26, v26
    v_mul_f32 v99, v27, v27
    v_fma_f32 v96, v96, v90, v89
    v_fma_f32 v97, v97, v90, v89
    v_fma_f32 v98, v98, v90, v89
    v_fma_f32 v99, v99, v90, v89
    s_add_u32 s30, s5, 4096
    buffer_load_dwordx4 v[168:171], v3, s[8:11], s30 offen offset:2048 sc1
    v_mul_f32 v96, v96, v24
    v_mul_f32 v97, v97, v25
    v_mul_f32 v98, v98, v26
    v_mul_f32 v99, v99, v27
    v_exp_f32 v96, v96
    v_exp_f32 v97, v97
    v_exp_f32 v98, v98
    v_exp_f32 v99, v99
    v_fma_f32 v96, v96, v91, v91
    v_fma_f32 v97, v97, v91, v91
    v_fma_f32 v98, v98, v91, v91
    v_fma_f32 v99, v99, v91, v91
    s_add_u32 s30, s5, 4096
    buffer_load_dwordx4 v[172:175], v3, s[8:11], s30 offen offset:3072 sc1
    v_rcp_f32 v96, v96
    v_rcp_f32 v97, v97
    v_rcp_f32 v98, v98
    v_rcp_f32 v99, v99
    v_mul_f32 v24, v24, v96
    v_mul_f32 v25, v25, v97
    v_mul_f32 v26, v26, v98
    v_mul_f32 v27, v27, v99
    v_cvt_pk_bf16_f32 v120, v24, v25
    v_cvt_pk_bf16_f32 v121, v26, v27
    v_fmac_f32 v28, v88, v60
    v_fmac_f32 v29, v88, v61
    s_add_u32 s30, s5, 8192
    buffer_load_dwordx4 v[176:179], v3, s[8:11], s30 offen offset:0 sc1
    v_fmac_f32 v30, v88, v62
    v_fmac_f32 v31, v88, v63
    v_mul_f32 v100, v28, v28
    v_mul_f32 v101, v29, v29
    v_mul_f32 v102, v30, v30
    v_mul_f32 v103, v31, v31
    v_fma_f32 v100, v100, v90, v89
    v_fma_f32 v101, v101, v90, v89
    v_fma_f32 v102, v102, v90, v89
    v_fma_f32 v103, v103, v90, v89
    v_mul_f32 v100, v100, v28
    v_mul_f32 v101, v101, v29
    s_add_u32 s30, s5, 8192
    buffer_load_dwordx4 v[180:183], v3, s[8:11], s30 offen offset:1024 sc1
    v_mul_f32 v102, v102, v30
    v_mul_f32 v103, v103, v31
    v_exp_f32 v100, v100
    v_exp_f32 v101, v101
    v_exp_f32 v102, v102
    v_exp_f32 v103, v103
    v_fma_f32 v100, v100, v91, v91
    v_fma_f32 v101, v101, v91, v91
    v_fma_f32 v102, v102, v91, v91
    v_fma_f32 v103, v103, v91, v91
    v_rcp_f32 v100, v100
    v_rcp_f32 v101, v101
    s_add_u32 s30, s5, 8192
    buffer_load_dwordx4 v[184:187], v3, s[8:11], s30 offen offset:2048 sc1
    v_rcp_f32 v102, v102
    v_rcp_f32 v103, v103
    v_mul_f32 v28, v28, v100
    v_mul_f32 v29, v29, v101
    v_mul_f32 v30, v30, v102
    v_mul_f32 v31, v31, v103
    v_cvt_pk_bf16_f32 v122, v28, v29
    v_cvt_pk_bf16_f32 v123, v30, v31
    v_fmac_f32 v32, v88, v64
    v_fmac_f32 v33, v88, v65
    v_fmac_f32 v34, v88, v66
    v_fmac_f32 v35, v88, v67
    s_add_u32 s30, s5, 8192
    buffer_load_dwordx4 v[188:191], v3, s[8:11], s30 offen offset:3072 sc1
    v_mul_f32 v96, v32, v32
    v_mul_f32 v97, v33, v33
    v_mul_f32 v98, v34, v34
    v_mul_f32 v99, v35, v35
    v_fma_f32 v96, v96, v90, v89
    v_fma_f32 v97, v97, v90, v89
    v_fma_f32 v98, v98, v90, v89
    v_fma_f32 v99, v99, v90, v89
    v_mul_f32 v96, v96, v32
    v_mul_f32 v97, v97, v33
    v_mul_f32 v98, v98, v34
    v_mul_f32 v99, v99, v35
    s_add_u32 s30, s5, 12288
    buffer_load_dwordx4 v[192:195], v3, s[8:11], s30 offen offset:0 sc1
    v_exp_f32 v96, v96
    v_exp_f32 v97, v97
    v_exp_f32 v98, v98
    v_exp_f32 v99, v99
    v_fma_f32 v96, v96, v91, v91
    v_fma_f32 v97, v97, v91, v91
    v_fma_f32 v98, v98, v91, v91
    v_fma_f32 v99, v99, v91, v91
    v_rcp_f32 v96, v96
    v_rcp_f32 v97, v97
    v_rcp_f32 v98, v98
    v_rcp_f32 v99, v99
    s_add_u32 s30, s5, 12288
    buffer_load_dwordx4 v[196:199], v3, s[8:11], s30 offen offset:1024 sc1
    v_mul_f32 v32, v32, v96
    v_mul_f32 v33, v33, v97
    v_mul_f32 v34, v34, v98
    v_mul_f32 v35, v35, v99
    v_cvt_pk_bf16_f32 v124, v32, v33
    v_cvt_pk_bf16_f32 v125, v34, v35
    v_fmac_f32 v36, v88, v68
    v_fmac_f32 v37, v88, v69
    v_fmac_f32 v38, v88, v70
    v_fmac_f32 v39, v88, v71
    v_mul_f32 v100, v36, v36
    v_mul_f32 v101, v37, v37
    s_add_u32 s30, s5, 12288
    buffer_load_dwordx4 v[200:203], v3, s[8:11], s30 offen offset:2048 sc1
    v_mul_f32 v102, v38, v38
    v_mul_f32 v103, v39, v39
    v_fma_f32 v100, v100, v90, v89
    v_fma_f32 v101, v101, v90, v89
    v_fma_f32 v102, v102, v90, v89
    v_fma_f32 v103, v103, v90, v89
    v_mul_f32 v100, v100, v36
    v_mul_f32 v101, v101, v37
    v_mul_f32 v102, v102, v38
    v_mul_f32 v103, v103, v39
    v_exp_f32 v100, v100
    v_exp_f32 v101, v101
    s_add_u32 s30, s5, 12288
    buffer_load_dwordx4 v[204:207], v3, s[8:11], s30 offen offset:3072 sc1
    v_exp_f32 v102, v102
    v_exp_f32 v103, v103
    v_fma_f32 v100, v100, v91, v91
    v_fma_f32 v101, v101, v91, v91
    v_fma_f32 v102, v102, v91, v91
    v_fma_f32 v103, v103, v91, v91
    v_rcp_f32 v100, v100
    v_rcp_f32 v101, v101
    v_rcp_f32 v102, v102
    v_rcp_f32 v103, v103
    v_mul_f32 v36, v36, v100
    v_mul_f32 v37, v37, v101
    v_mul_f32 v38, v38, v102
    v_mul_f32 v39, v39, v103
    v_cvt_pk_bf16_f32 v126, v36, v37
    v_cvt_pk_bf16_f32 v127, v38, v39
L_on95:
    s_cmp_lt_u32 s20, 4
    s_cbranch_scc1 L_on96
    v_mov_b32 v96, v89
    v_mov_b32 v98, v91
    v_pk_fma_f32 v[24:25], v[56:57], v[88:89], v[24:25] op_sel_hi:[1,0,1]
    v_pk_fma_f32 v[26:27], v[58:59], v[88:89], v[26:27] op_sel_hi:[1,0,1]
    v_pk_fma_f32 v[28:29], v[60:61], v[88:89], v[28:29] op_sel_hi:[1,0,1]
    v_pk_fma_f32 v[30:31], v[62:63], v[88:89], v[30:31] op_sel_hi:[1,0,1]
    v_pk_fma_f32 v[32:33], v[64:65], v[88:89], v[32:33] op_sel_hi:[1,0,1]
    v_pk_fma_f32 v[34:35], v[66:67], v[88:89], v[34:35] op_sel_hi:[1,0,1]
    s_add_u32 s30, s5, 4096
    buffer_load_dwordx4 v[168:171], v3, s[8:11], s30 offen offset:2048 sc1
    v_pk_fma_f32 v[36:37], v[68:69], v[88:89], v[36:37] op_sel_hi:[1,0,1]
    v_pk_fma_f32 v[38:39], v[70:71], v[88:89], v[38:39] op_sel_hi:[1,0,1]
    v_pk_mul_f32 v[128:129], v[24:25], v[24:25]
    v_pk_mul_f32 v[130:131], v[26:27], v[26:27]
    v_pk_mul_f32 v[132:133], v[28:29], v[28:29]
    v_pk_mul_f32 v[134:135], v[30:31], v[30:31]
    v_pk_mul_f32 v[136:137], v[32:33], v[32:33]
    v_pk_mul_f32 v[138:139], v[34:35], v[34:35]
    s_add_u32 s30, s5, 4096
    buffer_load_dwordx4 v[172:175], v3, s[8:11], s30 offen offset:3072 sc1
    v_pk_mul_f32 v[140:141], v[36:37], v[36:37]
    v_pk_mul_f32 v[142:143], v[38:39], v[38:39]
    v_pk_fma_f32 v[128:129], v[128:129], v[90:91], v[96:97] op_sel_hi:[1,0,0]
    v_pk_fma_f32 v[130:131], v[130:131], v[90:91], v[96:97] op_sel_hi:[1,0,0]
    v_pk_fma_f32 v[132:133], v[132:133], v[90:91], v[96:97] op_sel_hi:[1,0,0]
    v_pk_fma_f32 v[134:135], v[134:135], v[90:91], v[96:97] op_sel_hi:[1,0,0]
    v_pk_fma_f32 v[136:137], v[136:137], v[90:91], v[96:97] op_sel_hi:[1,0,0]
    v_pk_fma_f32 v[138:139], v[138:139], v[90:91], v[96:97] op_sel_hi:[1,0,0]
    s_add_u32 s30, s5, 8192
    buffer_load_dwordx4 v[176:179], v3, s[8:11], s30 offen offset:0 sc1
    v_pk_fma_f32 v[140:141], v[140:141], v[90:91], v[96:97] op_sel_hi:[1,0,0]
    v_pk_fma_f32 v[142:143], v[142:143], v[90:91], v[96:97] op_sel_hi:[1,0,0]
    v_pk_mul_f32 v[128:129], v[128:129], v[24:25]
    v_pk_mul_f32 v[130:131], v[130:131], v[26:27]
    v_pk_mul_f32 v[132:133], v[132:133], v[28:29]
    v_pk_mul_f32 v[134:135], v[134:135], v[30:31]
    v_pk_mul_f32 v[136:137], v[136:137], v[32:33]
    v_pk_mul_f32 v[138:139], v[138:139], v[34:35]
    s_add_u32 s30, s5, 8192
    buffer_load_dwordx4 v[180:183], v3, s[8:11], s30 offen offset:1024 sc1
    v_pk_mul_f32 v[140:141], v[140:141], v[36:37]
    v_pk_mul_f32 v[142:143], v[142:143], v[38:39]
    v_exp_f32 v128, v128
    v_exp_f32 v129, v129
    v_exp_f32 v130, v130
    v_exp_f32 v131, v131
    v_exp_f32 v132, v132
    v_exp_f32 v133, v133
    s_add_u32 s30, s5, 8192
    buffer_load_dwordx4 v[184:187], v3, s[8:11], s30 offen offset:2048 sc1
    v_exp_f32 v134, v134
    v_exp_f32 v135, v135
    v_exp_f32 v136, v136
    v_exp_f32 v137, v137
    v_exp_f32 v138, v138
    v_exp_f32 v139, v139
    v_exp_f32 v140, v140
    v_exp_f32 v141, v141
    s_add_u32 s30, s5, 8192
    buffer_load_dwordx4 v[188:191], v3, s[8:11], s30 offen offset:3072 sc1
    v_exp_f32 v142, v142
    v_exp_f32 v143, v143
    v_pk_fma_f32 v[128:129], v[128:129], v[98:99], v[98:99] op_sel_hi:[1,0,0]
    v_pk_fma_f32 v[130:131], v[130:131], v[98:99], v[98:99] op_sel_hi:[1,0,0]
    v_pk_fma_f32 v[132:133], v[132:133], v[98:99], v[98:99] op_sel_hi:[1,0,0]
    v_pk_fma_f32 v[134:135], v[134:135], v[98:99], v[98:99] op_sel_hi:[1,0,0]
    v_pk_fma_f32 v[136:137], v[136:137], v[98:99], v[98:99] op_sel_hi:[1,0,0]
    v_pk_fma_f32 v[138:139], v[138:139], v[98:99], v[98:99] op_sel_hi:[1,0,0]
    s_add_u32 s30, s5, 12288
    buffer_load_dwordx4 v[192:195], v3, s[8:11], s30 offen offset:0 sc1
    v_pk_fma_f32 v[140:141], v[140:141], v[98:99], v[98:99] op_sel_hi:[1,0,0]
    v_pk_fma_f32 v[142:143], v[142:143], v[98:99], v[98:99] op_sel_hi:[1,0,0]
    v_rcp_f32 v128, v128
    v_rcp_f32 v129, v129
    v_rcp_f32 v130, v130
    v_rcp_f32 v131, v131
    v_rcp_f32 v132, v132
    v_rcp_f32 v133, v133
    s_add_u32 s30, s5, 12288
    buffer_load_dwordx4 v[196:199], v3, s[8:11], s30 offen offset:1024 sc1
    v_rcp_f32 v134, v134
    v_rcp_f32 v135, v135
    v_rcp_f32 v136, v136
    v_rcp_f32 v137, v137
    v_rcp_f32 v138, v138
    v_rcp_f32 v139, v139
    v_rcp_f32 v140, v140
    v_rcp_f32 v141, v141
    s_add_u32 s30, s5, 12288
    buffer_load_dwordx4 v[200:203], v3, s[8:11], s30 offen offset:2048 sc1
    v_rcp_f32 v142, v142
    v_rcp_f32 v143, v143
    v_pk_mul_f32 v[24:25], v[24:25], v[128:129]
    v_pk_mul_f32 v[26:27], v[26:27], v[130:131]
    v_pk_mul_f32 v[28:29], v[28:29], v[132:133]
    v_pk_mul_f32 v[30:31], v[30:31], v[134:135]
    v_pk_mul_f32 v[32:33], v[32:33], v[136:137]
    v_pk_mul_f32 v[34:35], v[34:35], v[138:139]
    s_add_u32 s30, s5, 12288
    buffer_load_dwordx4 v[204:207], v3, s[8:11], s30 offen offset:3072 sc1
    v_pk_mul_f32 v[36:37], v[36:37], v[140:141]
    v_pk_mul_f32 v[38:39], v[38:39], v[142:143]
    v_cvt_pk_bf16_f32 v120, v24, v25
    v_cvt_pk_bf16_f32 v121, v26, v27
    v_cvt_pk_bf16_f32 v122, v28, v29
    v_cvt_pk_bf16_f32 v123, v30, v31
    v_cvt_pk_bf16_f32 v124, v32, v33
    v_cvt_pk_bf16_f32 v125, v34, v35
    v_cvt_pk_bf16_f32 v126, v36, v37
    v_cvt_pk_bf16_f32 v127, v38, v39
L_on96:
    s_cmp_eq_u32 s61, 0
    s_cbranch_scc1 L_sf97
    buffer_store_dwordx4 v[120:123], v3, s[8:11], s26 offen
    buffer_store_dwordx4 v[124:127], v3, s[8:11], s26 offen offset:1024
L_sd98:
    s_setprio 2
    v_mov_b32 v96, v93
    v_mov_b32 v98, v95
    v_pk_fma_f32 v[40:41], v[56:57], v[92:93], v[40:41] op_sel_hi:[1,0,1]
    v_pk_fma_f32 v[42:43], v[58:59], v[92:93], v[42:43] op_sel_hi:[1,0,1]
    v_pk_fma_f32 v[44:45], v[60:61], v[92:93], v[44:45] op_sel_hi:[1,0,1]
    v_pk_fma_f32 v[46:47], v[62:63], v[92:93], v[46:47] op_sel_hi:[1,0,1]
    v_pk_fma_f32 v[48:49], v[64:65], v[92:93], v[48:49] op_sel_hi:[1,0,1]
    v_pk_fma_f32 v[50:51], v[66:67], v[92:93], v[50:51] op_sel_hi:[1,0,1]
    v_pk_fma_f32 v[52:53], v[68:69], v[92:93], v[52:53] op_sel_hi:[1,0,1]
    v_pk_fma_f32 v[54:55], v[70:71], v[92:93], v[54:55] op_sel_hi:[1,0,1]
    v_pk_mul_f32 v[128:129], v[40:41], v[40:41]
    v_pk_mul_f32 v[130:131], v[42:43], v[42:43]
    v_pk_mul_f32 v[132:133], v[44:45], v[44:45]
    v_pk_mul_f32 v[134:135], v[46:47], v[46:47]
    v_pk_mul_f32 v[136:137], v[48:49], v[48:49]
    v_pk_mul_f32 v[138:139], v[50:51], v[50:51]
    v_pk_mul_f32 v[140:141], v[52:53], v[52:53]
    v_pk_mul_f32 v[142:143], v[54:55], v[54:55]
    v_pk_fma_f32 v[128:129], v[128:129], v[94:95], v[96:97] op_sel_hi:[1,0,0]
    v_pk_fma_f32 v[130:131], v[130:131], v[94:95], v[96:97] op_sel_hi:[1,0,0]
    v_pk_fma_f32 v[132:133], v[132:133], v[94:95], v[96:97] op_sel_hi:[1,0,0]
    v_pk_fma_f32 v[134:135], v[134:135], v[94:95], v[96:97] op_sel_hi:[1,0,0]
    v_pk_fma_f32 v[136:137], v[136:137], v[94:95], v[96:97] op_sel_hi:[1,0,0]
    v_pk_fma_f32 v[138:139], v[138:139], v[94:95], v[96:97] op_sel_hi:[1,0,0]
    v_pk_fma_f32 v[140:141], v[140:141], v[94:95], v[96:97] op_sel_hi:[1,0,0]
    v_pk_fma_f32 v[142:143], v[142:143], v[94:95], v[96:97] op_sel_hi:[1,0,0]
    v_pk_mul_f32 v[128:129], v[128:129], v[40:41]
    v_pk_mul_f32 v[130:131], v[130:131], v[42:43]
    v_pk_mul_f32 v[132:133], v[132:133], v[44:45]
    v_pk_mul_f32 v[134:135], v[134:135], v[46:47]
    v_pk_mul_f32 v[136:137], v[136:137], v[48:49]
    v_pk_mul_f32 v[138:139], v[138:139], v[50:51]
    v_pk_mul_f32 v[140:141], v[140:141], v[52:53]
    v_pk_mul_f32 v[142:143], v[142:143], v[54:55]
    v_exp_f32 v128, v128
    v_exp_f32 v129, v129
    v_exp_f32 v130, v130
    v_exp_f32 v131, v131
    v_exp_f32 v132, v132
    v_exp_f32 v133, v133
    v_exp_f32 v134, v134
    v_exp_f32 v135, v135
    v_exp_f32 v136, v136
    v_exp_f32 v137, v137
    v_exp_f32 v138, v138
    v_exp_f32 v139, v139
    v_exp_f32 v140, v140
    v_exp_f32 v141, v141
    v_exp_f32 v142, v142
    v_exp_f32 v143, v143
    v_pk_fma_f32 v[128:129], v[128:129], v[98:99], v[98:99] op_sel_hi:[1,0,0]
    v_pk_fma_f32 v[130:131], v[130:131], v[98:99], v[98:99] op_sel_hi:[1,0,0]
    v_pk_fma_f32 v[132:133], v[132:133], v[98:99], v[98:99] op_sel_hi:[1,0,0]
    v_pk_fma_f32 v[134:135], v[134:135], v[98:99], v[98:99] op_sel_hi:[1,0,0]
    v_pk_fma_f32 v[136:137], v[136:137], v[98:99], v[98:99] op_sel_hi:[1,0,0]
    v_pk_fma_f32 v[138:139], v[138:139], v[98:99], v[98:99] op_sel_hi:[1,0,0]
    v_pk_fma_f32 v[140:141], v[140:141], v[98:99], v[98:99] op_sel_hi:[1,0,0]
    v_pk_fma_f32 v[142:143], v[142:143], v[98:99], v[98:99] op_sel_hi:[1,0,0]
    s_cmp_eq_u32 s61, 0
    s_cbranch_scc1 L_sf99
    s_waitcnt vmcnt(0)
    s_mov_b64 exec, 1
    buffer_store_dwordx2 v[10:11], off, s[8:11], s35
    s_mov_b64 exec, -1
L_sd100:
    v_rcp_f32 v128, v128
    v_rcp_f32 v129, v129
    v_rcp_f32 v130, v130
    v_rcp_f32 v131, v131
    v_rcp_f32 v132, v132
    v_rcp_f32 v133, v133
    v_rcp_f32 v134, v134
    v_rcp_f32 v135, v135
    v_rcp_f32 v136, v136
    v_rcp_f32 v137, v137
    v_rcp_f32 v138, v138
    v_rcp_f32 v139, v139
    v_rcp_f32 v140, v140
    v_rcp_f32 v141, v141
    v_rcp_f32 v142, v142
    v_rcp_f32 v143, v143
    v_pk_mul_f32 v[40:41], v[40:41], v[128:129]
    v_pk_mul_f32 v[42:43], v[42:43], v[130:131]
    v_pk_mul_f32 v[44:45], v[44:45], v[132:133]
    v_pk_mul_f32 v[46:47], v[46:47], v[134:135]
    v_pk_mul_f32 v[48:49], v[48:49], v[136:137]
    v_pk_mul_f32 v[50:51], v[50:51], v[138:139]
    v_pk_mul_f32 v[52:53], v[52:53], v[140:141]
    v_pk_mul_f32 v[54:55], v[54:55], v[142:143]
    v_cvt_pk_bf16_f32 v104, v40, v41
    v_cvt_pk_bf16_f32 v105, v42, v43
    v_cvt_pk_bf16_f32 v106, v44, v45
    v_cvt_pk_bf16_f32 v107, v46, v47
    v_cvt_pk_bf16_f32 v108, v48, v49
    v_cvt_pk_bf16_f32 v109, v50, v51
    v_cvt_pk_bf16_f32 v110, v52, v53
    v_cvt_pk_bf16_f32 v111, v54, v55
    s_cmp_eq_u32 s61, 0
    s_cbranch_scc1 L_sf101
    buffer_store_dwordx4 v[104:107], v3, s[8:11], s27 offen
    buffer_store_dwordx4 v[108:111], v3, s[8:11], s27 offen offset:1024
L_sd102:
    s_mov_b64 exec, 0x7f
    buffer_load_dwordx2 v[16:17], v1, s[8:11], s32 offen sc1
    s_mov_b64 exec, -1
    s_cmp_eq_u32 s61, 0
    s_cbranch_scc1 L_sf103
    s_waitcnt vmcnt(0)
    s_mov_b64 exec, 1
    buffer_store_dwordx2 v[10:11], off, s[8:11], s29
    s_mov_b64 exec, -1
L_sd104:
    s_setprio 0
    s_branch L_join93
L_help92:
    buffer_load_dwordx4 v[24:27], v3, s[8:11], s28 offen offset:0 sc1
    buffer_load_dwordx4 v[28:31], v3, s[8:11], s28 offen offset:1024 sc1
    buffer_load_dwordx4 v[32:35], v3, s[8:11], s28 offen offset:2048 sc1
    buffer_load_dwordx4 v[36:39], v3, s[8:11], s28 offen offset:3072 sc1
    v_lshrrev_b32 v40, 2, v2
    v_lshl_add_u32 v40, v9, 4, v40
    v_lshlrev_b32 v40, 4, v40
    v_cmp_eq_u32 s[74:75], 1, v9
    v_cmp_eq_u32 s[6:7], 2, v9
    v_cmp_eq_u32 vcc, 3, v9
    s_waitcnt vmcnt(0) lgkmcnt(0)
    v_pk_add_f32 v[24:25], v[24:25], v[26:27]
    v_pk_add_f32 v[28:29], v[28:29], v[30:31]
    v_pk_add_f32 v[32:33], v[32:33], v[34:35]
    v_pk_add_f32 v[36:37], v[36:37], v[38:39]
    v_add_f32_dpp v24, v24, v24 quad_perm:[1,0,3,2] row_mask:0xf bank_mask:0xf
    v_add_f32_dpp v25, v25, v25 quad_perm:[1,0,3,2] row_mask:0xf bank_mask:0xf
    v_add_f32_dpp v28, v28, v28 quad_perm:[1,0,3,2] row_mask:0xf bank_mask:0xf
    v_add_f32_dpp v29, v29, v29 quad_perm:[1,0,3,2] row_mask:0xf bank_mask:0xf
    v_add_f32_dpp v32, v32, v32 quad_perm:[1,0,3,2] row_mask:0xf bank_mask:0xf
    v_add_f32_dpp v33, v33, v33 quad_perm:[1,0,3,2] row_mask:0xf bank_mask:0xf
    v_add_f32_dpp v36, v36, v36 quad_perm:[1,0,3,2] row_mask:0xf bank_mask:0xf
    v_add_f32_dpp v37, v37, v37 quad_perm:[1,0,3,2] row_mask:0xf bank_mask:0xf
    v_add_f32_dpp v24, v24, v24 quad_perm:[2,3,0,1] row_mask:0xf bank_mask:0xf
    v_add_f32_dpp v25, v25, v25 quad_perm:[2,3,0,1] row_mask:0xf bank_mask:0xf
    v_add_f32_dpp v28, v28, v28 quad_perm:[2,3,0,1] row_mask:0xf bank_mask:0xf
    v_add_f32_dpp v29, v29, v29 quad_perm:[2,3,0,1] row_mask:0xf bank_mask:0xf
    v_add_f32_dpp v32, v32, v32 quad_perm:[2,3,0,1] row_mask:0xf bank_mask:0xf
    v_add_f32_dpp v33, v33, v33 quad_perm:[2,3,0,1] row_mask:0xf bank_mask:0xf
    v_add_f32_dpp v36, v36, v36 quad_perm:[2,3,0,1] row_mask:0xf bank_mask:0xf
    v_add_f32_dpp v37, v37, v37 quad_perm:[2,3,0,1] row_mask:0xf bank_mask:0xf
    v_cndmask_b32 v24, v24, v28, s[74:75]
    v_cndmask_b32 v25, v25, v29, s[74:75]
    v_cndmask_b32 v24, v24, v32, s[6:7]
    v_cndmask_b32 v25, v25, v33, s[6:7]
    v_cndmask_b32 v24, v24, v36, vcc
    v_cndmask_b32 v25, v25, v37, vcc
    v_mul_f32 v24, 0xbb000000, v24
    v_mul_f32 v25, 0x3b000000, v25
    v_fma_f32 v25, -v24, v24, v25
    v_max_f32 v25, 0, v25
    v_add_f32 v28, 0x3727c5ac, v25
    v_rsq_f32 v29, v28
    v_sqrt_f32 v27, v28
    v_mul_f32 v25, 0xc0135761, v29
    v_mul_f32 v26, v29, v29
    v_mul_f32 v26, v26, v29
    v_mul_f32 v26, 0xbdd2d3e8, v26
    ds_write_b128 v40, v[24:27] offset:30720
    s_waitcnt lgkmcnt(0)
    s_barrier
    s_add_u32 s30, s5, 0
    buffer_load_dwordx4 v[144:147], v3, s[8:11], s30 offen offset:0 sc1
    s_add_u32 s30, s5, 0
    buffer_load_dwordx4 v[148:151], v3, s[8:11], s30 offen offset:1024 sc1
    s_add_u32 s30, s5, 0
    buffer_load_dwordx4 v[152:155], v3, s[8:11], s30 offen offset:2048 sc1
    s_add_u32 s30, s5, 0
    buffer_load_dwordx4 v[156:159], v3, s[8:11], s30 offen offset:3072 sc1
    s_mov_b64 exec, 0x7f
    s_mov_b32 s60, 0
L_poll105:
    s_sleep 8
    buffer_load_dwordx2 v[10:11], v1, s[8:11], s32 offen sc1
    s_add_u32 s60, s60, 1
    s_cmp_gt_u32 s60, 0x20000
    s_waitcnt vmcnt(0)
    s_cbranch_scc1 L_polld106
    v_cmp_ne_u64 vcc, s[58:59], v[10:11]
    s_cbranch_vccnz L_poll105
L_polld106:
    s_mov_b64 exec, -1
    v_mov_b32 v16, s58
    v_mov_b32 v17, s59
L_join93:
    s_mov_b64 exec, 0x7f
    v_cmp_ne_u64 vcc, s[58:59], v[16:17]
    s_mov_b64 exec, -1
    s_cbranch_vccz L_bk107
    s_mov_b64 exec, 0x7f
    s_mov_b32 s60, 0
L_poll108:
    buffer_load_dwordx2 v[10:11], v1, s[8:11], s32 offen sc1
    s_add_u32 s60, s60, 1
    s_cmp_gt_u32 s60, 0x20000
    s_waitcnt vmcnt(0)
    s_cbranch_scc1 L_polld109
    v_cmp_ne_u64 vcc, s[58:59], v[10:11]
    s_cbranch_vccnz L_poll108
L_polld109:
    s_mov_b64 exec, -1
L_bk107:
    s_add_u32 s32, s32, 2048
    s_add_u32 s30, s31, 0
    buffer_load_dwordx4 v[56:59], v3, s[8:11], s30 offen offset:0 sc1
    s_add_u32 s30, s31, 0
    buffer_load_dwordx4 v[60:63], v3, s[8:11], s30 offen offset:1024 sc1
    s_add_u32 s30, s31, 0
    buffer_load_dwordx4 v[64:67], v3, s[8:11], s30 offen offset:2048 sc1
    s_add_u32 s30, s31, 0
    buffer_load_dwordx4 v[68:71], v3, s[8:11], s30 offen offset:3072 sc1
    s_add_u32 s30, s31, 4096
    buffer_load_dwordx4 v[128:131], v3, s[8:11], s30 offen offset:0 sc1
    s_add_u32 s30, s31, 4096
    buffer_load_dwordx4 v[132:135], v3, s[8:11], s30 offen offset:1024 sc1
    ds_read_b128 v[120:123], v20
    ds_read_b128 v[124:127], v21
    s_waitcnt vmcnt(5) lgkmcnt(0)
    v_mfma_f32_32x32x16_bf16 v[24:39], v[144:147], v[56:59], 0
    v_mfma_f32_32x32x16_bf16 v[40:55], v[148:151], v[56:59], 0
    s_waitcnt vmcnt(4)
    v_mfma_f32_32x32x16_bf16 v[24:39], v[152:155], v[60:63], v[24:39]
    v_mfma_f32_32x32x16_bf16 v[40:55], v[156:159], v[60:63], v[40:55]
    s_add_u32 s30, s31, 4096
    buffer_load_dwordx4 v[136:139], v3, s[8:11], s30 offen offset:2048 sc1
    s_waitcnt vmcnt(4)
    v_mfma_f32_32x32x16_bf16 v[24:39], v[160:163], v[64:67], v[24:39]
    v_mfma_f32_32x32x16_bf16 v[40:55], v[164:167], v[64:67], v[40:55]
    s_add_u32 s30, s31, 4096
    buffer_load_dwordx4 v[140:143], v3, s[8:11], s30 offen offset:3072 sc1
    s_waitcnt vmcnt(4)
    v_mfma_f32_32x32x16_bf16 v[24:39], v[168:171], v[68:71], v[24:39]
    v_mfma_f32_32x32x16_bf16 v[40:55], v[172:175], v[68:71], v[40:55]
    s_mov_b64 exec, 0x7f
    buffer_load_dwordx2 v[16:17], v1, s[8:11], s32 offen sc1
    s_mov_b64 exec, -1
    s_add_u32 s30, s31, 8192
    buffer_load_dwordx4 v[72:75], v3, s[8:11], s30 offen offset:0 sc1
    s_waitcnt vmcnt(5)
    v_mfma_f32_32x32x16_bf16 v[24:39], v[176:179], v[128:131], v[24:39]
    v_mfma_f32_32x32x16_bf16 v[40:55], v[180:183], v[128:131], v[40:55]
    s_add_u32 s30, s31, 8192
    buffer_load_dwordx4 v[76:79], v3, s[8:11], s30 offen offset:1024 sc1
    s_waitcnt vmcnt(5)
    v_mfma_f32_32x32x16_bf16 v[24:39], v[184:187], v[132:135], v[24:39]
    v_mfma_f32_32x32x16_bf16 v[40:55], v[188:191], v[132:135], v[40:55]
    s_add_u32 s30, s31, 8192
    buffer_load_dwordx4 v[80:83], v3, s[8:11], s30 offen offset:2048 sc1
    s_waitcnt vmcnt(5)
    v_mfma_f32_32x32x16_bf16 v[24:39], v[192:195], v[136:139], v[24:39]
    v_mfma_f32_32x32x16_bf16 v[40:55], v[196:199], v[136:139], v[40:55]
    s_waitcnt vmcnt(3)
    s_mov_b64 exec, 0x7f
    v_cmp_ne_u64 vcc, s[58:59], v[16:17]
    s_mov_b64 exec, -1
    s_cbranch_vccz L_bk110
    s_mov_b64 exec, 0x7f
    s_mov_b32 s60, 0
L_poll111:
    buffer_load_dwordx2 v[10:11], v1, s[8:11], s32 offen sc1
    s_add_u32 s60, s60, 1
    s_cmp_gt_u32 s60, 0x20000
    s_waitcnt vmcnt(0)
    s_cbranch_scc1 L_polld112
    v_cmp_ne_u64 vcc, s[58:59], v[10:11]
    s_cbranch_vccnz L_poll111
L_polld112:
    s_mov_b64 exec, -1
L_bk110:
    s_add_u32 s30, s31, 8192
    buffer_load_dwordx4 v[84:87], v3, s[8:11], s30 offen offset:3072 sc1
    v_mfma_f32_32x32x16_bf16 v[24:39], v[200:203], v[140:143], v[24:39]
    v_mfma_f32_32x32x16_bf16 v[40:55], v[204:207], v[140:143], v[40:55]
    s_add_u32 s30, s31, 12288
    buffer_load_dwordx4 v[56:59], v3, s[8:11], s30 offen offset:0 sc1
    s_waitcnt vmcnt(4)
    v_mfma_f32_32x32x16_bf16 v[24:39], v[208:211], v[72:75], v[24:39]
    v_mfma_f32_32x32x16_bf16 v[40:55], v[212:215], v[72:75], v[40:55]
    s_add_u32 s30, s31, 12288
    buffer_load_dwordx4 v[60:63], v3, s[8:11], s30 offen offset:1024 sc1
    s_waitcnt vmcnt(4)
    v_mfma_f32_32x32x16_bf16 v[24:39], v[216:219], v[76:79], v[24:39]
    v_mfma_f32_32x32x16_bf16 v[40:55], v[220:223], v[76:79], v[40:55]
    s_add_u32 s30, s31, 114688
    buffer_load_dwordx4 v[64:67], v3, s[8:11], s30 offen offset:0 sc1
    s_waitcnt vmcnt(4)
    v_mfma_f32_32x32x16_bf16 v[24:39], v[224:227], v[80:83], v[24:39]
    v_mfma_f32_32x32x16_bf16 v[40:55], v[228:231], v[80:83], v[40:55]
    s_add_u32 s30, s31, 114688
    buffer_load_dwordx4 v[68:71], v3, s[8:11], s30 offen offset:1024 sc1
    s_waitcnt vmcnt(4)
    v_mfma_f32_32x32x16_bf16 v[24:39], v[232:235], v[84:87], v[24:39]
    v_mfma_f32_32x32x16_bf16 v[40:55], v[236:239], v[84:87], v[40:55]
    s_add_u32 s30, s31, 114688
    buffer_load_dwordx4 v[128:131], v3, s[8:11], s30 offen offset:2048 sc1
    s_waitcnt vmcnt(4)
    v_mfma_f32_32x32x16_bf16 v[24:39], v[240:243], v[56:59], v[24:39]
    v_mfma_f32_32x32x16_bf16 v[40:55], v[244:247], v[56:59], v[40:55]
    s_add_u32 s30, s31, 114688
    buffer_load_dwordx4 v[132:135], v3, s[8:11], s30 offen offset:3072 sc1
    s_waitcnt vmcnt(4)
    v_mfma_f32_32x32x16_bf16 v[24:39], v[248:251], v[60:63], v[24:39]
    v_mfma_f32_32x32x16_bf16 v[40:55], v[252:255], v[60:63], v[40:55]
    s_add_u32 s30, s31, 118784
    buffer_load_dwordx4 v[136:139], v3, s[8:11], s30 offen offset:0 sc1
    s_waitcnt vmcnt(4)
    s_barrier
    v_mfma_f32_32x32x16_bf16 v[88:103], v[144:147], v[64:67], 0
    v_mfma_f32_32x32x16_bf16 v[104:119], v[148:151], v[64:67], 0
    s_add_u32 s30, s31, 118784
    buffer_load_dwordx4 v[140:143], v3, s[8:11], s30 offen offset:1024 sc1
    s_waitcnt vmcnt(4)
    v_mfma_f32_32x32x16_bf16 v[88:103], v[152:155], v[68:71], v[88:103]
    v_mfma_f32_32x32x16_bf16 v[104:119], v[156:159], v[68:71], v[104:119]
    s_add_u32 s30, s31, 118784
    buffer_load_dwordx4 v[72:75], v3, s[8:11], s30 offen offset:2048 sc1
    v_xor_b32 v18, 0, v13
    ds_write_b128 v18, v[24:27] offset:0
    s_waitcnt vmcnt(4)
    v_mfma_f32_32x32x16_bf16 v[88:103], v[160:163], v[128:131], v[88:103]
    v_mfma_f32_32x32x16_bf16 v[104:119], v[164:167], v[128:131], v[104:119]
    s_add_u32 s30, s31, 118784
    buffer_load_dwordx4 v[76:79], v3, s[8:11], s30 offen offset:3072 sc1
    v_xor_b32 v19, 32, v13
    ds_write_b128 v19, v[28:31] offset:1024
    s_waitcnt vmcnt(4)
    v_mfma_f32_32x32x16_bf16 v[88:103], v[168:171], v[132:135], v[88:103]
    v_mfma_f32_32x32x16_bf16 v[104:119], v[172:175], v[132:135], v[104:119]
    s_add_u32 s30, s31, 122880
    buffer_load_dwordx4 v[80:83], v3, s[8:11], s30 offen offset:0 sc1
    v_xor_b32 v18, 64, v13
    ds_write_b128 v18, v[32:35] offset:2048
    s_waitcnt vmcnt(4)
    v_mfma_f32_32x32x16_bf16 v[88:103], v[176:179], v[136:139], v[88:103]
    v_mfma_f32_32x32x16_bf16 v[104:119], v[180:183], v[136:139], v[104:119]
    s_add_u32 s30, s31, 122880
    buffer_load_dwordx4 v[84:87], v3, s[8:11], s30 offen offset:1024 sc1
    v_xor_b32 v19, 96, v13
    ds_write_b128 v19, v[36:39] offset:3072
    s_waitcnt vmcnt(4)
    v_mfma_f32_32x32x16_bf16 v[88:103], v[184:187], v[140:143], v[88:103]
    v_mfma_f32_32x32x16_bf16 v[104:119], v[188:191], v[140:143], v[104:119]
    s_add_u32 s30, s31, 122880
    buffer_load_dwordx4 v[56:59], v3, s[8:11], s30 offen offset:2048 sc1
    v_xor_b32 v18, 128, v13
    ds_write_b128 v18, v[40:43] offset:4096
    s_waitcnt vmcnt(4)
    v_mfma_f32_32x32x16_bf16 v[88:103], v[192:195], v[72:75], v[88:103]
    v_mfma_f32_32x32x16_bf16 v[104:119], v[196:199], v[72:75], v[104:119]
    s_add_u32 s30, s31, 122880
    buffer_load_dwordx4 v[60:63], v3, s[8:11], s30 offen offset:3072 sc1
    v_xor_b32 v19, 160, v13
    ds_write_b128 v19, v[44:47] offset:5120
    s_waitcnt vmcnt(4)
    v_mfma_f32_32x32x16_bf16 v[88:103], v[200:203], v[76:79], v[88:103]
    v_mfma_f32_32x32x16_bf16 v[104:119], v[204:207], v[76:79], v[104:119]
    s_add_u32 s30, s31, 126976
    buffer_load_dwordx4 v[64:67], v3, s[8:11], s30 offen offset:0 sc1
    v_xor_b32 v18, 192, v13
    ds_write_b128 v18, v[48:51] offset:6144
    s_waitcnt vmcnt(4)
    v_mfma_f32_32x32x16_bf16 v[88:103], v[208:211], v[80:83], v[88:103]
    v_mfma_f32_32x32x16_bf16 v[104:119], v[212:215], v[80:83], v[104:119]
    s_add_u32 s30, s31, 126976
    buffer_load_dwordx4 v[68:71], v3, s[8:11], s30 offen offset:1024 sc1
    v_xor_b32 v19, 224, v13
    ds_write_b128 v19, v[52:55] offset:7168
    s_waitcnt vmcnt(4)
    v_mfma_f32_32x32x16_bf16 v[88:103], v[216:219], v[84:87], v[88:103]
    v_mfma_f32_32x32x16_bf16 v[104:119], v[220:223], v[84:87], v[104:119]
    s_waitcnt vmcnt(3)
    v_mfma_f32_32x32x16_bf16 v[88:103], v[224:227], v[56:59], v[88:103]
    v_mfma_f32_32x32x16_bf16 v[104:119], v[228:231], v[56:59], v[104:119]
    s_waitcnt vmcnt(2)
    v_mfma_f32_32x32x16_bf16 v[88:103], v[232:235], v[60:63], v[88:103]
    v_mfma_f32_32x32x16_bf16 v[104:119], v[236:239], v[60:63], v[104:119]
    s_waitcnt vmcnt(1)
    v_mfma_f32_32x32x16_bf16 v[88:103], v[240:243], v[64:67], v[88:103]
    v_mfma_f32_32x32x16_bf16 v[104:119], v[244:247], v[64:67], v[104:119]
    s_waitcnt vmcnt(0)
    v_mfma_f32_32x32x16_bf16 v[88:103], v[248:251], v[68:71], v[88:103]
    v_mfma_f32_32x32x16_bf16 v[104:119], v[252:255], v[68:71], v[104:119]
    v_xor_b32 v18, 65536, v13
    s_nop 9
    ds_write_b128 v18, v[88:91] offset:0
    v_xor_b32 v19, 65568, v13
    ds_write_b128 v19, v[92:95] offset:1024
    v_xor_b32 v18, 65600, v13
    ds_write_b128 v18, v[96:99] offset:2048
    v_xor_b32 v19, 65632, v13
    ds_write_b128 v19, v[100:103] offset:3072
    v_xor_b32 v18, 65664, v13
    ds_write_b128 v18, v[104:107] offset:4096
    v_xor_b32 v19, 65696, v13
    ds_write_b128 v19, v[108:111] offset:5120
    v_xor_b32 v18, 65728, v13
    ds_write_b128 v18, v[112:115] offset:6144
    v_xor_b32 v19, 65760, v13
    ds_write_b128 v19, v[116:119] offset:7168
    s_waitcnt lgkmcnt(0)
    s_barrier
    ds_read_b128 v[144:147], v22 offset:0
    ds_read_b128 v[148:151], v22 offset:8192
    ds_read_b128 v[152:155], v22 offset:16384
    ds_read_b128 v[156:159], v22 offset:24576
    ds_read_b128 v[160:163], v22 offset:32768
    ds_read_b128 v[164:167], v22 offset:40960
    ds_read_b128 v[168:171], v22 offset:49152
    ds_read_b128 v[172:175], v22 offset:57344
    ds_read_b128 v[176:179], v23 offset:0
    ds_read_b128 v[180:183], v23 offset:8192
    ds_read_b128 v[184:187], v23 offset:16384
    ds_read_b128 v[188:191], v23 offset:24576
    ds_read_b128 v[192:195], v23 offset:32768
    ds_read_b128 v[196:199], v23 offset:40960
    ds_read_b128 v[200:203], v23 offset:49152
    ds_read_b128 v[204:207], v23 offset:57344
    s_waitcnt lgkmcnt(14)
    v_pk_add_f32 v[120:121], v[120:121], v[144:145]
    v_pk_add_f32 v[122:123], v[122:123], v[146:147]
    v_pk_add_f32 v[120:121], v[120:121], v[148:149]
    v_pk_add_f32 v[122:123], v[122:123], v[150:151]
    s_waitcnt lgkmcnt(12)
    v_pk_add_f32 v[120:121], v[120:121], v[152:153]
    v_pk_add_f32 v[122:123], v[122:123], v[154:155]
    v_pk_add_f32 v[120:121], v[120:121], v[156:157]
    v_pk_add_f32 v[122:123], v[122:123], v[158:159]
    s_waitcnt lgkmcnt(10)
    v_pk_add_f32 v[120:121], v[120:121], v[160:161]
    v_pk_add_f32 v[122:123], v[122:123], v[162:163]
    v_pk_add_f32 v[120:121], v[120:121], v[164:165]
    v_pk_add_f32 v[122:123], v[122:123], v[166:167]
    s_waitcnt lgkmcnt(8)
    v_pk_add_f32 v[120:121], v[120:121], v[168:169]
    v_pk_add_f32 v[122:123], v[122:123], v[170:171]
    v_pk_add_f32 v[120:121], v[120:121], v[172:173]
    v_pk_add_f32 v[122:123], v[122:123], v[174:175]
    v_cvt_pk_bf16_f32 v24, v120, v121
    v_cvt_pk_bf16_f32 v25, v122, v123
    buffer_store_dwordx2 v[24:25], v12, s[16:19], s72 offen
    s_waitcnt lgkmcnt(6)
    v_pk_add_f32 v[124:125], v[124:125], v[176:177]
    v_pk_add_f32 v[126:127], v[126:127], v[178:179]
    v_pk_add_f32 v[124:125], v[124:125], v[180:181]
    v_pk_add_f32 v[126:127], v[126:127], v[182:183]
    s_waitcnt lgkmcnt(4)
    v_pk_add_f32 v[124:125], v[124:125], v[184:185]
    v_pk_add_f32 v[126:127], v[126:127], v[186:187]
    v_pk_add_f32 v[124:125], v[124:125], v[188:189]
    v_pk_add_f32 v[126:127], v[126:127], v[190:191]
    s_waitcnt lgkmcnt(2)
    v_pk_add_f32 v[124:125], v[124:125], v[192:193]
    v_pk_add_f32 v[126:127], v[126:127], v[194:195]
    v_pk_add_f32 v[124:125], v[124:125], v[196:197]
    v_pk_add_f32 v[126:127], v[126:127], v[198:199]
    s_waitcnt lgkmcnt(0)
    v_pk_add_f32 v[124:125], v[124:125], v[200:201]
    v_pk_add_f32 v[126:127], v[126:127], v[202:203]
    v_pk_add_f32 v[124:125], v[124:125], v[204:205]
    v_pk_add_f32 v[126:127], v[126:127], v[206:207]
    v_cvt_pk_bf16_f32 v26, v124, v125
    v_cvt_pk_bf16_f32 v27, v126, v127
    buffer_store_dwordx2 v[26:27], v12, s[16:19], s73 offen
    s_endpgm
L_sf45:
    s_nop 7
    s_mov_b64 exec, 1
    buffer_store_dwordx2 v[10:11], off, s[8:11], s27 sc1
    s_mov_b64 exec, -1
    s_nop 7
    s_branch L_sd46
L_sf64:
    s_nop 7
    v_pk_mul_f32 v[128:129], v[128:129], v[196:197] op_sel_hi:[1,0]
    v_pk_mul_f32 v[130:131], v[130:131], v[196:197] op_sel_hi:[1,0]
    v_pk_mul_f32 v[132:133], v[132:133], v[196:197] op_sel_hi:[1,0]
    v_pk_mul_f32 v[134:135], v[134:135], v[196:197] op_sel_hi:[1,0]
    v_pk_mul_f32 v[136:137], v[136:137], v[196:197] op_sel_hi:[1,0]
    v_pk_mul_f32 v[138:139], v[138:139], v[196:197] op_sel_hi:[1,0]
    v_pk_mul_f32 v[140:141], v[140:141], v[196:197] op_sel_hi:[1,0]
    v_pk_mul_f32 v[142:143], v[142:143], v[196:197] op_sel_hi:[1,0]
    v_pk_fma_f32 v[16:17], v[16:17], v[226:227], v[128:129] op_sel_hi:[1,0,1]
    v_pk_fma_f32 v[18:19], v[18:19], v[226:227], v[130:131] op_sel_hi:[1,0,1]
    v_pk_fma_f32 v[20:21], v[20:21], v[226:227], v[132:133] op_sel_hi:[1,0,1]
    v_pk_fma_f32 v[22:23], v[22:23], v[226:227], v[134:135] op_sel_hi:[1,0,1]
    v_cvt_pk_bf16_f32 v200, v16, v17
    v_cvt_pk_bf16_f32 v201, v18, v19
    v_cvt_pk_bf16_f32 v202, v20, v21
    v_cvt_pk_bf16_f32 v203, v22, v23
    s_add_u32 s26, s6, 0
    buffer_store_dwordx4 v[200:203], v3, s[8:11], s26 offen sc1
    v_pk_fma_f32 v[24:25], v[24:25], v[226:227], v[136:137] op_sel_hi:[1,0,1]
    v_pk_fma_f32 v[26:27], v[26:27], v[226:227], v[138:139] op_sel_hi:[1,0,1]
    v_pk_fma_f32 v[28:29], v[28:29], v[226:227], v[140:141] op_sel_hi:[1,0,1]
    v_pk_fma_f32 v[30:31], v[30:31], v[226:227], v[142:143] op_sel_hi:[1,0,1]
    v_cvt_pk_bf16_f32 v204, v24, v25
    v_cvt_pk_bf16_f32 v205, v26, v27
    v_cvt_pk_bf16_f32 v206, v28, v29
    v_cvt_pk_bf16_f32 v207, v30, v31
    s_add_u32 s26, s6, 229376
    buffer_store_dwordx4 v[204:207], v3, s[8:11], s26 offen sc1
    v_pk_mul_f32 v[144:145], v[144:145], v[192:193] op_sel_hi:[1,0]
    v_pk_mul_f32 v[146:147], v[146:147], v[192:193] op_sel_hi:[1,0]
    v_pk_mul_f32 v[148:149], v[148:149], v[192:193] op_sel_hi:[1,0]
    v_pk_mul_f32 v[150:151], v[150:151], v[192:193] op_sel_hi:[1,0]
    v_pk_mul_f32 v[152:153], v[152:153], v[192:193] op_sel_hi:[1,0]
    v_pk_mul_f32 v[154:155], v[154:155], v[192:193] op_sel_hi:[1,0]
    v_pk_mul_f32 v[156:157], v[156:157], v[192:193] op_sel_hi:[1,0]
    v_pk_mul_f32 v[158:159], v[158:159], v[192:193] op_sel_hi:[1,0]
    v_pk_fma_f32 v[32:33], v[32:33], v[224:225], v[144:145] op_sel_hi:[1,0,1]
    v_pk_fma_f32 v[34:35], v[34:35], v[224:225], v[146:147] op_sel_hi:[1,0,1]
    v_pk_fma_f32 v[36:37], v[36:37], v[224:225], v[148:149] op_sel_hi:[1,0,1]
    v_pk_fma_f32 v[38:39], v[38:39], v[224:225], v[150:151] op_sel_hi:[1,0,1]
    v_cvt_pk_bf16_f32 v208, v32, v33
    v_cvt_pk_bf16_f32 v209, v34, v35
    v_cvt_pk_bf16_f32 v210, v36, v37
    v_cvt_pk_bf16_f32 v211, v38, v39
    s_add_u32 s26, s6, 65536
    buffer_store_dwordx4 v[208:211], v3, s[8:11], s26 offen sc1
    v_pk_fma_f32 v[40:41], v[40:41], v[224:225], v[152:153] op_sel_hi:[1,0,1]
    v_pk_fma_f32 v[42:43], v[42:43], v[224:225], v[154:155] op_sel_hi:[1,0,1]
    v_pk_fma_f32 v[44:45], v[44:45], v[224:225], v[156:157] op_sel_hi:[1,0,1]
    v_pk_fma_f32 v[46:47], v[46:47], v[224:225], v[158:159] op_sel_hi:[1,0,1]
    v_cvt_pk_bf16_f32 v212, v40, v41
    v_cvt_pk_bf16_f32 v213, v42, v43
    v_cvt_pk_bf16_f32 v214, v44, v45
    v_cvt_pk_bf16_f32 v215, v46, v47
    s_add_u32 s26, s6, 294912
    buffer_store_dwordx4 v[212:215], v3, s[8:11], s26 offen sc1
    s_waitcnt lgkmcnt(0)
    s_add_u32 s26, s6, 0x20000
    v_pk_mul_f32 v[160:161], v[160:161], v[194:195] op_sel_hi:[1,0]
    v_pk_mul_f32 v[162:163], v[162:163], v[194:195] op_sel_hi:[1,0]
    v_pk_mul_f32 v[164:165], v[164:165], v[194:195] op_sel_hi:[1,0]
    v_pk_mul_f32 v[166:167], v[166:167], v[194:195] op_sel_hi:[1,0]
    v_pk_mul_f32 v[168:169], v[168:169], v[194:195] op_sel_hi:[1,0]
    v_pk_mul_f32 v[170:171], v[170:171], v[194:195] op_sel_hi:[1,0]
    v_pk_mul_f32 v[172:173], v[172:173], v[194:195] op_sel_hi:[1,0]
    v_pk_mul_f32 v[174:175], v[174:175], v[194:195] op_sel_hi:[1,0]
    v_pk_fma_f32 v[48:49], v[48:49], v[176:177], v[160:161]
    v_pk_fma_f32 v[50:51], v[50:51], v[178:179], v[162:163]
    v_pk_fma_f32 v[52:53], v[52:53], v[180:181], v[164:165]
    v_pk_fma_f32 v[54:55], v[54:55], v[182:183], v[166:167]
    v_cvt_pk_bf16_f32 v216, v48, v49
    v_cvt_pk_bf16_f32 v217, v50, v51
    v_cvt_pk_bf16_f32 v218, v52, v53
    v_cvt_pk_bf16_f32 v219, v54, v55
    buffer_store_dwordx4 v[216:219], v124, s[8:11], s26 offen offset:0 sc1
    v_pk_fma_f32 v[56:57], v[56:57], v[184:185], v[168:169]
    v_pk_fma_f32 v[58:59], v[58:59], v[186:187], v[170:171]
    v_pk_fma_f32 v[60:61], v[60:61], v[188:189], v[172:173]
    v_pk_fma_f32 v[62:63], v[62:63], v[190:191], v[174:175]
    v_cvt_pk_bf16_f32 v220, v56, v57
    v_cvt_pk_bf16_f32 v221, v58, v59
    v_cvt_pk_bf16_f32 v222, v60, v61
    v_cvt_pk_bf16_f32 v223, v62, v63
    buffer_store_dwordx4 v[220:223], v124, s[8:11], s26 offen offset:512 sc1
    s_nop 7
    s_branch L_sd65
L_sf67:
    s_nop 7
    s_mov_b64 exec, 1
    buffer_store_dwordx2 v[10:11], off, s[8:11], s26 sc1
    s_mov_b64 exec, -1
    s_nop 7
    s_branch L_sd68
L_sf79:
    s_nop 7
    buffer_store_dwordx4 v[16:19], v3, s[8:11], s33 offen sc1
    buffer_store_dwordx4 v[20:23], v3, s[8:11], s33 offen offset:1024 sc1
    v_pk_add_f32 v[48:49], v[32:33], v[34:35]
    v_pk_mul_f32 v[50:51], v[32:33], v[32:33]
    v_pk_fma_f32 v[50:51], v[34:35], v[34:35], v[50:51]
    v_pk_add_f32 v[48:49], v[48:49], v[36:37]
    v_pk_fma_f32 v[50:51], v[36:37], v[36:37], v[50:51]
    v_pk_add_f32 v[48:49], v[48:49], v[38:39]
    v_pk_fma_f32 v[50:51], v[38:39], v[38:39], v[50:51]
    v_pk_add_f32 v[48:49], v[48:49], v[40:41]
    v_pk_fma_f32 v[50:51], v[40:41], v[40:41], v[50:51]
    v_pk_add_f32 v[48:49], v[48:49], v[42:43]
    v_pk_fma_f32 v[50:51], v[42:43], v[42:43], v[50:51]
    v_pk_add_f32 v[48:49], v[48:49], v[44:45]
    v_pk_fma_f32 v[50:51], v[44:45], v[44:45], v[50:51]
    v_pk_add_f32 v[48:49], v[48:49], v[46:47]
    v_pk_fma_f32 v[50:51], v[46:47], v[46:47], v[50:51]
    v_add_f32 v48, v48, v49
    v_add_f32 v49, v50, v51
    v_mov_b32 v50, v48
    v_mov_b32 v51, v49
    s_nop 0
    v_permlane16_swap_b32 v48, v50
    v_permlane16_swap_b32 v49, v51
    v_add_f32 v48, v48, v50
    v_add_f32 v49, v49, v51
    v_mov_b32 v50, v48
    v_mov_b32 v51, v49
    s_nop 0
    v_permlane32_swap_b32 v48, v50
    v_permlane32_swap_b32 v49, v51
    v_add_f32 v48, v48, v50
    v_add_f32 v49, v49, v51
    s_mov_b64 exec, 0xffff
    buffer_store_dwordx2 v[48:49], v31, s[8:11], s34 offen sc1
    s_mov_b64 exec, -1
    s_barrier
    ds_read_b128 v[128:131], v15 offset:0
    ds_read_b128 v[132:135], v15 offset:1024
    ds_read_b128 v[136:139], v15 offset:2048
    ds_read_b128 v[140:143], v15 offset:3072
    ds_read_b128 v[144:147], v15 offset:4096
    ds_read_b128 v[148:151], v15 offset:5120
    ds_read_b128 v[152:155], v15 offset:6144
    ds_read_b128 v[156:159], v15 offset:7168
    ds_read_b128 v[112:115], v102 offset:28672
    ds_read_b128 v[116:119], v102 offset:28736
    ds_read_b128 v[120:123], v102 offset:28800
    ds_read_b128 v[124:127], v102 offset:28864
    s_waitcnt vmcnt(0)
    s_mov_b64 exec, 1
    buffer_store_dwordx2 v[104:105], off, s[8:11], s35 sc1
    s_mov_b64 exec, -1
    s_nop 7
    s_branch L_sd80
L_sf83:
    s_nop 7
    buffer_store_dwordx4 v[64:67], v3, s[8:11], s33 offen sc1
    buffer_store_dwordx4 v[68:71], v3, s[8:11], s33 offen offset:1024 sc1
    s_nop 7
    s_branch L_sd84
L_sf85:
    s_nop 7
    s_mov_b64 exec, 1
    buffer_store_dwordx2 v[104:105], off, s[8:11], s35 sc1
    s_mov_b64 exec, -1
    s_nop 7
    s_branch L_sd86
L_sf90:
    s_nop 7
    buffer_store_dwordx4 v[64:67], v3, s[8:11], s33 offen sc1
    buffer_store_dwordx4 v[68:71], v3, s[8:11], s33 offen offset:1024 sc1
    v_pk_add_f32 v[48:49], v[32:33], v[34:35]
    v_pk_mul_f32 v[50:51], v[32:33], v[32:33]
    v_pk_fma_f32 v[50:51], v[34:35], v[34:35], v[50:51]
    v_pk_add_f32 v[48:49], v[48:49], v[36:37]
    v_pk_fma_f32 v[50:51], v[36:37], v[36:37], v[50:51]
    v_pk_add_f32 v[48:49], v[48:49], v[38:39]
    v_pk_fma_f32 v[50:51], v[38:39], v[38:39], v[50:51]
    v_pk_add_f32 v[48:49], v[48:49], v[40:41]
    v_pk_fma_f32 v[50:51], v[40:41], v[40:41], v[50:51]
    v_pk_add_f32 v[48:49], v[48:49], v[42:43]
    v_pk_fma_f32 v[50:51], v[42:43], v[42:43], v[50:51]
    v_pk_add_f32 v[48:49], v[48:49], v[44:45]
    v_pk_fma_f32 v[50:51], v[44:45], v[44:45], v[50:51]
    v_pk_add_f32 v[48:49], v[48:49], v[46:47]
    v_pk_fma_f32 v[50:51], v[46:47], v[46:47], v[50:51]
    v_add_f32 v48, v48, v49
    v_add_f32 v49, v50, v51
    v_mov_b32 v50, v48
    v_mov_b32 v51, v49
    s_nop 0
    v_permlane16_swap_b32 v48, v50
    v_permlane16_swap_b32 v49, v51
    v_add_f32 v48, v48, v50
    v_add_f32 v49, v49, v51
    v_mov_b32 v50, v48
    v_mov_b32 v51, v49
    s_nop 0
    v_permlane32_swap_b32 v48, v50
    v_permlane32_swap_b32 v49, v51
    v_add_f32 v48, v48, v50
    v_add_f32 v49, v49, v51
    s_mov_b64 exec, 0xffff
    buffer_store_dwordx2 v[48:49], v31, s[8:11], s34 offen sc1
    s_barrier
    s_waitcnt vmcnt(0)
    s_mov_b64 exec, 1
    buffer_store_dwordx2 v[104:105], off, s[8:11], s35 sc1
    s_mov_b64 exec, -1
    s_nop 7
    s_branch L_sd91
L_sf97:
    s_nop 7
    buffer_store_dwordx4 v[120:123], v3, s[8:11], s26 offen sc1
    buffer_store_dwordx4 v[124:127], v3, s[8:11], s26 offen offset:1024 sc1
    s_nop 7
    s_branch L_sd98
L_sf99:
    s_nop 7
    s_waitcnt vmcnt(0)
    s_mov_b64 exec, 1
    buffer_store_dwordx2 v[10:11], off, s[8:11], s35 sc1
    s_mov_b64 exec, -1
    s_nop 7
    s_branch L_sd100
L_sf101:
    s_nop 7
    buffer_store_dwordx4 v[104:107], v3, s[8:11], s27 offen sc1
    buffer_store_dwordx4 v[108:111], v3, s[8:11], s27 offen offset:1024 sc1
    s_nop 7
    s_branch L_sd102
L_sf103:
    s_nop 7
    s_waitcnt vmcnt(0)
    s_mov_b64 exec, 1
    buffer_store_dwordx2 v[10:11], off, s[8:11], s29 sc1
    s_mov_b64 exec, -1
    s_nop 7
    s_branch L_sd104
L_fb77:
    s_nop 15
    s_add_u32 s30, s67, 0x10000
    s_add_u32 s31, s67, 0x20000
    v_mov_b32 v128, 0xff800000
    v_mov_b32 v144, 0xff800000
    s_mov_b32 s32, 0
L_fb1113:
    s_add_u32 s33, s30, s32
    buffer_load_dwordx4 v[96:99], v3, s[8:11], s33 offen sc1
    s_waitcnt vmcnt(0)
    v_mfma_f32_32x32x16_bf16 v[20:35], v[96:99], v[12:15], 0
    v_mfma_f32_32x32x16_bf16 v[36:51], v[96:99], v[16:19], 0
    s_nop 10
    v_max3_f32 v128, v20, v21, v128
    v_max3_f32 v128, v22, v23, v128
    v_max3_f32 v128, v24, v25, v128
    v_max3_f32 v128, v26, v27, v128
    v_max3_f32 v128, v28, v29, v128
    v_max3_f32 v128, v30, v31, v128
    v_max3_f32 v128, v32, v33, v128
    v_max3_f32 v128, v34, v35, v128
    v_max3_f32 v144, v36, v37, v144
    v_max3_f32 v144, v38, v39, v144
    v_max3_f32 v144, v40, v41, v144
    v_max3_f32 v144, v42, v43, v144
    v_max3_f32 v144, v44, v45, v144
    v_max3_f32 v144, v46, v47, v144
    v_max3_f32 v144, v48, v49, v144
    v_max3_f32 v144, v50, v51, v144
    s_add_u32 s32, s32, 1024
    s_cmp_lt_u32 s32, 0x10000
    s_cbranch_scc1 L_fb1113
    v_mov_b32 v129, v128
    s_nop 1
    v_permlane32_swap_b32 v128, v129
    v_max_f32 v128, v128, v129
    v_sub_f32 v128, 0, v128
    v_mov_b32 v129, v128
    v_mov_b32 v130, v128
    v_mov_b32 v131, v128
    v_mov_b32 v132, v128
    v_mov_b32 v133, v128
    v_mov_b32 v134, v128
    v_mov_b32 v135, v128
    v_mov_b32 v136, v128
    v_mov_b32 v137, v128
    v_mov_b32 v138, v128
    v_mov_b32 v139, v128
    v_mov_b32 v140, v128
    v_mov_b32 v141, v128
    v_mov_b32 v142, v128
    v_mov_b32 v143, v128
    v_mov_b32 v145, v144
    s_nop 1
    v_permlane32_swap_b32 v144, v145
    v_max_f32 v144, v144, v145
    v_sub_f32 v144, 0, v144
    v_mov_b32 v145, v144
    v_mov_b32 v146, v144
    v_mov_b32 v147, v144
    v_mov_b32 v148, v144
    v_mov_b32 v149, v144
    v_mov_b32 v150, v144
    v_mov_b32 v151, v144
    v_mov_b32 v152, v144
    v_mov_b32 v153, v144
    v_mov_b32 v154, v144
    v_mov_b32 v155, v144
    v_mov_b32 v156, v144
    v_mov_b32 v157, v144
    v_mov_b32 v158, v144
    v_mov_b32 v159, v144
    v_mov_b32 v52, 0
    v_mov_b32 v53, 0
    v_mov_b32 v54, 0
    v_mov_b32 v55, 0
    v_mov_b32 v56, 0
    v_mov_b32 v57, 0
    v_mov_b32 v58, 0
    v_mov_b32 v59, 0
    v_mov_b32 v60, 0
    v_mov_b32 v61, 0
    v_mov_b32 v62, 0
    v_mov_b32 v63, 0
    v_mov_b32 v64, 0
    v_mov_b32 v65, 0
    v_mov_b32 v66, 0
    v_mov_b32 v67, 0
    v_mov_b32 v68, 0
    v_mov_b32 v69, 0
    v_mov_b32 v70, 0
    v_mov_b32 v71, 0
    v_mov_b32 v72, 0
    v_mov_b32 v73, 0
    v_mov_b32 v74, 0
    v_mov_b32 v75, 0
    v_mov_b32 v76, 0
    v_mov_b32 v77, 0
    v_mov_b32 v78, 0
    v_mov_b32 v79, 0
    v_mov_b32 v80, 0
    v_mov_b32 v81, 0
    v_mov_b32 v82, 0
    v_mov_b32 v83, 0
    v_and_b32 v10, 27, v4
    v_cmp_eq_u32 vcc, 16, v10
    v_mov_b32 v10, 0x3f803f80
    s_nop 0
    v_cndmask_b32 v100, 0, v10, vcc
    v_cndmask_b32 v101, 0, v10, vcc
    v_cndmask_b32 v102, 0, v10, vcc
    v_cndmask_b32 v103, 0, v10, vcc
    v_cndmask_b32 v104, 0, v10, vcc
    v_cndmask_b32 v105, 0, v10, vcc
    v_cndmask_b32 v106, 0, v10, vcc
    v_cndmask_b32 v107, 0, v10, vcc
    v_lshlrev_b32 v10, 8, v5
    v_lshl_add_u32 v10, v6, 4, v10
    s_mov_b32 s32, 0
    s_mov_b32 s34, 0xffff
    s_mov_b32 s35, 0xffff
L_fb2114:
    s_add_u32 s33, s30, s32
    buffer_load_dwordx4 v[96:99], v3, s[8:11], s33 offen sc1
    s_add_u32 s33, s31, s32
    s_mov_b64 exec, s[34:35]
    buffer_load_dwordx4 v[100:103], v10, s[8:11], s33 offen sc1
    buffer_load_dwordx4 v[104:107], v10, s[8:11], s33 offen offset:512 sc1
    s_mov_b64 exec, -1
    s_waitcnt vmcnt(0)
    v_mfma_f32_32x32x16_bf16 v[20:35], v[96:99], v[12:15], v[128:143]
    v_mfma_f32_32x32x16_bf16 v[36:51], v[96:99], v[16:19], v[144:159]
    s_nop 10
    v_exp_f32 v20, v20
    v_exp_f32 v21, v21
    v_exp_f32 v22, v22
    v_exp_f32 v23, v23
    v_exp_f32 v24, v24
    v_exp_f32 v25, v25
    v_exp_f32 v26, v26
    v_exp_f32 v27, v27
    v_exp_f32 v28, v28
    v_exp_f32 v29, v29
    v_exp_f32 v30, v30
    v_exp_f32 v31, v31
    v_exp_f32 v32, v32
    v_exp_f32 v33, v33
    v_exp_f32 v34, v34
    v_exp_f32 v35, v35
    v_cvt_pk_bf16_f32 v84, v20, v21
    v_cvt_pk_bf16_f32 v85, v22, v23
    v_cvt_pk_bf16_f32 v86, v24, v25
    v_cvt_pk_bf16_f32 v87, v26, v27
    v_cvt_pk_bf16_f32 v88, v28, v29
    v_cvt_pk_bf16_f32 v89, v30, v31
    v_cvt_pk_bf16_f32 v90, v32, v33
    v_cvt_pk_bf16_f32 v91, v34, v35
    v_mfma_f32_32x32x16_bf16 v[52:67], v[100:103], v[84:87], v[52:67]
    s_nop 0
    v_mfma_f32_32x32x16_bf16 v[52:67], v[104:107], v[88:91], v[52:67]
    s_nop 15
    v_exp_f32 v36, v36
    v_exp_f32 v37, v37
    v_exp_f32 v38, v38
    v_exp_f32 v39, v39
    v_exp_f32 v40, v40
    v_exp_f32 v41, v41
    v_exp_f32 v42, v42
    v_exp_f32 v43, v43
    v_exp_f32 v44, v44
    v_exp_f32 v45, v45
    v_exp_f32 v46, v46
    v_exp_f32 v47, v47
    v_exp_f32 v48, v48
    v_exp_f32 v49, v49
    v_exp_f32 v50, v50
    v_exp_f32 v51, v51
    v_cvt_pk_bf16_f32 v84, v36, v37
    v_cvt_pk_bf16_f32 v85, v38, v39
    v_cvt_pk_bf16_f32 v86, v40, v41
    v_cvt_pk_bf16_f32 v87, v42, v43
    v_cvt_pk_bf16_f32 v88, v44, v45
    v_cvt_pk_bf16_f32 v89, v46, v47
    v_cvt_pk_bf16_f32 v90, v48, v49
    v_cvt_pk_bf16_f32 v91, v50, v51
    v_mfma_f32_32x32x16_bf16 v[68:83], v[100:103], v[84:87], v[68:83]
    s_nop 0
    v_mfma_f32_32x32x16_bf16 v[68:83], v[104:107], v[88:91], v[68:83]
    s_nop 15
    s_add_u32 s32, s32, 1024
    s_cmp_lt_u32 s32, 0x10000
    s_cbranch_scc1 L_fb2114
    s_nop 15
    s_branch L_fbr78
sequential_preLN__mha_block__mixer_s_mlp__prompt_kernel_end:
    s_endpgm
.section .rodata,"a"
.p2align 6
.amdhsa_kernel sequential_preLN__mha_block__mixer_s_mlp__prompt_kernel
  .amdhsa_next_free_vgpr 256
  .amdhsa_next_free_sgpr 76
  .amdhsa_accum_offset 256
  .amdhsa_group_segment_fixed_size 0
  .amdhsa_kernarg_size 88
  .amdhsa_user_sgpr_count 2
  .amdhsa_user_sgpr_kernarg_segment_ptr 1
  .amdhsa_system_sgpr_workgroup_id_x 1
  .amdhsa_float_denorm_mode_32 3
  .amdhsa_float_denorm_mode_16_64 3
.end_amdhsa_kernel
```
